```python
import torch

def _softmax(x, axis=-1):
    return torch.softmax(x, dim=axis)
def _gelu(x):
    return torch.nn.functional.gelu(x, approximate="tanh")
def _silu(x):
    return torch.nn.functional.silu(x)
def _sigmoid(x):
    return torch.sigmoid(x)
def _layernorm(x, axis=-1, eps=1e-5):
    m = x.mean(dim=axis, keepdim=True)
    v = x.var(dim=axis, keepdim=True, unbiased=False)
    return (x - m) / torch.sqrt(v + eps)
def _scatter_add(tgt, idx, src, axis=0):
    return tgt.clone().index_add_(axis, idx, src)
def _segment_sum(src, seg, n):
    out = torch.zeros((n,) + src.shape[1:], dtype=src.dtype)
    return out.index_add_(0, seg, src)
def _pad(x, pw):
    flat = tuple(v for pair in reversed(pw) for v in pair)
    return torch.nn.functional.pad(x, flat)

kernel_name = 'sequential_preLN__mha_block__dense_activation_squared_relu__prompt'

def setup_inputs():

    _w = (lambda a: (lambda t: t.to(torch.bfloat16) if t.is_floating_point() else t)(torch.as_tensor(a)))
    def _A_setup():
        B, S, D, H = 1, 2048, 640, 32
        return {
            "x": _w((lambda *s: torch.randn(*s, dtype=torch.bfloat16) * 0.05)(B, S, D)),
            "wqkv": _w((lambda *s: torch.randn(*s, dtype=torch.bfloat16) * 0.05)(D, 3 * D)),
            "wo": _w((lambda *s: torch.randn(*s, dtype=torch.bfloat16) * 0.05)(D, D)),
        }
    _A_in = _A_setup()

    def _B_setup():
        B, S, D, F = 1, 2048, 640, 1728
        return {
            "x": _w((lambda *s: torch.randn(*s, dtype=torch.bfloat16) * 0.05)(B, S, D)),
            "w1": _w((lambda *s: torch.randn(*s, dtype=torch.bfloat16) * 0.05)(D, F)),
            "b1": _w((lambda *s: torch.randn(*s, dtype=torch.bfloat16) * 0.4)(F)),
            "w2": _w((lambda *s: torch.randn(*s, dtype=torch.bfloat16) * 0.05)(F, D)),
            "b2": _w((lambda *s: torch.randn(*s, dtype=torch.bfloat16) * 3.2)(D)),
        }
    _B_in = _B_setup()

    return {
        "A_x": _A_in["x"],
        "A_wqkv": _A_in["wqkv"],
        "A_wo": _A_in["wo"],
        "B_x": _B_in["x"],
        "B_w1": _B_in["w1"],
        "B_b1": _B_in["b1"],
        "B_w2": _B_in["w2"],
        "B_b2": _B_in["b2"],
    }

def reference(A_x, A_wqkv, A_wo, B_x, B_w1, B_b1, B_w2, B_b2):
    def _A_ref(x, wqkv, wo):
        B, S, D = x.shape
        H = 32
        Dh = D // H
        qkv = (lambda x, *d: x.permute(*d))((x @ wqkv).reshape(B, S, 3, H, Dh), 2, 0, 3, 1, 4)
        q, k, v = qkv[0], qkv[1], qkv[2]
        scores = torch.einsum("bhqd,bhkd->bhqk", q, k) * (Dh ** -0.5)
        p = _softmax(scores, axis=-1)
        o = torch.einsum("bhqk,bhkd->bhqd", p, v)
        return (lambda x, *d: x.permute(*d))(o, 0, 2, 1, 3).reshape(B, S, D) @ wo

    def _B_ref(x, w1, b1, w2, b2):
        h = torch.einsum("bsd,df->bsf", x, w1) + b1
        zero = torch.zeros_like(h)
        r = torch.where(h > zero, h, zero)
        h = r * r
        out = torch.einsum("bsf,fd->bsd", h, w2) + b2
        return out

    x = A_x
    h = x + _A_ref(_layernorm(x, axis=-1), A_wqkv, A_wo)
    h2 = h + _B_ref(_layernorm(h, axis=-1), B_w1, B_b1, B_w2, B_b2)
    return h2
```

```asm
; @launch kernel=k1_kernel grid=(256,1,1) block=(512,1,1) lds=163840
; @launch kernel=kf_kernel grid=(256,1,1) block=(512,1,1) lds=163840
.amdgcn_target "amdgcn-amd-amdhsa--gfx950"
.text
.globl k1_kernel
.p2align 8
.type k1_kernel,@function
k1_kernel:
    s_cmp_ge_u32 s2, 256
    s_cbranch_scc1 k1_kernel_end
    s_getpc_b64 s[40:41]
.Lpc_k1:
    s_sub_u32 s40, s40, (.Lpc_k1 - k1_kernel)
    s_subb_u32 s41, s41, 0
    v_lshlrev_b32 v144, 6, v0
    s_mov_b32 s42, (.Lkf_last - k1_kernel - 4)
    v_add_u32 v146, 0, v144
    v_min_u32 v146, s42, v146
    v_mov_b32 v147, s41
    v_add_co_u32 v146, vcc, s40, v146
    s_nop 1
    v_addc_co_u32 v147, vcc, 0, v147, vcc
    global_load_dword v151, v[146:147], off
    v_add_u32 v146, 32768, v144
    v_min_u32 v146, s42, v146
    v_mov_b32 v147, s41
    v_add_co_u32 v146, vcc, s40, v146
    s_nop 1
    v_addc_co_u32 v147, vcc, 0, v147, vcc
    global_load_dword v151, v[146:147], off
    s_load_dwordx2 s[24:25], s[0:1], 0
    s_load_dwordx2 s[26:27], s[0:1], 8
    s_load_dwordx2 s[4:5], s[0:1], 80
    s_load_dwordx2 s[28:29], s[0:1], 16
    s_load_dwordx2 s[30:31], s[0:1], 32
    s_load_dwordx2 s[32:33], s[0:1], 48
    s_and_b32 s15, s2, 7
    s_lshr_b32 s16, s2, 3
    s_and_b32 s13, s15, 3
    s_lshl_b32 s13, s13, 2
    s_and_b32 s17, s16, 3
    s_add_u32 s13, s13, s17
    s_lshr_b32 s14, s15, 2
    s_lshl_b32 s14, s14, 3
    s_lshr_b32 s17, s16, 2
    s_add_u32 s14, s14, s17
    v_lshrrev_b32 v1, 6, v0
    v_and_b32 v2, 63, v0
    v_readfirstlane_b32 s12, v1
    v_and_b32 v3, 31, v2
    v_lshrrev_b32 v4, 5, v2
    v_lshlrev_b32 v10, 4, v2
    s_nop 0
    s_and_b32 s23, s12, 3
    s_cmp_lt_u32 s12, 4
    s_cbranch_scc1 k1_kernel_compute
    v_lshrrev_b32 v5, 3, v2
    s_lshl_b32 s40, s23, 3
    v_add_u32 v5, s40, v5
    v_lshrrev_b32 v6, 4, v2
    s_lshl_b32 s40, s23, 2
    v_add_u32 v7, s40, v6
    v_and_b32 v7, 7, v7
    v_and_b32 v8, 7, v2
    v_xor_b32 v7, v7, v8
    s_movk_i32 s40, 1280
    v_mul_lo_u32 v5, v5, s40
    v_lshl_add_u32 v5, v7, 4, v5
    s_mul_i32 s35, s13, 163840
    s_lshl_b32 s40, s23, 2
    v_add_u32 v7, s40, v6
    s_movk_i32 s40, 3840
    v_mul_lo_u32 v7, v7, s40
    v_and_b32 v8, 15, v2
    v_lshlrev_b32 v9, 2, v6
    v_xor_b32 v8, v8, v9
    v_lshl_add_u32 v6, v8, 4, v7
    s_lshl_b32 s36, s14, 8
    s_lshl_b32 s37, s23, 10
    s_waitcnt lgkmcnt(0)
    s_mov_b32 s56, s24
    s_and_b32 s57, s25, 0xffff
    s_mov_b32 s58, 2621440
    s_mov_b32 s59, 0x20000
    s_mov_b32 s60, s26
    s_and_b32 s61, s27, 0xffff
    s_mov_b32 s62, 2457600
    s_mov_b32 s63, 0x20000
    s_mov_b32 s8, s4
    s_and_b32 s9, s5, 0xffff
    s_mov_b32 s10, 31932416
    s_mov_b32 s11, 0x20000
    s_cmp_ge_u32 s14, 15
    s_cbranch_scc1 k1_kernel_nogemm
    s_add_u32 m0, s37, 0
    s_add_u32 s38, s35, 0
    buffer_load_dwordx4 v5, s[56:59], s38 offen lds
    s_add_u32 m0, s37, 4096
    s_add_u32 s38, s35, 40960
    buffer_load_dwordx4 v5, s[56:59], s38 offen lds
    s_add_u32 m0, s37, 8192
    s_add_u32 s38, s35, 81920
    buffer_load_dwordx4 v5, s[56:59], s38 offen lds
    s_add_u32 m0, s37, 12288
    s_add_u32 s38, s35, 122880
    buffer_load_dwordx4 v5, s[56:59], s38 offen lds
    s_add_u32 m0, s37, 32768
    s_add_u32 s38, s35, 128
    buffer_load_dwordx4 v5, s[56:59], s38 offen lds
    s_add_u32 m0, s37, 36864
    s_add_u32 s38, s35, 41088
    buffer_load_dwordx4 v5, s[56:59], s38 offen lds
    s_add_u32 m0, s37, 40960
    s_add_u32 s38, s35, 82048
    buffer_load_dwordx4 v5, s[56:59], s38 offen lds
    s_add_u32 m0, s37, 45056
    s_add_u32 s38, s35, 123008
    buffer_load_dwordx4 v5, s[56:59], s38 offen lds
    v_lshlrev_b32 v96, 17, v2
    s_lshl_b32 s40, s23, 23
    buffer_load_dword v100, v96, s[8:11], s40 offen
    s_cmp_lt_u32 s2, 40
    s_cbranch_scc0 .Lpk1
    s_mov_b32 s64, s28
    s_and_b32 s65, s29, 0xffff
    s_mov_b32 s66, 819200
    s_mov_b32 s67, 0x20000
    s_mul_hi_u32 s46, s2, 429496730
    s_mul_i32 s47, s46, 10
    s_sub_u32 s47, s2, s47
    s_movk_i32 s41, 160
    s_movk_i32 s42, 1280
    s_mov_b32 s44, 5079040
    s_movk_i32 s45, 20480
    s_branch .Lpk3
.Lpk1:
    s_cmp_lt_u32 s2, 148
    s_cbranch_scc0 .Lpk2
    s_mov_b32 s64, s30
    s_and_b32 s65, s31, 0xffff
    s_mov_b32 s66, 2211840
    s_mov_b32 s67, 0x20000
    s_sub_u32 s40, s2, 40
    s_mul_hi_u32 s46, s40, 159072863
    s_mul_i32 s47, s46, 27
    s_sub_u32 s47, s40, s47
    s_movk_i32 s41, 160
    s_movk_i32 s42, 3456
    s_mov_b32 s44, 5898240
    s_movk_i32 s45, 20480
    s_branch .Lpk3
.Lpk2:
    s_mov_b32 s64, s32
    s_and_b32 s65, s33, 0xffff
    s_mov_b32 s66, 2211840
    s_mov_b32 s67, 0x20000
    s_sub_u32 s40, s2, 148
    s_mul_hi_u32 s46, s40, 429496730
    s_mul_i32 s47, s46, 10
    s_sub_u32 s47, s40, s47
    s_movk_i32 s41, 192
    s_movk_i32 s42, 1280
    s_mov_b32 s44, 8110080
    s_mov_b32 s45, 55296
.Lpk3:
    s_mul_i32 s43, s46, s41
    s_lshr_b32 s48, s43, 3
    s_mul_i32 s43, s43, s42
    s_lshl_b32 s40, s47, 7
    s_add_u32 s43, s43, s40
    s_lshl_b32 s40, s47, 2
    s_mul_i32 s40, s40, s45
    s_add_u32 s44, s44, s40
    s_lshl_b32 s40, s48, 8
    s_add_u32 s44, s44, s40
    v_lshrrev_b32 v11, 3, v2
    s_lshl_b32 s40, s23, 3
    v_add_u32 v11, s40, v11
    v_mul_lo_u32 v11, v11, s42
    v_and_b32 v12, 7, v2
    v_lshl_add_u32 v11, v12, 4, v11
    s_cmp_lt_u32 s2, 238
    s_cselect_b32 s49, s43, 0x7ff00000
    s_lshl_b32 s50, s42, 5
    v_lshrrev_b32 v7, 1, v3
    v_and_b32 v7, 7, v7
    s_lshl_b32 s40, s23, 12
    v_lshlrev_b32 v8, 7, v3
    v_add_u32 v8, s40, v8
    v_or_b32 v9, 0, v4
    v_xor_b32 v9, v9, v7
    v_lshl_add_u32 v14, v9, 4, v8
    v_add_u32 v18, 0x10000, v14
    v_or_b32 v9, 2, v4
    v_xor_b32 v9, v9, v7
    v_lshl_add_u32 v15, v9, 4, v8
    v_add_u32 v19, 0x10000, v15
    v_or_b32 v9, 4, v4
    v_xor_b32 v9, v9, v7
    v_lshl_add_u32 v16, v9, 4, v8
    v_add_u32 v20, 0x10000, v16
    v_or_b32 v9, 6, v4
    v_xor_b32 v9, v9, v7
    v_lshl_add_u32 v17, v9, 4, v8
    v_add_u32 v21, 0x10000, v17
    v_mov_b32 v40, 0
    v_mov_b32 v41, 0
    v_mov_b32 v42, 0
    v_mov_b32 v43, 0
    s_waitcnt vmcnt(5)
    s_barrier
    ds_read_b128 v[24:27], v14 offset:0
    ds_read_b128 v[28:31], v15 offset:0
    ds_read_b128 v[32:35], v16 offset:0
    ds_read_b128 v[36:39], v17 offset:0
    s_add_u32 m0, s37, 65536
    s_add_u32 s38, s35, 256
    buffer_load_dwordx4 v5, s[56:59], s38 offen lds
    s_waitcnt lgkmcnt(0)
    v_lshlrev_b32 v44, 16, v24
    v_and_b32 v45, 0xffff0000, v24
    v_add_f32 v40, v40, v44
    v_fmac_f32 v42, v44, v44
    v_add_f32 v40, v40, v45
    v_fmac_f32 v42, v45, v45
    v_lshlrev_b32 v46, 16, v25
    v_and_b32 v47, 0xffff0000, v25
    v_add_f32 v41, v41, v46
    v_fmac_f32 v43, v46, v46
    v_add_f32 v41, v41, v47
    v_fmac_f32 v43, v47, v47
    s_add_u32 m0, s37, 69632
    s_add_u32 s38, s35, 41216
    buffer_load_dwordx4 v5, s[56:59], s38 offen lds
    v_lshlrev_b32 v44, 16, v26
    v_and_b32 v45, 0xffff0000, v26
    v_add_f32 v40, v40, v44
    v_fmac_f32 v42, v44, v44
    v_add_f32 v40, v40, v45
    v_fmac_f32 v42, v45, v45
    v_lshlrev_b32 v46, 16, v27
    v_and_b32 v47, 0xffff0000, v27
    v_add_f32 v41, v41, v46
    v_fmac_f32 v43, v46, v46
    v_add_f32 v41, v41, v47
    v_fmac_f32 v43, v47, v47
    s_add_u32 m0, s37, 73728
    s_add_u32 s38, s35, 82176
    buffer_load_dwordx4 v5, s[56:59], s38 offen lds
    v_lshlrev_b32 v44, 16, v28
    v_and_b32 v45, 0xffff0000, v28
    v_add_f32 v40, v40, v44
    v_fmac_f32 v42, v44, v44
    v_add_f32 v40, v40, v45
    v_fmac_f32 v42, v45, v45
    v_lshlrev_b32 v46, 16, v29
    v_and_b32 v47, 0xffff0000, v29
    v_add_f32 v41, v41, v46
    v_fmac_f32 v43, v46, v46
    v_add_f32 v41, v41, v47
    v_fmac_f32 v43, v47, v47
    s_add_u32 m0, s37, 77824
    s_add_u32 s38, s35, 123136
    buffer_load_dwordx4 v5, s[56:59], s38 offen lds
    v_lshlrev_b32 v44, 16, v30
    v_and_b32 v45, 0xffff0000, v30
    v_add_f32 v40, v40, v44
    v_fmac_f32 v42, v44, v44
    v_add_f32 v40, v40, v45
    v_fmac_f32 v42, v45, v45
    v_lshlrev_b32 v46, 16, v31
    v_and_b32 v47, 0xffff0000, v31
    v_add_f32 v41, v41, v46
    v_fmac_f32 v43, v46, v46
    v_add_f32 v41, v41, v47
    v_fmac_f32 v43, v47, v47
    s_add_u32 m0, s37, 98304
    s_add_u32 s38, s35, 384
    buffer_load_dwordx4 v5, s[56:59], s38 offen lds
    v_lshlrev_b32 v44, 16, v32
    v_and_b32 v45, 0xffff0000, v32
    v_add_f32 v40, v40, v44
    v_fmac_f32 v42, v44, v44
    v_add_f32 v40, v40, v45
    v_fmac_f32 v42, v45, v45
    v_lshlrev_b32 v46, 16, v33
    v_and_b32 v47, 0xffff0000, v33
    v_add_f32 v41, v41, v46
    v_fmac_f32 v43, v46, v46
    v_add_f32 v41, v41, v47
    v_fmac_f32 v43, v47, v47
    s_add_u32 m0, s37, 102400
    s_add_u32 s38, s35, 41344
    buffer_load_dwordx4 v5, s[56:59], s38 offen lds
    v_lshlrev_b32 v44, 16, v34
    v_and_b32 v45, 0xffff0000, v34
    v_add_f32 v40, v40, v44
    v_fmac_f32 v42, v44, v44
    v_add_f32 v40, v40, v45
    v_fmac_f32 v42, v45, v45
    v_lshlrev_b32 v46, 16, v35
    v_and_b32 v47, 0xffff0000, v35
    v_add_f32 v41, v41, v46
    v_fmac_f32 v43, v46, v46
    v_add_f32 v41, v41, v47
    v_fmac_f32 v43, v47, v47
    s_add_u32 m0, s37, 106496
    s_add_u32 s38, s35, 82304
    buffer_load_dwordx4 v5, s[56:59], s38 offen lds
    v_lshlrev_b32 v44, 16, v36
    v_and_b32 v45, 0xffff0000, v36
    v_add_f32 v40, v40, v44
    v_fmac_f32 v42, v44, v44
    v_add_f32 v40, v40, v45
    v_fmac_f32 v42, v45, v45
    v_lshlrev_b32 v46, 16, v37
    v_and_b32 v47, 0xffff0000, v37
    v_add_f32 v41, v41, v46
    v_fmac_f32 v43, v46, v46
    v_add_f32 v41, v41, v47
    v_fmac_f32 v43, v47, v47
    s_add_u32 m0, s37, 110592
    s_add_u32 s38, s35, 123264
    buffer_load_dwordx4 v5, s[56:59], s38 offen lds
    v_lshlrev_b32 v44, 16, v38
    v_and_b32 v45, 0xffff0000, v38
    v_add_f32 v40, v40, v44
    v_fmac_f32 v42, v44, v44
    v_add_f32 v40, v40, v45
    v_fmac_f32 v42, v45, v45
    v_lshlrev_b32 v46, 16, v39
    v_and_b32 v47, 0xffff0000, v39
    v_add_f32 v41, v41, v46
    v_fmac_f32 v43, v46, v46
    v_add_f32 v41, v41, v47
    v_fmac_f32 v43, v47, v47
    s_waitcnt vmcnt(9)
    s_barrier
    ds_read_b128 v[24:27], v14 offset:32768
    ds_read_b128 v[28:31], v15 offset:32768
    ds_read_b128 v[32:35], v16 offset:32768
    ds_read_b128 v[36:39], v17 offset:32768
    s_add_u32 m0, s37, 0
    s_add_u32 s38, s35, 512
    buffer_load_dwordx4 v5, s[56:59], s38 offen lds
    s_waitcnt lgkmcnt(0)
    v_lshlrev_b32 v44, 16, v24
    v_and_b32 v45, 0xffff0000, v24
    v_add_f32 v40, v40, v44
    v_fmac_f32 v42, v44, v44
    v_add_f32 v40, v40, v45
    v_fmac_f32 v42, v45, v45
    v_lshlrev_b32 v46, 16, v25
    v_and_b32 v47, 0xffff0000, v25
    v_add_f32 v41, v41, v46
    v_fmac_f32 v43, v46, v46
    v_add_f32 v41, v41, v47
    v_fmac_f32 v43, v47, v47
    v_lshlrev_b32 v44, 16, v26
    v_and_b32 v45, 0xffff0000, v26
    v_add_f32 v40, v40, v44
    v_fmac_f32 v42, v44, v44
    v_add_f32 v40, v40, v45
    v_fmac_f32 v42, v45, v45
    v_lshlrev_b32 v46, 16, v27
    v_and_b32 v47, 0xffff0000, v27
    v_add_f32 v41, v41, v46
    v_fmac_f32 v43, v46, v46
    v_add_f32 v41, v41, v47
    v_fmac_f32 v43, v47, v47
    s_add_u32 m0, s37, 4096
    s_add_u32 s38, s35, 41472
    buffer_load_dwordx4 v5, s[56:59], s38 offen lds
    v_lshlrev_b32 v44, 16, v28
    v_and_b32 v45, 0xffff0000, v28
    v_add_f32 v40, v40, v44
    v_fmac_f32 v42, v44, v44
    v_add_f32 v40, v40, v45
    v_fmac_f32 v42, v45, v45
    v_lshlrev_b32 v46, 16, v29
    v_and_b32 v47, 0xffff0000, v29
    v_add_f32 v41, v41, v46
    v_fmac_f32 v43, v46, v46
    v_add_f32 v41, v41, v47
    v_fmac_f32 v43, v47, v47
    v_lshlrev_b32 v44, 16, v30
    v_and_b32 v45, 0xffff0000, v30
    v_add_f32 v40, v40, v44
    v_fmac_f32 v42, v44, v44
    v_add_f32 v40, v40, v45
    v_fmac_f32 v42, v45, v45
    v_lshlrev_b32 v46, 16, v31
    v_and_b32 v47, 0xffff0000, v31
    v_add_f32 v41, v41, v46
    v_fmac_f32 v43, v46, v46
    v_add_f32 v41, v41, v47
    v_fmac_f32 v43, v47, v47
    s_add_u32 m0, s37, 8192
    s_add_u32 s38, s35, 82432
    buffer_load_dwordx4 v5, s[56:59], s38 offen lds
    v_lshlrev_b32 v44, 16, v32
    v_and_b32 v45, 0xffff0000, v32
    v_add_f32 v40, v40, v44
    v_fmac_f32 v42, v44, v44
    v_add_f32 v40, v40, v45
    v_fmac_f32 v42, v45, v45
    v_lshlrev_b32 v46, 16, v33
    v_and_b32 v47, 0xffff0000, v33
    v_add_f32 v41, v41, v46
    v_fmac_f32 v43, v46, v46
    v_add_f32 v41, v41, v47
    v_fmac_f32 v43, v47, v47
    v_lshlrev_b32 v44, 16, v34
    v_and_b32 v45, 0xffff0000, v34
    v_add_f32 v40, v40, v44
    v_fmac_f32 v42, v44, v44
    v_add_f32 v40, v40, v45
    v_fmac_f32 v42, v45, v45
    v_lshlrev_b32 v46, 16, v35
    v_and_b32 v47, 0xffff0000, v35
    v_add_f32 v41, v41, v46
    v_fmac_f32 v43, v46, v46
    v_add_f32 v41, v41, v47
    v_fmac_f32 v43, v47, v47
    s_add_u32 m0, s37, 12288
    s_add_u32 s38, s35, 123392
    buffer_load_dwordx4 v5, s[56:59], s38 offen lds
    v_lshlrev_b32 v44, 16, v36
    v_and_b32 v45, 0xffff0000, v36
    v_add_f32 v40, v40, v44
    v_fmac_f32 v42, v44, v44
    v_add_f32 v40, v40, v45
    v_fmac_f32 v42, v45, v45
    v_lshlrev_b32 v46, 16, v37
    v_and_b32 v47, 0xffff0000, v37
    v_add_f32 v41, v41, v46
    v_fmac_f32 v43, v46, v46
    v_add_f32 v41, v41, v47
    v_fmac_f32 v43, v47, v47
    v_lshlrev_b32 v44, 16, v38
    v_and_b32 v45, 0xffff0000, v38
    v_add_f32 v40, v40, v44
    v_fmac_f32 v42, v44, v44
    v_add_f32 v40, v40, v45
    v_fmac_f32 v42, v45, v45
    v_lshlrev_b32 v46, 16, v39
    v_and_b32 v47, 0xffff0000, v39
    v_add_f32 v41, v41, v46
    v_fmac_f32 v43, v46, v46
    v_add_f32 v41, v41, v47
    v_fmac_f32 v43, v47, v47
    s_waitcnt vmcnt(8)
    s_barrier
    ds_read_b128 v[24:27], v18 offset:0
    ds_read_b128 v[28:31], v19 offset:0
    ds_read_b128 v[32:35], v20 offset:0
    ds_read_b128 v[36:39], v21 offset:0
    s_add_u32 m0, s37, 32768
    s_add_u32 s38, s35, 640
    buffer_load_dwordx4 v5, s[56:59], s38 offen lds
    s_waitcnt lgkmcnt(0)
    v_lshlrev_b32 v44, 16, v24
    v_and_b32 v45, 0xffff0000, v24
    v_add_f32 v40, v40, v44
    v_fmac_f32 v42, v44, v44
    v_add_f32 v40, v40, v45
    v_fmac_f32 v42, v45, v45
    v_lshlrev_b32 v46, 16, v25
    v_and_b32 v47, 0xffff0000, v25
    v_add_f32 v41, v41, v46
    v_fmac_f32 v43, v46, v46
    v_add_f32 v41, v41, v47
    v_fmac_f32 v43, v47, v47
    v_lshlrev_b32 v44, 16, v26
    v_and_b32 v45, 0xffff0000, v26
    v_add_f32 v40, v40, v44
    v_fmac_f32 v42, v44, v44
    v_add_f32 v40, v40, v45
    v_fmac_f32 v42, v45, v45
    v_lshlrev_b32 v46, 16, v27
    v_and_b32 v47, 0xffff0000, v27
    v_add_f32 v41, v41, v46
    v_fmac_f32 v43, v46, v46
    v_add_f32 v41, v41, v47
    v_fmac_f32 v43, v47, v47
    s_add_u32 m0, s37, 36864
    s_add_u32 s38, s35, 41600
    buffer_load_dwordx4 v5, s[56:59], s38 offen lds
    v_lshlrev_b32 v44, 16, v28
    v_and_b32 v45, 0xffff0000, v28
    v_add_f32 v40, v40, v44
    v_fmac_f32 v42, v44, v44
    v_add_f32 v40, v40, v45
    v_fmac_f32 v42, v45, v45
    v_lshlrev_b32 v46, 16, v29
    v_and_b32 v47, 0xffff0000, v29
    v_add_f32 v41, v41, v46
    v_fmac_f32 v43, v46, v46
    v_add_f32 v41, v41, v47
    v_fmac_f32 v43, v47, v47
    v_lshlrev_b32 v44, 16, v30
    v_and_b32 v45, 0xffff0000, v30
    v_add_f32 v40, v40, v44
    v_fmac_f32 v42, v44, v44
    v_add_f32 v40, v40, v45
    v_fmac_f32 v42, v45, v45
    v_lshlrev_b32 v46, 16, v31
    v_and_b32 v47, 0xffff0000, v31
    v_add_f32 v41, v41, v46
    v_fmac_f32 v43, v46, v46
    v_add_f32 v41, v41, v47
    v_fmac_f32 v43, v47, v47
    s_add_u32 m0, s37, 40960
    s_add_u32 s38, s35, 82560
    buffer_load_dwordx4 v5, s[56:59], s38 offen lds
    v_lshlrev_b32 v44, 16, v32
    v_and_b32 v45, 0xffff0000, v32
    v_add_f32 v40, v40, v44
    v_fmac_f32 v42, v44, v44
    v_add_f32 v40, v40, v45
    v_fmac_f32 v42, v45, v45
    v_lshlrev_b32 v46, 16, v33
    v_and_b32 v47, 0xffff0000, v33
    v_add_f32 v41, v41, v46
    v_fmac_f32 v43, v46, v46
    v_add_f32 v41, v41, v47
    v_fmac_f32 v43, v47, v47
    v_lshlrev_b32 v44, 16, v34
    v_and_b32 v45, 0xffff0000, v34
    v_add_f32 v40, v40, v44
    v_fmac_f32 v42, v44, v44
    v_add_f32 v40, v40, v45
    v_fmac_f32 v42, v45, v45
    v_lshlrev_b32 v46, 16, v35
    v_and_b32 v47, 0xffff0000, v35
    v_add_f32 v41, v41, v46
    v_fmac_f32 v43, v46, v46
    v_add_f32 v41, v41, v47
    v_fmac_f32 v43, v47, v47
    s_add_u32 m0, s37, 45056
    s_add_u32 s38, s35, 123520
    buffer_load_dwordx4 v5, s[56:59], s38 offen lds
    v_lshlrev_b32 v44, 16, v36
    v_and_b32 v45, 0xffff0000, v36
    v_add_f32 v40, v40, v44
    v_fmac_f32 v42, v44, v44
    v_add_f32 v40, v40, v45
    v_fmac_f32 v42, v45, v45
    v_lshlrev_b32 v46, 16, v37
    v_and_b32 v47, 0xffff0000, v37
    v_add_f32 v41, v41, v46
    v_fmac_f32 v43, v46, v46
    v_add_f32 v41, v41, v47
    v_fmac_f32 v43, v47, v47
    v_lshlrev_b32 v44, 16, v38
    v_and_b32 v45, 0xffff0000, v38
    v_add_f32 v40, v40, v44
    v_fmac_f32 v42, v44, v44
    v_add_f32 v40, v40, v45
    v_fmac_f32 v42, v45, v45
    v_lshlrev_b32 v46, 16, v39
    v_and_b32 v47, 0xffff0000, v39
    v_add_f32 v41, v41, v46
    v_fmac_f32 v43, v46, v46
    v_add_f32 v41, v41, v47
    v_fmac_f32 v43, v47, v47
    s_add_u32 m0, s37, 131072
    s_nop 0
    buffer_load_dwordx4 v11, s[64:67], s49 offen nt lds
    s_add_u32 s49, s49, s50
    s_add_u32 m0, s37, 135168
    s_nop 0
    buffer_load_dwordx4 v11, s[64:67], s49 offen nt lds
    s_add_u32 s49, s49, s50
    s_waitcnt vmcnt(10)
    s_barrier
    ds_read_b128 v[24:27], v18 offset:32768
    ds_read_b128 v[28:31], v19 offset:32768
    ds_read_b128 v[32:35], v20 offset:32768
    ds_read_b128 v[36:39], v21 offset:32768
    s_add_u32 m0, s37, 65536
    s_add_u32 s38, s35, 768
    buffer_load_dwordx4 v5, s[56:59], s38 offen lds
    s_waitcnt lgkmcnt(0)
    v_lshlrev_b32 v44, 16, v24
    v_and_b32 v45, 0xffff0000, v24
    v_add_f32 v40, v40, v44
    v_fmac_f32 v42, v44, v44
    v_add_f32 v40, v40, v45
    v_fmac_f32 v42, v45, v45
    v_lshlrev_b32 v46, 16, v25
    v_and_b32 v47, 0xffff0000, v25
    v_add_f32 v41, v41, v46
    v_fmac_f32 v43, v46, v46
    v_add_f32 v41, v41, v47
    v_fmac_f32 v43, v47, v47
    v_lshlrev_b32 v44, 16, v26
    v_and_b32 v45, 0xffff0000, v26
    v_add_f32 v40, v40, v44
    v_fmac_f32 v42, v44, v44
    v_add_f32 v40, v40, v45
    v_fmac_f32 v42, v45, v45
    v_lshlrev_b32 v46, 16, v27
    v_and_b32 v47, 0xffff0000, v27
    v_add_f32 v41, v41, v46
    v_fmac_f32 v43, v46, v46
    v_add_f32 v41, v41, v47
    v_fmac_f32 v43, v47, v47
    s_add_u32 m0, s37, 69632
    s_add_u32 s38, s35, 41728
    buffer_load_dwordx4 v5, s[56:59], s38 offen lds
    v_lshlrev_b32 v44, 16, v28
    v_and_b32 v45, 0xffff0000, v28
    v_add_f32 v40, v40, v44
    v_fmac_f32 v42, v44, v44
    v_add_f32 v40, v40, v45
    v_fmac_f32 v42, v45, v45
    v_lshlrev_b32 v46, 16, v29
    v_and_b32 v47, 0xffff0000, v29
    v_add_f32 v41, v41, v46
    v_fmac_f32 v43, v46, v46
    v_add_f32 v41, v41, v47
    v_fmac_f32 v43, v47, v47
    v_lshlrev_b32 v44, 16, v30
    v_and_b32 v45, 0xffff0000, v30
    v_add_f32 v40, v40, v44
    v_fmac_f32 v42, v44, v44
    v_add_f32 v40, v40, v45
    v_fmac_f32 v42, v45, v45
    v_lshlrev_b32 v46, 16, v31
    v_and_b32 v47, 0xffff0000, v31
    v_add_f32 v41, v41, v46
    v_fmac_f32 v43, v46, v46
    v_add_f32 v41, v41, v47
    v_fmac_f32 v43, v47, v47
    s_add_u32 m0, s37, 73728
    s_add_u32 s38, s35, 82688
    buffer_load_dwordx4 v5, s[56:59], s38 offen lds
    v_lshlrev_b32 v44, 16, v32
    v_and_b32 v45, 0xffff0000, v32
    v_add_f32 v40, v40, v44
    v_fmac_f32 v42, v44, v44
    v_add_f32 v40, v40, v45
    v_fmac_f32 v42, v45, v45
    v_lshlrev_b32 v46, 16, v33
    v_and_b32 v47, 0xffff0000, v33
    v_add_f32 v41, v41, v46
    v_fmac_f32 v43, v46, v46
    v_add_f32 v41, v41, v47
    v_fmac_f32 v43, v47, v47
    v_lshlrev_b32 v44, 16, v34
    v_and_b32 v45, 0xffff0000, v34
    v_add_f32 v40, v40, v44
    v_fmac_f32 v42, v44, v44
    v_add_f32 v40, v40, v45
    v_fmac_f32 v42, v45, v45
    v_lshlrev_b32 v46, 16, v35
    v_and_b32 v47, 0xffff0000, v35
    v_add_f32 v41, v41, v46
    v_fmac_f32 v43, v46, v46
    v_add_f32 v41, v41, v47
    v_fmac_f32 v43, v47, v47
    s_add_u32 m0, s37, 77824
    s_add_u32 s38, s35, 123648
    buffer_load_dwordx4 v5, s[56:59], s38 offen lds
    v_lshlrev_b32 v44, 16, v36
    v_and_b32 v45, 0xffff0000, v36
    v_add_f32 v40, v40, v44
    v_fmac_f32 v42, v44, v44
    v_add_f32 v40, v40, v45
    v_fmac_f32 v42, v45, v45
    v_lshlrev_b32 v46, 16, v37
    v_and_b32 v47, 0xffff0000, v37
    v_add_f32 v41, v41, v46
    v_fmac_f32 v43, v46, v46
    v_add_f32 v41, v41, v47
    v_fmac_f32 v43, v47, v47
    v_lshlrev_b32 v44, 16, v38
    v_and_b32 v45, 0xffff0000, v38
    v_add_f32 v40, v40, v44
    v_fmac_f32 v42, v44, v44
    v_add_f32 v40, v40, v45
    v_fmac_f32 v42, v45, v45
    v_lshlrev_b32 v46, 16, v39
    v_and_b32 v47, 0xffff0000, v39
    v_add_f32 v41, v41, v46
    v_fmac_f32 v43, v46, v46
    v_add_f32 v41, v41, v47
    v_fmac_f32 v43, v47, v47
    s_add_u32 m0, s37, 139264
    s_nop 0
    buffer_load_dwordx4 v11, s[64:67], s49 offen nt lds
    s_add_u32 s49, s49, s50
    s_add_u32 m0, s37, 143360
    s_nop 0
    buffer_load_dwordx4 v11, s[64:67], s49 offen nt lds
    s_add_u32 s49, s49, s50
    s_waitcnt vmcnt(12)
    s_barrier
    ds_read_b128 v[24:27], v14 offset:0
    ds_read_b128 v[28:31], v15 offset:0
    ds_read_b128 v[32:35], v16 offset:0
    ds_read_b128 v[36:39], v17 offset:0
    s_add_u32 m0, s37, 98304
    s_add_u32 s38, s35, 896
    buffer_load_dwordx4 v5, s[56:59], s38 offen lds
    s_waitcnt lgkmcnt(0)
    v_lshlrev_b32 v44, 16, v24
    v_and_b32 v45, 0xffff0000, v24
    v_add_f32 v40, v40, v44
    v_fmac_f32 v42, v44, v44
    v_add_f32 v40, v40, v45
    v_fmac_f32 v42, v45, v45
    v_lshlrev_b32 v46, 16, v25
    v_and_b32 v47, 0xffff0000, v25
    v_add_f32 v41, v41, v46
    v_fmac_f32 v43, v46, v46
    v_add_f32 v41, v41, v47
    v_fmac_f32 v43, v47, v47
    v_lshlrev_b32 v44, 16, v26
    v_and_b32 v45, 0xffff0000, v26
    v_add_f32 v40, v40, v44
    v_fmac_f32 v42, v44, v44
    v_add_f32 v40, v40, v45
    v_fmac_f32 v42, v45, v45
    v_lshlrev_b32 v46, 16, v27
    v_and_b32 v47, 0xffff0000, v27
    v_add_f32 v41, v41, v46
    v_fmac_f32 v43, v46, v46
    v_add_f32 v41, v41, v47
    v_fmac_f32 v43, v47, v47
    s_add_u32 m0, s37, 102400
    s_add_u32 s38, s35, 41856
    buffer_load_dwordx4 v5, s[56:59], s38 offen lds
    v_lshlrev_b32 v44, 16, v28
    v_and_b32 v45, 0xffff0000, v28
    v_add_f32 v40, v40, v44
    v_fmac_f32 v42, v44, v44
    v_add_f32 v40, v40, v45
    v_fmac_f32 v42, v45, v45
    v_lshlrev_b32 v46, 16, v29
    v_and_b32 v47, 0xffff0000, v29
    v_add_f32 v41, v41, v46
    v_fmac_f32 v43, v46, v46
    v_add_f32 v41, v41, v47
    v_fmac_f32 v43, v47, v47
    v_lshlrev_b32 v44, 16, v30
    v_and_b32 v45, 0xffff0000, v30
    v_add_f32 v40, v40, v44
    v_fmac_f32 v42, v44, v44
    v_add_f32 v40, v40, v45
    v_fmac_f32 v42, v45, v45
    v_lshlrev_b32 v46, 16, v31
    v_and_b32 v47, 0xffff0000, v31
    v_add_f32 v41, v41, v46
    v_fmac_f32 v43, v46, v46
    v_add_f32 v41, v41, v47
    v_fmac_f32 v43, v47, v47
    s_add_u32 m0, s37, 106496
    s_add_u32 s38, s35, 82816
    buffer_load_dwordx4 v5, s[56:59], s38 offen lds
    v_lshlrev_b32 v44, 16, v32
    v_and_b32 v45, 0xffff0000, v32
    v_add_f32 v40, v40, v44
    v_fmac_f32 v42, v44, v44
    v_add_f32 v40, v40, v45
    v_fmac_f32 v42, v45, v45
    v_lshlrev_b32 v46, 16, v33
    v_and_b32 v47, 0xffff0000, v33
    v_add_f32 v41, v41, v46
    v_fmac_f32 v43, v46, v46
    v_add_f32 v41, v41, v47
    v_fmac_f32 v43, v47, v47
    v_lshlrev_b32 v44, 16, v34
    v_and_b32 v45, 0xffff0000, v34
    v_add_f32 v40, v40, v44
    v_fmac_f32 v42, v44, v44
    v_add_f32 v40, v40, v45
    v_fmac_f32 v42, v45, v45
    v_lshlrev_b32 v46, 16, v35
    v_and_b32 v47, 0xffff0000, v35
    v_add_f32 v41, v41, v46
    v_fmac_f32 v43, v46, v46
    v_add_f32 v41, v41, v47
    v_fmac_f32 v43, v47, v47
    s_add_u32 m0, s37, 110592
    s_add_u32 s38, s35, 123776
    buffer_load_dwordx4 v5, s[56:59], s38 offen lds
    v_lshlrev_b32 v44, 16, v36
    v_and_b32 v45, 0xffff0000, v36
    v_add_f32 v40, v40, v44
    v_fmac_f32 v42, v44, v44
    v_add_f32 v40, v40, v45
    v_fmac_f32 v42, v45, v45
    v_lshlrev_b32 v46, 16, v37
    v_and_b32 v47, 0xffff0000, v37
    v_add_f32 v41, v41, v46
    v_fmac_f32 v43, v46, v46
    v_add_f32 v41, v41, v47
    v_fmac_f32 v43, v47, v47
    v_lshlrev_b32 v44, 16, v38
    v_and_b32 v45, 0xffff0000, v38
    v_add_f32 v40, v40, v44
    v_fmac_f32 v42, v44, v44
    v_add_f32 v40, v40, v45
    v_fmac_f32 v42, v45, v45
    v_lshlrev_b32 v46, 16, v39
    v_and_b32 v47, 0xffff0000, v39
    v_add_f32 v41, v41, v46
    v_fmac_f32 v43, v46, v46
    v_add_f32 v41, v41, v47
    v_fmac_f32 v43, v47, v47
    s_add_u32 m0, s37, 147456
    s_nop 0
    buffer_load_dwordx4 v11, s[64:67], s49 offen nt lds
    s_add_u32 s49, s49, s50
    s_add_u32 m0, s37, 151552
    s_nop 0
    buffer_load_dwordx4 v11, s[64:67], s49 offen nt lds
    s_add_u32 s49, s49, s50
    s_waitcnt vmcnt(14)
    s_barrier
    ds_read_b128 v[24:27], v14 offset:32768
    ds_read_b128 v[28:31], v15 offset:32768
    ds_read_b128 v[32:35], v16 offset:32768
    ds_read_b128 v[36:39], v17 offset:32768
    s_add_u32 m0, s37, 0
    s_add_u32 s38, s35, 1024
    buffer_load_dwordx4 v5, s[56:59], s38 offen lds
    s_waitcnt lgkmcnt(0)
    v_lshlrev_b32 v44, 16, v24
    v_and_b32 v45, 0xffff0000, v24
    v_add_f32 v40, v40, v44
    v_fmac_f32 v42, v44, v44
    v_add_f32 v40, v40, v45
    v_fmac_f32 v42, v45, v45
    v_lshlrev_b32 v46, 16, v25
    v_and_b32 v47, 0xffff0000, v25
    v_add_f32 v41, v41, v46
    v_fmac_f32 v43, v46, v46
    v_add_f32 v41, v41, v47
    v_fmac_f32 v43, v47, v47
    v_lshlrev_b32 v44, 16, v26
    v_and_b32 v45, 0xffff0000, v26
    v_add_f32 v40, v40, v44
    v_fmac_f32 v42, v44, v44
    v_add_f32 v40, v40, v45
    v_fmac_f32 v42, v45, v45
    v_lshlrev_b32 v46, 16, v27
    v_and_b32 v47, 0xffff0000, v27
    v_add_f32 v41, v41, v46
    v_fmac_f32 v43, v46, v46
    v_add_f32 v41, v41, v47
    v_fmac_f32 v43, v47, v47
    s_add_u32 m0, s37, 4096
    s_add_u32 s38, s35, 41984
    buffer_load_dwordx4 v5, s[56:59], s38 offen lds
    v_lshlrev_b32 v44, 16, v28
    v_and_b32 v45, 0xffff0000, v28
    v_add_f32 v40, v40, v44
    v_fmac_f32 v42, v44, v44
    v_add_f32 v40, v40, v45
    v_fmac_f32 v42, v45, v45
    v_lshlrev_b32 v46, 16, v29
    v_and_b32 v47, 0xffff0000, v29
    v_add_f32 v41, v41, v46
    v_fmac_f32 v43, v46, v46
    v_add_f32 v41, v41, v47
    v_fmac_f32 v43, v47, v47
    v_lshlrev_b32 v44, 16, v30
    v_and_b32 v45, 0xffff0000, v30
    v_add_f32 v40, v40, v44
    v_fmac_f32 v42, v44, v44
    v_add_f32 v40, v40, v45
    v_fmac_f32 v42, v45, v45
    v_lshlrev_b32 v46, 16, v31
    v_and_b32 v47, 0xffff0000, v31
    v_add_f32 v41, v41, v46
    v_fmac_f32 v43, v46, v46
    v_add_f32 v41, v41, v47
    v_fmac_f32 v43, v47, v47
    s_add_u32 m0, s37, 8192
    s_add_u32 s38, s35, 82944
    buffer_load_dwordx4 v5, s[56:59], s38 offen lds
    v_lshlrev_b32 v44, 16, v32
    v_and_b32 v45, 0xffff0000, v32
    v_add_f32 v40, v40, v44
    v_fmac_f32 v42, v44, v44
    v_add_f32 v40, v40, v45
    v_fmac_f32 v42, v45, v45
    v_lshlrev_b32 v46, 16, v33
    v_and_b32 v47, 0xffff0000, v33
    v_add_f32 v41, v41, v46
    v_fmac_f32 v43, v46, v46
    v_add_f32 v41, v41, v47
    v_fmac_f32 v43, v47, v47
    v_lshlrev_b32 v44, 16, v34
    v_and_b32 v45, 0xffff0000, v34
    v_add_f32 v40, v40, v44
    v_fmac_f32 v42, v44, v44
    v_add_f32 v40, v40, v45
    v_fmac_f32 v42, v45, v45
    v_lshlrev_b32 v46, 16, v35
    v_and_b32 v47, 0xffff0000, v35
    v_add_f32 v41, v41, v46
    v_fmac_f32 v43, v46, v46
    v_add_f32 v41, v41, v47
    v_fmac_f32 v43, v47, v47
    s_add_u32 m0, s37, 12288
    s_add_u32 s38, s35, 123904
    buffer_load_dwordx4 v5, s[56:59], s38 offen lds
    v_lshlrev_b32 v44, 16, v36
    v_and_b32 v45, 0xffff0000, v36
    v_add_f32 v40, v40, v44
    v_fmac_f32 v42, v44, v44
    v_add_f32 v40, v40, v45
    v_fmac_f32 v42, v45, v45
    v_lshlrev_b32 v46, 16, v37
    v_and_b32 v47, 0xffff0000, v37
    v_add_f32 v41, v41, v46
    v_fmac_f32 v43, v46, v46
    v_add_f32 v41, v41, v47
    v_fmac_f32 v43, v47, v47
    v_lshlrev_b32 v44, 16, v38
    v_and_b32 v45, 0xffff0000, v38
    v_add_f32 v40, v40, v44
    v_fmac_f32 v42, v44, v44
    v_add_f32 v40, v40, v45
    v_fmac_f32 v42, v45, v45
    v_lshlrev_b32 v46, 16, v39
    v_and_b32 v47, 0xffff0000, v39
    v_add_f32 v41, v41, v46
    v_fmac_f32 v43, v46, v46
    v_add_f32 v41, v41, v47
    v_fmac_f32 v43, v47, v47
    s_waitcnt vmcnt(4)
    s_barrier
    ds_read_b128 v[24:27], v18 offset:0
    ds_read_b128 v[28:31], v19 offset:0
    ds_read_b128 v[32:35], v20 offset:0
    ds_read_b128 v[36:39], v21 offset:0
    s_add_u32 m0, s37, 32768
    s_add_u32 s38, s35, 1152
    buffer_load_dwordx4 v5, s[56:59], s38 offen lds
    s_waitcnt lgkmcnt(0)
    v_lshlrev_b32 v44, 16, v24
    v_and_b32 v45, 0xffff0000, v24
    v_add_f32 v40, v40, v44
    v_fmac_f32 v42, v44, v44
    v_add_f32 v40, v40, v45
    v_fmac_f32 v42, v45, v45
    v_lshlrev_b32 v46, 16, v25
    v_and_b32 v47, 0xffff0000, v25
    v_add_f32 v41, v41, v46
    v_fmac_f32 v43, v46, v46
    v_add_f32 v41, v41, v47
    v_fmac_f32 v43, v47, v47
    v_lshlrev_b32 v44, 16, v26
    v_and_b32 v45, 0xffff0000, v26
    v_add_f32 v40, v40, v44
    v_fmac_f32 v42, v44, v44
    v_add_f32 v40, v40, v45
    v_fmac_f32 v42, v45, v45
    v_lshlrev_b32 v46, 16, v27
    v_and_b32 v47, 0xffff0000, v27
    v_add_f32 v41, v41, v46
    v_fmac_f32 v43, v46, v46
    v_add_f32 v41, v41, v47
    v_fmac_f32 v43, v47, v47
    s_add_u32 m0, s37, 36864
    s_add_u32 s38, s35, 42112
    buffer_load_dwordx4 v5, s[56:59], s38 offen lds
    v_lshlrev_b32 v44, 16, v28
    v_and_b32 v45, 0xffff0000, v28
    v_add_f32 v40, v40, v44
    v_fmac_f32 v42, v44, v44
    v_add_f32 v40, v40, v45
    v_fmac_f32 v42, v45, v45
    v_lshlrev_b32 v46, 16, v29
    v_and_b32 v47, 0xffff0000, v29
    v_add_f32 v41, v41, v46
    v_fmac_f32 v43, v46, v46
    v_add_f32 v41, v41, v47
    v_fmac_f32 v43, v47, v47
    v_lshlrev_b32 v44, 16, v30
    v_and_b32 v45, 0xffff0000, v30
    v_add_f32 v40, v40, v44
    v_fmac_f32 v42, v44, v44
    v_add_f32 v40, v40, v45
    v_fmac_f32 v42, v45, v45
    v_lshlrev_b32 v46, 16, v31
    v_and_b32 v47, 0xffff0000, v31
    v_add_f32 v41, v41, v46
    v_fmac_f32 v43, v46, v46
    v_add_f32 v41, v41, v47
    v_fmac_f32 v43, v47, v47
    s_add_u32 m0, s37, 40960
    s_add_u32 s38, s35, 83072
    buffer_load_dwordx4 v5, s[56:59], s38 offen lds
    v_lshlrev_b32 v44, 16, v32
    v_and_b32 v45, 0xffff0000, v32
    v_add_f32 v40, v40, v44
    v_fmac_f32 v42, v44, v44
    v_add_f32 v40, v40, v45
    v_fmac_f32 v42, v45, v45
    v_lshlrev_b32 v46, 16, v33
    v_and_b32 v47, 0xffff0000, v33
    v_add_f32 v41, v41, v46
    v_fmac_f32 v43, v46, v46
    v_add_f32 v41, v41, v47
    v_fmac_f32 v43, v47, v47
    v_lshlrev_b32 v44, 16, v34
    v_and_b32 v45, 0xffff0000, v34
    v_add_f32 v40, v40, v44
    v_fmac_f32 v42, v44, v44
    v_add_f32 v40, v40, v45
    v_fmac_f32 v42, v45, v45
    v_lshlrev_b32 v46, 16, v35
    v_and_b32 v47, 0xffff0000, v35
    v_add_f32 v41, v41, v46
    v_fmac_f32 v43, v46, v46
    v_add_f32 v41, v41, v47
    v_fmac_f32 v43, v47, v47
    s_add_u32 m0, s37, 45056
    s_add_u32 s38, s35, 124032
    buffer_load_dwordx4 v5, s[56:59], s38 offen lds
    v_lshlrev_b32 v44, 16, v36
    v_and_b32 v45, 0xffff0000, v36
    v_add_f32 v40, v40, v44
    v_fmac_f32 v42, v44, v44
    v_add_f32 v40, v40, v45
    v_fmac_f32 v42, v45, v45
    v_lshlrev_b32 v46, 16, v37
    v_and_b32 v47, 0xffff0000, v37
    v_add_f32 v41, v41, v46
    v_fmac_f32 v43, v46, v46
    v_add_f32 v41, v41, v47
    v_fmac_f32 v43, v47, v47
    v_lshlrev_b32 v44, 16, v38
    v_and_b32 v45, 0xffff0000, v38
    v_add_f32 v40, v40, v44
    v_fmac_f32 v42, v44, v44
    v_add_f32 v40, v40, v45
    v_fmac_f32 v42, v45, v45
    v_lshlrev_b32 v46, 16, v39
    v_and_b32 v47, 0xffff0000, v39
    v_add_f32 v41, v41, v46
    v_fmac_f32 v43, v46, v46
    v_add_f32 v41, v41, v47
    v_fmac_f32 v43, v47, v47
    s_waitcnt vmcnt(10)
    s_barrier
    ds_read_b128 v[24:27], v18 offset:32768
    ds_read_b128 v[28:31], v19 offset:32768
    ds_read_b128 v[32:35], v20 offset:32768
    ds_read_b128 v[36:39], v21 offset:32768
    s_waitcnt lgkmcnt(0)
    v_lshlrev_b32 v44, 16, v24
    v_and_b32 v45, 0xffff0000, v24
    v_add_f32 v40, v40, v44
    v_fmac_f32 v42, v44, v44
    v_add_f32 v40, v40, v45
    v_fmac_f32 v42, v45, v45
    v_lshlrev_b32 v46, 16, v25
    v_and_b32 v47, 0xffff0000, v25
    v_add_f32 v41, v41, v46
    v_fmac_f32 v43, v46, v46
    v_add_f32 v41, v41, v47
    v_fmac_f32 v43, v47, v47
    v_lshlrev_b32 v44, 16, v26
    v_and_b32 v45, 0xffff0000, v26
    v_add_f32 v40, v40, v44
    v_fmac_f32 v42, v44, v44
    v_add_f32 v40, v40, v45
    v_fmac_f32 v42, v45, v45
    v_lshlrev_b32 v46, 16, v27
    v_and_b32 v47, 0xffff0000, v27
    v_add_f32 v41, v41, v46
    v_fmac_f32 v43, v46, v46
    v_add_f32 v41, v41, v47
    v_fmac_f32 v43, v47, v47
    v_lshlrev_b32 v44, 16, v28
    v_and_b32 v45, 0xffff0000, v28
    v_add_f32 v40, v40, v44
    v_fmac_f32 v42, v44, v44
    v_add_f32 v40, v40, v45
    v_fmac_f32 v42, v45, v45
    v_lshlrev_b32 v46, 16, v29
    v_and_b32 v47, 0xffff0000, v29
    v_add_f32 v41, v41, v46
    v_fmac_f32 v43, v46, v46
    v_add_f32 v41, v41, v47
    v_fmac_f32 v43, v47, v47
    v_lshlrev_b32 v44, 16, v30
    v_and_b32 v45, 0xffff0000, v30
    v_add_f32 v40, v40, v44
    v_fmac_f32 v42, v44, v44
    v_add_f32 v40, v40, v45
    v_fmac_f32 v42, v45, v45
    v_lshlrev_b32 v46, 16, v31
    v_and_b32 v47, 0xffff0000, v31
    v_add_f32 v41, v41, v46
    v_fmac_f32 v43, v46, v46
    v_add_f32 v41, v41, v47
    v_fmac_f32 v43, v47, v47
    v_lshlrev_b32 v44, 16, v32
    v_and_b32 v45, 0xffff0000, v32
    v_add_f32 v40, v40, v44
    v_fmac_f32 v42, v44, v44
    v_add_f32 v40, v40, v45
    v_fmac_f32 v42, v45, v45
    v_lshlrev_b32 v46, 16, v33
    v_and_b32 v47, 0xffff0000, v33
    v_add_f32 v41, v41, v46
    v_fmac_f32 v43, v46, v46
    v_add_f32 v41, v41, v47
    v_fmac_f32 v43, v47, v47
    v_lshlrev_b32 v44, 16, v34
    v_and_b32 v45, 0xffff0000, v34
    v_add_f32 v40, v40, v44
    v_fmac_f32 v42, v44, v44
    v_add_f32 v40, v40, v45
    v_fmac_f32 v42, v45, v45
    v_lshlrev_b32 v46, 16, v35
    v_and_b32 v47, 0xffff0000, v35
    v_add_f32 v41, v41, v46
    v_fmac_f32 v43, v46, v46
    v_add_f32 v41, v41, v47
    v_fmac_f32 v43, v47, v47
    v_lshlrev_b32 v44, 16, v36
    v_and_b32 v45, 0xffff0000, v36
    v_add_f32 v40, v40, v44
    v_fmac_f32 v42, v44, v44
    v_add_f32 v40, v40, v45
    v_fmac_f32 v42, v45, v45
    v_lshlrev_b32 v46, 16, v37
    v_and_b32 v47, 0xffff0000, v37
    v_add_f32 v41, v41, v46
    v_fmac_f32 v43, v46, v46
    v_add_f32 v41, v41, v47
    v_fmac_f32 v43, v47, v47
    v_lshlrev_b32 v44, 16, v38
    v_and_b32 v45, 0xffff0000, v38
    v_add_f32 v40, v40, v44
    v_fmac_f32 v42, v44, v44
    v_add_f32 v40, v40, v45
    v_fmac_f32 v42, v45, v45
    v_lshlrev_b32 v46, 16, v39
    v_and_b32 v47, 0xffff0000, v39
    v_add_f32 v41, v41, v46
    v_fmac_f32 v43, v46, v46
    v_add_f32 v41, v41, v47
    v_fmac_f32 v43, v47, v47
    s_waitcnt vmcnt(4)
    s_barrier
    ds_read_b128 v[24:27], v14 offset:0
    ds_read_b128 v[28:31], v15 offset:0
    ds_read_b128 v[32:35], v16 offset:0
    ds_read_b128 v[36:39], v17 offset:0
    s_waitcnt lgkmcnt(0)
    v_lshlrev_b32 v44, 16, v24
    v_and_b32 v45, 0xffff0000, v24
    v_add_f32 v40, v40, v44
    v_fmac_f32 v42, v44, v44
    v_add_f32 v40, v40, v45
    v_fmac_f32 v42, v45, v45
    v_lshlrev_b32 v46, 16, v25
    v_and_b32 v47, 0xffff0000, v25
    v_add_f32 v41, v41, v46
    v_fmac_f32 v43, v46, v46
    v_add_f32 v41, v41, v47
    v_fmac_f32 v43, v47, v47
    v_lshlrev_b32 v44, 16, v26
    v_and_b32 v45, 0xffff0000, v26
    v_add_f32 v40, v40, v44
    v_fmac_f32 v42, v44, v44
    v_add_f32 v40, v40, v45
    v_fmac_f32 v42, v45, v45
    v_lshlrev_b32 v46, 16, v27
    v_and_b32 v47, 0xffff0000, v27
    v_add_f32 v41, v41, v46
    v_fmac_f32 v43, v46, v46
    v_add_f32 v41, v41, v47
    v_fmac_f32 v43, v47, v47
    v_lshlrev_b32 v44, 16, v28
    v_and_b32 v45, 0xffff0000, v28
    v_add_f32 v40, v40, v44
    v_fmac_f32 v42, v44, v44
    v_add_f32 v40, v40, v45
    v_fmac_f32 v42, v45, v45
    v_lshlrev_b32 v46, 16, v29
    v_and_b32 v47, 0xffff0000, v29
    v_add_f32 v41, v41, v46
    v_fmac_f32 v43, v46, v46
    v_add_f32 v41, v41, v47
    v_fmac_f32 v43, v47, v47
    v_lshlrev_b32 v44, 16, v30
    v_and_b32 v45, 0xffff0000, v30
    v_add_f32 v40, v40, v44
    v_fmac_f32 v42, v44, v44
    v_add_f32 v40, v40, v45
    v_fmac_f32 v42, v45, v45
    v_lshlrev_b32 v46, 16, v31
    v_and_b32 v47, 0xffff0000, v31
    v_add_f32 v41, v41, v46
    v_fmac_f32 v43, v46, v46
    v_add_f32 v41, v41, v47
    v_fmac_f32 v43, v47, v47
    v_lshlrev_b32 v44, 16, v32
    v_and_b32 v45, 0xffff0000, v32
    v_add_f32 v40, v40, v44
    v_fmac_f32 v42, v44, v44
    v_add_f32 v40, v40, v45
    v_fmac_f32 v42, v45, v45
    v_lshlrev_b32 v46, 16, v33
    v_and_b32 v47, 0xffff0000, v33
    v_add_f32 v41, v41, v46
    v_fmac_f32 v43, v46, v46
    v_add_f32 v41, v41, v47
    v_fmac_f32 v43, v47, v47
    v_lshlrev_b32 v44, 16, v34
    v_and_b32 v45, 0xffff0000, v34
    v_add_f32 v40, v40, v44
    v_fmac_f32 v42, v44, v44
    v_add_f32 v40, v40, v45
    v_fmac_f32 v42, v45, v45
    v_lshlrev_b32 v46, 16, v35
    v_and_b32 v47, 0xffff0000, v35
    v_add_f32 v41, v41, v46
    v_fmac_f32 v43, v46, v46
    v_add_f32 v41, v41, v47
    v_fmac_f32 v43, v47, v47
    v_lshlrev_b32 v44, 16, v36
    v_and_b32 v45, 0xffff0000, v36
    v_add_f32 v40, v40, v44
    v_fmac_f32 v42, v44, v44
    v_add_f32 v40, v40, v45
    v_fmac_f32 v42, v45, v45
    v_lshlrev_b32 v46, 16, v37
    v_and_b32 v47, 0xffff0000, v37
    v_add_f32 v41, v41, v46
    v_fmac_f32 v43, v46, v46
    v_add_f32 v41, v41, v47
    v_fmac_f32 v43, v47, v47
    v_lshlrev_b32 v44, 16, v38
    v_and_b32 v45, 0xffff0000, v38
    v_add_f32 v40, v40, v44
    v_fmac_f32 v42, v44, v44
    v_add_f32 v40, v40, v45
    v_fmac_f32 v42, v45, v45
    v_lshlrev_b32 v46, 16, v39
    v_and_b32 v47, 0xffff0000, v39
    v_add_f32 v41, v41, v46
    v_fmac_f32 v43, v46, v46
    v_add_f32 v41, v41, v47
    v_fmac_f32 v43, v47, v47
    s_waitcnt vmcnt(0)
    s_barrier
    ds_read_b128 v[24:27], v14 offset:32768
    ds_read_b128 v[28:31], v15 offset:32768
    ds_read_b128 v[32:35], v16 offset:32768
    ds_read_b128 v[36:39], v17 offset:32768
    s_waitcnt lgkmcnt(0)
    v_lshlrev_b32 v44, 16, v24
    v_and_b32 v45, 0xffff0000, v24
    v_add_f32 v40, v40, v44
    v_fmac_f32 v42, v44, v44
    v_add_f32 v40, v40, v45
    v_fmac_f32 v42, v45, v45
    v_lshlrev_b32 v46, 16, v25
    v_and_b32 v47, 0xffff0000, v25
    v_add_f32 v41, v41, v46
    v_fmac_f32 v43, v46, v46
    v_add_f32 v41, v41, v47
    v_fmac_f32 v43, v47, v47
    v_lshlrev_b32 v44, 16, v26
    v_and_b32 v45, 0xffff0000, v26
    v_add_f32 v40, v40, v44
    v_fmac_f32 v42, v44, v44
    v_add_f32 v40, v40, v45
    v_fmac_f32 v42, v45, v45
    v_lshlrev_b32 v46, 16, v27
    v_and_b32 v47, 0xffff0000, v27
    v_add_f32 v41, v41, v46
    v_fmac_f32 v43, v46, v46
    v_add_f32 v41, v41, v47
    v_fmac_f32 v43, v47, v47
    v_lshlrev_b32 v44, 16, v28
    v_and_b32 v45, 0xffff0000, v28
    v_add_f32 v40, v40, v44
    v_fmac_f32 v42, v44, v44
    v_add_f32 v40, v40, v45
    v_fmac_f32 v42, v45, v45
    v_lshlrev_b32 v46, 16, v29
    v_and_b32 v47, 0xffff0000, v29
    v_add_f32 v41, v41, v46
    v_fmac_f32 v43, v46, v46
    v_add_f32 v41, v41, v47
    v_fmac_f32 v43, v47, v47
    v_lshlrev_b32 v44, 16, v30
    v_and_b32 v45, 0xffff0000, v30
    v_add_f32 v40, v40, v44
    v_fmac_f32 v42, v44, v44
    v_add_f32 v40, v40, v45
    v_fmac_f32 v42, v45, v45
    v_lshlrev_b32 v46, 16, v31
    v_and_b32 v47, 0xffff0000, v31
    v_add_f32 v41, v41, v46
    v_fmac_f32 v43, v46, v46
    v_add_f32 v41, v41, v47
    v_fmac_f32 v43, v47, v47
    v_lshlrev_b32 v44, 16, v32
    v_and_b32 v45, 0xffff0000, v32
    v_add_f32 v40, v40, v44
    v_fmac_f32 v42, v44, v44
    v_add_f32 v40, v40, v45
    v_fmac_f32 v42, v45, v45
    v_lshlrev_b32 v46, 16, v33
    v_and_b32 v47, 0xffff0000, v33
    v_add_f32 v41, v41, v46
    v_fmac_f32 v43, v46, v46
    v_add_f32 v41, v41, v47
    v_fmac_f32 v43, v47, v47
    v_lshlrev_b32 v44, 16, v34
    v_and_b32 v45, 0xffff0000, v34
    v_add_f32 v40, v40, v44
    v_fmac_f32 v42, v44, v44
    v_add_f32 v40, v40, v45
    v_fmac_f32 v42, v45, v45
    v_lshlrev_b32 v46, 16, v35
    v_and_b32 v47, 0xffff0000, v35
    v_add_f32 v41, v41, v46
    v_fmac_f32 v43, v46, v46
    v_add_f32 v41, v41, v47
    v_fmac_f32 v43, v47, v47
    v_lshlrev_b32 v44, 16, v36
    v_and_b32 v45, 0xffff0000, v36
    v_add_f32 v40, v40, v44
    v_fmac_f32 v42, v44, v44
    v_add_f32 v40, v40, v45
    v_fmac_f32 v42, v45, v45
    v_lshlrev_b32 v46, 16, v37
    v_and_b32 v47, 0xffff0000, v37
    v_add_f32 v41, v41, v46
    v_fmac_f32 v43, v46, v46
    v_add_f32 v41, v41, v47
    v_fmac_f32 v43, v47, v47
    v_lshlrev_b32 v44, 16, v38
    v_and_b32 v45, 0xffff0000, v38
    v_add_f32 v40, v40, v44
    v_fmac_f32 v42, v44, v44
    v_add_f32 v40, v40, v45
    v_fmac_f32 v42, v45, v45
    v_lshlrev_b32 v46, 16, v39
    v_and_b32 v47, 0xffff0000, v39
    v_add_f32 v41, v41, v46
    v_fmac_f32 v43, v46, v46
    v_add_f32 v41, v41, v47
    v_fmac_f32 v43, v47, v47
    v_add_f32 v40, v40, v41
    v_add_f32 v42, v42, v43
    v_mov_b32 v44, v40
    v_mov_b32 v45, v40
    s_nop 1
    v_permlane32_swap_b32 v44, v45
    v_add_f32 v40, v44, v45
    v_mov_b32 v44, v42
    v_mov_b32 v45, v42
    s_nop 1
    v_permlane32_swap_b32 v44, v45
    v_add_f32 v42, v44, v45
    v_mul_f32 v40, 0x3acccccd, v40
    v_mul_f32 v41, 0x3acccccd, v42
    v_fma_f32 v41, -v40, v40, v41
    v_max_f32 v41, 0, v41
    v_add_f32 v41, 0x3727c5ac, v41
    v_rsq_f32 v41, v41
    s_nop 0
    v_mul_f32 v40, v40, v41
    s_lshl_b32 s40, s23, 7
    s_add_u32 s40, s40, 155648
    v_lshlrev_b32 v7, 2, v3
    v_add_u32 v7, s40, v7
    ds_write_b32 v7, v40
    ds_write_b32 v7, v41 offset:512
    s_waitcnt lgkmcnt(0)
    s_barrier
    s_endpgm
k1_kernel_nogemm:
    s_cmp_lt_u32 s2, 40
    s_cbranch_scc0 .Lpk4
    s_mov_b32 s64, s28
    s_and_b32 s65, s29, 0xffff
    s_mov_b32 s66, 819200
    s_mov_b32 s67, 0x20000
    s_mul_hi_u32 s46, s2, 429496730
    s_mul_i32 s47, s46, 10
    s_sub_u32 s47, s2, s47
    s_movk_i32 s41, 160
    s_movk_i32 s42, 1280
    s_mov_b32 s44, 5079040
    s_movk_i32 s45, 20480
    s_branch .Lpk6
.Lpk4:
    s_cmp_lt_u32 s2, 148
    s_cbranch_scc0 .Lpk5
    s_mov_b32 s64, s30
    s_and_b32 s65, s31, 0xffff
    s_mov_b32 s66, 2211840
    s_mov_b32 s67, 0x20000
    s_sub_u32 s40, s2, 40
    s_mul_hi_u32 s46, s40, 159072863
    s_mul_i32 s47, s46, 27
    s_sub_u32 s47, s40, s47
    s_movk_i32 s41, 160
    s_movk_i32 s42, 3456
    s_mov_b32 s44, 5898240
    s_movk_i32 s45, 20480
    s_branch .Lpk6
.Lpk5:
    s_mov_b32 s64, s32
    s_and_b32 s65, s33, 0xffff
    s_mov_b32 s66, 2211840
    s_mov_b32 s67, 0x20000
    s_sub_u32 s40, s2, 148
    s_mul_hi_u32 s46, s40, 429496730
    s_mul_i32 s47, s46, 10
    s_sub_u32 s47, s40, s47
    s_movk_i32 s41, 192
    s_movk_i32 s42, 1280
    s_mov_b32 s44, 8110080
    s_mov_b32 s45, 55296
.Lpk6:
    s_mul_i32 s43, s46, s41
    s_lshr_b32 s48, s43, 3
    s_mul_i32 s43, s43, s42
    s_lshl_b32 s40, s47, 7
    s_add_u32 s43, s43, s40
    s_lshl_b32 s40, s47, 2
    s_mul_i32 s40, s40, s45
    s_add_u32 s44, s44, s40
    s_lshl_b32 s40, s48, 8
    s_add_u32 s44, s44, s40
    v_lshrrev_b32 v11, 3, v2
    s_lshl_b32 s40, s23, 3
    v_add_u32 v11, s40, v11
    v_mul_lo_u32 v11, v11, s42
    v_and_b32 v12, 7, v2
    v_lshl_add_u32 v11, v12, 4, v11
    s_cmp_lt_u32 s2, 238
    s_cselect_b32 s49, s43, 0x7ff00000
    s_lshl_b32 s50, s42, 5
    s_add_u32 m0, s37, 131072
    s_nop 0
    buffer_load_dwordx4 v11, s[64:67], s49 offen nt lds
    s_add_u32 s49, s49, s50
    s_add_u32 m0, s37, 135168
    s_nop 0
    buffer_load_dwordx4 v11, s[64:67], s49 offen nt lds
    s_add_u32 s49, s49, s50
    s_add_u32 m0, s37, 139264
    s_nop 0
    buffer_load_dwordx4 v11, s[64:67], s49 offen nt lds
    s_add_u32 s49, s49, s50
    s_add_u32 m0, s37, 143360
    s_nop 0
    buffer_load_dwordx4 v11, s[64:67], s49 offen nt lds
    s_add_u32 s49, s49, s50
    s_add_u32 m0, s37, 147456
    s_nop 0
    buffer_load_dwordx4 v11, s[64:67], s49 offen nt lds
    s_add_u32 s49, s49, s50
    s_add_u32 m0, s37, 151552
    s_nop 0
    buffer_load_dwordx4 v11, s[64:67], s49 offen nt lds
    s_add_u32 s49, s49, s50
    v_lshlrev_b32 v1, 4, v2
    s_lshl_b32 s40, s23, 10
    v_add_u32 v1, s40, v1
    v_mov_b32 v100, 0
    v_mov_b32 v101, 0
    v_mov_b32 v102, 0
    v_mov_b32 v103, 0
    s_mov_b32 s17, 30818304
    buffer_store_dwordx4 v[100:103], v1, s[8:11], s17 offen
    s_add_u32 s17, s17, 4096
    buffer_store_dwordx4 v[100:103], v1, s[8:11], s17 offen
    s_waitcnt vmcnt(0)
    s_barrier
    v_lshrrev_b32 v12, 4, v2
    v_lshrrev_b32 v13, 2, v2
    v_and_b32 v13, 3, v13
    v_lshl_add_u32 v12, v12, 3, v13
    v_lshlrev_b32 v12, 7, v12
    v_and_b32 v13, 3, v2
    v_lshl_add_u32 v12, v13, 3, v12
    s_lshl_b32 s49, s23, 5
    s_add_u32 s49, s49, 131072
    v_add_u32 v12, s49, v12
    s_mul_i32 s54, s23, s45
    s_add_u32 s54, s54, s44
    s_cmp_lt_u32 s2, 238
    s_cselect_b32 s54, s54, 0x7ff00000
    s_cmp_gt_u32 s41, 160
    s_cselect_b32 s55, s54, 0x7ff00000
    ds_read_b64_tr_b16 v[48:49], v12 offset:0
    ds_read_b64_tr_b16 v[50:51], v12 offset:512
    ds_read_b64_tr_b16 v[52:53], v12 offset:4096
    ds_read_b64_tr_b16 v[54:55], v12 offset:4608
    ds_read_b64_tr_b16 v[56:57], v12 offset:8192
    ds_read_b64_tr_b16 v[58:59], v12 offset:8704
    ds_read_b64_tr_b16 v[60:61], v12 offset:12288
    ds_read_b64_tr_b16 v[62:63], v12 offset:12800
    ds_read_b64_tr_b16 v[64:65], v12 offset:16384
    ds_read_b64_tr_b16 v[66:67], v12 offset:16896
    ds_read_b64_tr_b16 v[68:69], v12 offset:20480
    ds_read_b64_tr_b16 v[70:71], v12 offset:20992
    s_waitcnt lgkmcnt(0)
    s_add_u32 s49, s54, 0
    buffer_store_dwordx4 v[48:51], v10, s[8:11], s49 offen sc1
    s_add_u32 s49, s54, 1024
    buffer_store_dwordx4 v[52:55], v10, s[8:11], s49 offen sc1
    s_add_u32 s49, s54, 2048
    buffer_store_dwordx4 v[56:59], v10, s[8:11], s49 offen sc1
    s_add_u32 s49, s54, 3072
    buffer_store_dwordx4 v[60:63], v10, s[8:11], s49 offen sc1
    s_add_u32 s49, s54, 4096
    buffer_store_dwordx4 v[64:67], v10, s[8:11], s49 offen sc1
    s_add_u32 s49, s55, 5120
    buffer_store_dwordx4 v[68:71], v10, s[8:11], s49 offen sc1
    s_endpgm
k1_kernel_compute:
    s_cmp_ge_u32 s14, 15
    s_cbranch_scc1 k1_kernel_end
    s_and_b32 s21, s12, 1
    s_lshr_b32 s22, s12, 1
    v_lshrrev_b32 v6, 4, v2
    s_lshl_b32 s40, s23, 2
    v_add_u32 v7, s40, v6
    s_movk_i32 s40, 3840
    v_mul_lo_u32 v7, v7, s40
    v_and_b32 v8, 15, v2
    v_lshlrev_b32 v9, 2, v6
    v_xor_b32 v8, v8, v9
    v_lshl_add_u32 v6, v8, 4, v7
    s_lshl_b32 s36, s14, 8
    s_lshl_b32 s37, s23, 10
    s_waitcnt lgkmcnt(0)
    s_mov_b32 s60, s26
    s_and_b32 s61, s27, 0xffff
    s_mov_b32 s62, 2457600
    s_mov_b32 s63, 0x20000
    s_add_u32 m0, s37, 16384
    s_add_u32 s38, s36, 0
    buffer_load_dwordx4 v6, s[60:63], s38 offen lds
    s_add_u32 m0, s37, 20480
    s_add_u32 s38, s36, 61440
    buffer_load_dwordx4 v6, s[60:63], s38 offen lds
    s_add_u32 m0, s37, 24576
    s_add_u32 s38, s36, 122880
    buffer_load_dwordx4 v6, s[60:63], s38 offen lds
    s_add_u32 m0, s37, 28672
    s_add_u32 s38, s36, 184320
    buffer_load_dwordx4 v6, s[60:63], s38 offen lds
    s_add_u32 m0, s37, 49152
    s_add_u32 s38, s36, 245760
    buffer_load_dwordx4 v6, s[60:63], s38 offen lds
    s_add_u32 m0, s37, 53248
    s_add_u32 s38, s36, 307200
    buffer_load_dwordx4 v6, s[60:63], s38 offen lds
    s_add_u32 m0, s37, 57344
    s_add_u32 s38, s36, 368640
    buffer_load_dwordx4 v6, s[60:63], s38 offen lds
    s_add_u32 m0, s37, 61440
    s_add_u32 s38, s36, 430080
    buffer_load_dwordx4 v6, s[60:63], s38 offen lds
    v_lshrrev_b32 v7, 1, v3
    v_and_b32 v7, 7, v7
    s_lshl_b32 s40, s22, 13
    v_lshlrev_b32 v8, 7, v3
    v_add_u32 v8, s40, v8
    v_or_b32 v9, 0, v4
    v_xor_b32 v9, v9, v7
    v_lshl_add_u32 v14, v9, 4, v8
    v_add_u32 v18, 0x10000, v14
    v_or_b32 v9, 2, v4
    v_xor_b32 v9, v9, v7
    v_lshl_add_u32 v15, v9, 4, v8
    v_add_u32 v19, 0x10000, v15
    v_or_b32 v9, 4, v4
    v_xor_b32 v9, v9, v7
    v_lshl_add_u32 v16, v9, 4, v8
    v_add_u32 v20, 0x10000, v16
    v_or_b32 v9, 6, v4
    v_xor_b32 v9, v9, v7
    v_lshl_add_u32 v17, v9, 4, v8
    v_add_u32 v21, 0x10000, v17
    v_lshrrev_b32 v7, 2, v2
    v_and_b32 v7, 3, v7
    v_and_b32 v8, 3, v2
    v_and_b32 v9, 1, v8
    v_lshlrev_b32 v9, 1, v9
    v_lshrrev_b32 v11, 1, v8
    v_or_b32 v9, v9, v11
    s_cmp_lt_u32 s14, 10
    s_cselect_b64 vcc, -1, 0
    v_cndmask_b32 v8, v8, v9, vcc
    v_lshrrev_b32 v9, 4, v2
    v_and_b32 v9, 1, v9
    v_lshl_add_u32 v8, v9, 2, v8
    v_lshl_add_u32 v12, v4, 3, v7
    v_lshlrev_b32 v12, 8, v12
    v_and_b32 v13, 1, v8
    v_lshl_add_u32 v12, v13, 3, v12
    v_lshrrev_b32 v8, 1, v8
    v_lshlrev_b32 v11, 2, v7
    s_xor_b32 s40, s22, 0
    s_lshl_b32 s41, s21, 1
    s_add_u32 s40, s40, s41
    s_mov_b32 s50, s40
    s_lshl_b32 s40, s40, 2
    v_add_u32 v9, s40, v8
    v_xor_b32 v9, v9, v11
    v_lshl_add_u32 v22, v9, 4, v12
    v_add_u32 v22, 16384, v22
    v_add_u32 v23, 0x10000, v22
    s_xor_b32 s40, s22, 1
    s_lshl_b32 s41, s21, 1
    s_add_u32 s40, s40, s41
    s_mov_b32 s51, s40
    s_lshl_b32 s40, s40, 2
    v_add_u32 v9, s40, v8
    v_xor_b32 v9, v9, v11
    v_lshl_add_u32 v24, v9, 4, v12
    v_add_u32 v24, 16384, v24
    v_add_u32 v25, 0x10000, v24
    v_mov_b32 v28, 0
    s_mov_b32 s52, 0x00020001
    s_mov_b32 s53, 0x00020001
    v_mov_b32 v7, 0x3f803f80
    v_cndmask_b32 v28, v28, v7, s[52:53]
    v_mov_b32 v29, v28
    v_mov_b32 v30, v28
    v_mov_b32 v31, v28
    v_mov_b32 v32, 0
    v_mov_b32 v33, 0
    v_mov_b32 v34, 0
    v_mov_b32 v35, 0
    s_waitcnt lgkmcnt(0)
    s_mov_b32 s8, s4
    s_and_b32 s9, s5, 0xffff
    s_mov_b32 s10, 31932416
    s_mov_b32 s11, 0x20000
    s_mov_b32 s56, s50
    s_mov_b32 s57, s51
    s_cmp_lt_u32 s2, 40
    s_cbranch_scc0 .Lpk7
    s_mov_b32 s64, s28
    s_and_b32 s65, s29, 0xffff
    s_mov_b32 s66, 819200
    s_mov_b32 s67, 0x20000
    s_mul_hi_u32 s46, s2, 429496730
    s_mul_i32 s47, s46, 10
    s_sub_u32 s47, s2, s47
    s_movk_i32 s41, 160
    s_movk_i32 s42, 1280
    s_mov_b32 s44, 5079040
    s_movk_i32 s45, 20480
    s_branch .Lpk9
.Lpk7:
    s_cmp_lt_u32 s2, 148
    s_cbranch_scc0 .Lpk8
    s_mov_b32 s64, s30
    s_and_b32 s65, s31, 0xffff
    s_mov_b32 s66, 2211840
    s_mov_b32 s67, 0x20000
    s_sub_u32 s40, s2, 40
    s_mul_hi_u32 s46, s40, 159072863
    s_mul_i32 s47, s46, 27
    s_sub_u32 s47, s40, s47
    s_movk_i32 s41, 160
    s_movk_i32 s42, 3456
    s_mov_b32 s44, 5898240
    s_movk_i32 s45, 20480
    s_branch .Lpk9
.Lpk8:
    s_mov_b32 s64, s32
    s_and_b32 s65, s33, 0xffff
    s_mov_b32 s66, 2211840
    s_mov_b32 s67, 0x20000
    s_sub_u32 s40, s2, 148
    s_mul_hi_u32 s46, s40, 429496730
    s_mul_i32 s47, s46, 10
    s_sub_u32 s47, s40, s47
    s_movk_i32 s41, 192
    s_movk_i32 s42, 1280
    s_mov_b32 s44, 8110080
    s_mov_b32 s45, 55296
.Lpk9:
    s_mul_i32 s43, s46, s41
    s_lshr_b32 s48, s43, 3
    s_mul_i32 s43, s43, s42
    s_lshl_b32 s40, s47, 7
    s_add_u32 s43, s43, s40
    s_lshl_b32 s40, s47, 2
    s_mul_i32 s40, s40, s45
    s_add_u32 s44, s44, s40
    s_lshl_b32 s40, s48, 8
    s_add_u32 s44, s44, s40
    v_lshrrev_b32 v12, 4, v2
    v_lshrrev_b32 v13, 2, v2
    v_and_b32 v13, 3, v13
    v_lshl_add_u32 v12, v12, 3, v13
    v_lshlrev_b32 v12, 7, v12
    v_and_b32 v13, 3, v2
    v_lshl_add_u32 v12, v13, 3, v12
    s_lshl_b32 s49, s23, 5
    s_add_u32 s49, s49, 131072
    v_add_u32 v12, s49, v12
    s_mul_i32 s54, s23, s45
    s_add_u32 s54, s54, s44
    s_cmp_lt_u32 s2, 238
    s_cselect_b32 s54, s54, 0x7ff00000
    s_cmp_gt_u32 s41, 160
    s_cselect_b32 s55, s54, 0x7ff00000
    v_mov_b32 v152, 0
    v_mov_b32 v156, 0x3f803f80
    v_mov_b32 v153, 0
    v_mov_b32 v157, 0x3f803f80
    v_mov_b32 v154, 0
    v_mov_b32 v158, 0x3f803f80
    v_mov_b32 v155, 0
    v_mov_b32 v159, 0x3f803f80
    s_cmp_ge_u32 s14, 10
    s_cbranch_scc1 k1_kernel_v
    s_waitcnt vmcnt(4)
    s_barrier
    ds_read_b64_tr_b16 v[104:105], v22 offset:0
    ds_read_b64_tr_b16 v[106:107], v22 offset:1024
    ds_read_b64_tr_b16 v[108:109], v24 offset:0
    ds_read_b64_tr_b16 v[110:111], v24 offset:1024
    ds_read_b128 v[120:123], v14 offset:0
    ds_read_b128 v[124:127], v14 offset:4096
    ds_read_b64_tr_b16 v[112:113], v22 offset:4096
    ds_read_b64_tr_b16 v[114:115], v22 offset:5120
    ds_read_b64_tr_b16 v[116:117], v24 offset:4096
    ds_read_b64_tr_b16 v[118:119], v24 offset:5120
    ds_read_b128 v[128:131], v15 offset:0
    ds_read_b128 v[132:135], v15 offset:4096
    s_waitcnt lgkmcnt(6)
    v_mfma_f32_32x32x16_bf16 v[40:55], v[104:107], v[120:123], 0
    v_mfma_f32_32x32x16_bf16 v[56:71], v[104:107], v[124:127], 0
    v_mfma_f32_32x32x16_bf16 v[72:87], v[108:111], v[120:123], 0
    v_mfma_f32_32x32x16_bf16 v[88:103], v[108:111], v[124:127], 0
    v_mfma_f32_16x16x32_bf16 v[32:35], v[104:107], v[28:31], v[32:35]
    s_add_u32 m0, s37, 81920
    s_add_u32 s38, s36, 491520
    buffer_load_dwordx4 v6, s[60:63], s38 offen lds
    s_add_u32 m0, s37, 86016
    s_add_u32 s38, s36, 552960
    buffer_load_dwordx4 v6, s[60:63], s38 offen lds
    ds_read_b64_tr_b16 v[104:105], v22 offset:8192
    ds_read_b64_tr_b16 v[106:107], v22 offset:9216
    ds_read_b64_tr_b16 v[108:109], v24 offset:8192
    ds_read_b64_tr_b16 v[110:111], v24 offset:9216
    ds_read_b128 v[120:123], v16 offset:0
    ds_read_b128 v[124:127], v16 offset:4096
    s_waitcnt lgkmcnt(6)
    v_mfma_f32_32x32x16_bf16 v[40:55], v[112:115], v[128:131], v[40:55]
    v_mfma_f32_32x32x16_bf16 v[56:71], v[112:115], v[132:135], v[56:71]
    v_mfma_f32_32x32x16_bf16 v[72:87], v[116:119], v[128:131], v[72:87]
    v_mfma_f32_32x32x16_bf16 v[88:103], v[116:119], v[132:135], v[88:103]
    v_mfma_f32_16x16x32_bf16 v[32:35], v[112:115], v[28:31], v[32:35]
    s_add_u32 m0, s37, 90112
    s_add_u32 s38, s36, 614400
    buffer_load_dwordx4 v6, s[60:63], s38 offen lds
    s_add_u32 m0, s37, 94208
    s_add_u32 s38, s36, 675840
    buffer_load_dwordx4 v6, s[60:63], s38 offen lds
    ds_read_b64_tr_b16 v[112:113], v22 offset:12288
    ds_read_b64_tr_b16 v[114:115], v22 offset:13312
    ds_read_b64_tr_b16 v[116:117], v24 offset:12288
    ds_read_b64_tr_b16 v[118:119], v24 offset:13312
    ds_read_b128 v[128:131], v17 offset:0
    ds_read_b128 v[132:135], v17 offset:4096
    s_waitcnt lgkmcnt(6)
    v_mfma_f32_32x32x16_bf16 v[40:55], v[104:107], v[120:123], v[40:55]
    v_mfma_f32_32x32x16_bf16 v[56:71], v[104:107], v[124:127], v[56:71]
    v_mfma_f32_32x32x16_bf16 v[72:87], v[108:111], v[120:123], v[72:87]
    v_mfma_f32_32x32x16_bf16 v[88:103], v[108:111], v[124:127], v[88:103]
    v_mfma_f32_16x16x32_bf16 v[32:35], v[104:107], v[28:31], v[32:35]
    s_add_u32 m0, s37, 114688
    s_add_u32 s38, s36, 737280
    buffer_load_dwordx4 v6, s[60:63], s38 offen lds
    s_add_u32 m0, s37, 118784
    s_add_u32 s38, s36, 798720
    buffer_load_dwordx4 v6, s[60:63], s38 offen lds
    s_waitcnt lgkmcnt(0)
    s_waitcnt vmcnt(6)
    s_barrier
    ds_read_b64_tr_b16 v[104:105], v22 offset:32768
    ds_read_b64_tr_b16 v[106:107], v22 offset:33792
    ds_read_b64_tr_b16 v[108:109], v24 offset:32768
    ds_read_b64_tr_b16 v[110:111], v24 offset:33792
    ds_read_b128 v[120:123], v14 offset:32768
    ds_read_b128 v[124:127], v14 offset:36864
    v_mfma_f32_32x32x16_bf16 v[40:55], v[112:115], v[128:131], v[40:55]
    v_mfma_f32_32x32x16_bf16 v[56:71], v[112:115], v[132:135], v[56:71]
    v_mfma_f32_32x32x16_bf16 v[72:87], v[116:119], v[128:131], v[72:87]
    v_mfma_f32_32x32x16_bf16 v[88:103], v[116:119], v[132:135], v[88:103]
    v_mfma_f32_16x16x32_bf16 v[32:35], v[112:115], v[28:31], v[32:35]
    s_add_u32 m0, s37, 122880
    s_add_u32 s38, s36, 860160
    buffer_load_dwordx4 v6, s[60:63], s38 offen lds
    s_add_u32 m0, s37, 126976
    s_add_u32 s38, s36, 921600
    buffer_load_dwordx4 v6, s[60:63], s38 offen lds
    ds_read_b64_tr_b16 v[112:113], v22 offset:36864
    ds_read_b64_tr_b16 v[114:115], v22 offset:37888
    ds_read_b64_tr_b16 v[116:117], v24 offset:36864
    ds_read_b64_tr_b16 v[118:119], v24 offset:37888
    ds_read_b128 v[128:131], v15 offset:32768
    ds_read_b128 v[132:135], v15 offset:36864
    s_waitcnt lgkmcnt(6)
    v_mfma_f32_32x32x16_bf16 v[40:55], v[104:107], v[120:123], v[40:55]
    v_mfma_f32_32x32x16_bf16 v[56:71], v[104:107], v[124:127], v[56:71]
    v_mfma_f32_32x32x16_bf16 v[72:87], v[108:111], v[120:123], v[72:87]
    v_mfma_f32_32x32x16_bf16 v[88:103], v[108:111], v[124:127], v[88:103]
    v_mfma_f32_16x16x32_bf16 v[32:35], v[104:107], v[28:31], v[32:35]
    s_add_u32 m0, s37, 16384
    s_add_u32 s38, s36, 983040
    buffer_load_dwordx4 v6, s[60:63], s38 offen lds
    ds_read_b64_tr_b16 v[104:105], v22 offset:40960
    ds_read_b64_tr_b16 v[106:107], v22 offset:41984
    ds_read_b64_tr_b16 v[108:109], v24 offset:40960
    ds_read_b64_tr_b16 v[110:111], v24 offset:41984
    ds_read_b128 v[120:123], v16 offset:32768
    ds_read_b128 v[124:127], v16 offset:36864
    s_waitcnt lgkmcnt(6)
    v_mfma_f32_32x32x16_bf16 v[40:55], v[112:115], v[128:131], v[40:55]
    v_mfma_f32_32x32x16_bf16 v[56:71], v[112:115], v[132:135], v[56:71]
    v_mfma_f32_32x32x16_bf16 v[72:87], v[116:119], v[128:131], v[72:87]
    v_mfma_f32_32x32x16_bf16 v[88:103], v[116:119], v[132:135], v[88:103]
    v_mfma_f32_16x16x32_bf16 v[32:35], v[112:115], v[28:31], v[32:35]
    s_add_u32 m0, s37, 20480
    s_add_u32 s38, s36, 1044480
    buffer_load_dwordx4 v6, s[60:63], s38 offen lds
    ds_read_b64_tr_b16 v[112:113], v22 offset:45056
    ds_read_b64_tr_b16 v[114:115], v22 offset:46080
    ds_read_b64_tr_b16 v[116:117], v24 offset:45056
    ds_read_b64_tr_b16 v[118:119], v24 offset:46080
    ds_read_b128 v[128:131], v17 offset:32768
    ds_read_b128 v[132:135], v17 offset:36864
    s_waitcnt lgkmcnt(6)
    v_mfma_f32_32x32x16_bf16 v[40:55], v[104:107], v[120:123], v[40:55]
    v_mfma_f32_32x32x16_bf16 v[56:71], v[104:107], v[124:127], v[56:71]
    v_mfma_f32_32x32x16_bf16 v[72:87], v[108:111], v[120:123], v[72:87]
    v_mfma_f32_32x32x16_bf16 v[88:103], v[108:111], v[124:127], v[88:103]
    v_mfma_f32_16x16x32_bf16 v[32:35], v[104:107], v[28:31], v[32:35]
    s_add_u32 m0, s37, 24576
    s_add_u32 s38, s36, 1105920
    buffer_load_dwordx4 v6, s[60:63], s38 offen lds
    s_waitcnt lgkmcnt(0)
    s_waitcnt vmcnt(7)
    s_barrier
    ds_read_b64_tr_b16 v[104:105], v23 offset:0
    ds_read_b64_tr_b16 v[106:107], v23 offset:1024
    ds_read_b64_tr_b16 v[108:109], v25 offset:0
    ds_read_b64_tr_b16 v[110:111], v25 offset:1024
    ds_read_b128 v[120:123], v18 offset:0
    ds_read_b128 v[124:127], v18 offset:4096
    v_mfma_f32_32x32x16_bf16 v[40:55], v[112:115], v[128:131], v[40:55]
    v_mfma_f32_32x32x16_bf16 v[56:71], v[112:115], v[132:135], v[56:71]
    v_mfma_f32_32x32x16_bf16 v[72:87], v[116:119], v[128:131], v[72:87]
    v_mfma_f32_32x32x16_bf16 v[88:103], v[116:119], v[132:135], v[88:103]
    v_mfma_f32_16x16x32_bf16 v[32:35], v[112:115], v[28:31], v[32:35]
    s_add_u32 m0, s37, 28672
    s_add_u32 s38, s36, 1167360
    buffer_load_dwordx4 v6, s[60:63], s38 offen lds
    ds_read_b64_tr_b16 v[112:113], v23 offset:4096
    ds_read_b64_tr_b16 v[114:115], v23 offset:5120
    ds_read_b64_tr_b16 v[116:117], v25 offset:4096
    ds_read_b64_tr_b16 v[118:119], v25 offset:5120
    ds_read_b128 v[128:131], v19 offset:0
    ds_read_b128 v[132:135], v19 offset:4096
    s_waitcnt lgkmcnt(6)
    v_mfma_f32_32x32x16_bf16 v[40:55], v[104:107], v[120:123], v[40:55]
    v_mfma_f32_32x32x16_bf16 v[56:71], v[104:107], v[124:127], v[56:71]
    v_mfma_f32_32x32x16_bf16 v[72:87], v[108:111], v[120:123], v[72:87]
    v_mfma_f32_32x32x16_bf16 v[88:103], v[108:111], v[124:127], v[88:103]
    v_mfma_f32_16x16x32_bf16 v[32:35], v[104:107], v[28:31], v[32:35]
    s_add_u32 m0, s37, 49152
    s_add_u32 s38, s36, 1228800
    buffer_load_dwordx4 v6, s[60:63], s38 offen lds
    ds_read_b64_tr_b16 v[104:105], v23 offset:8192
    ds_read_b64_tr_b16 v[106:107], v23 offset:9216
    ds_read_b64_tr_b16 v[108:109], v25 offset:8192
    ds_read_b64_tr_b16 v[110:111], v25 offset:9216
    ds_read_b128 v[120:123], v20 offset:0
    ds_read_b128 v[124:127], v20 offset:4096
    s_waitcnt lgkmcnt(6)
    v_mfma_f32_32x32x16_bf16 v[40:55], v[112:115], v[128:131], v[40:55]
    v_mfma_f32_32x32x16_bf16 v[56:71], v[112:115], v[132:135], v[56:71]
    v_mfma_f32_32x32x16_bf16 v[72:87], v[116:119], v[128:131], v[72:87]
    v_mfma_f32_32x32x16_bf16 v[88:103], v[116:119], v[132:135], v[88:103]
    v_mfma_f32_16x16x32_bf16 v[32:35], v[112:115], v[28:31], v[32:35]
    s_add_u32 m0, s37, 53248
    s_add_u32 s38, s36, 1290240
    buffer_load_dwordx4 v6, s[60:63], s38 offen lds
    ds_read_b64_tr_b16 v[112:113], v23 offset:12288
    ds_read_b64_tr_b16 v[114:115], v23 offset:13312
    ds_read_b64_tr_b16 v[116:117], v25 offset:12288
    ds_read_b64_tr_b16 v[118:119], v25 offset:13312
    ds_read_b128 v[128:131], v21 offset:0
    ds_read_b128 v[132:135], v21 offset:4096
    s_waitcnt lgkmcnt(6)
    v_mfma_f32_32x32x16_bf16 v[40:55], v[104:107], v[120:123], v[40:55]
    v_mfma_f32_32x32x16_bf16 v[56:71], v[104:107], v[124:127], v[56:71]
    v_mfma_f32_32x32x16_bf16 v[72:87], v[108:111], v[120:123], v[72:87]
    v_mfma_f32_32x32x16_bf16 v[88:103], v[108:111], v[124:127], v[88:103]
    v_mfma_f32_16x16x32_bf16 v[32:35], v[104:107], v[28:31], v[32:35]
    s_add_u32 m0, s37, 57344
    s_add_u32 s38, s36, 1351680
    buffer_load_dwordx4 v6, s[60:63], s38 offen lds
    s_waitcnt lgkmcnt(0)
    s_waitcnt vmcnt(7)
    s_barrier
    ds_read_b64_tr_b16 v[104:105], v23 offset:32768
    ds_read_b64_tr_b16 v[106:107], v23 offset:33792
    ds_read_b64_tr_b16 v[108:109], v25 offset:32768
    ds_read_b64_tr_b16 v[110:111], v25 offset:33792
    ds_read_b128 v[120:123], v18 offset:32768
    ds_read_b128 v[124:127], v18 offset:36864
    v_mfma_f32_32x32x16_bf16 v[40:55], v[112:115], v[128:131], v[40:55]
    v_mfma_f32_32x32x16_bf16 v[56:71], v[112:115], v[132:135], v[56:71]
    v_mfma_f32_32x32x16_bf16 v[72:87], v[116:119], v[128:131], v[72:87]
    v_mfma_f32_32x32x16_bf16 v[88:103], v[116:119], v[132:135], v[88:103]
    v_mfma_f32_16x16x32_bf16 v[32:35], v[112:115], v[28:31], v[32:35]
    s_add_u32 m0, s37, 61440
    s_add_u32 s38, s36, 1413120
    buffer_load_dwordx4 v6, s[60:63], s38 offen lds
    ds_read_b64_tr_b16 v[112:113], v23 offset:36864
    ds_read_b64_tr_b16 v[114:115], v23 offset:37888
    ds_read_b64_tr_b16 v[116:117], v25 offset:36864
    ds_read_b64_tr_b16 v[118:119], v25 offset:37888
    ds_read_b128 v[128:131], v19 offset:32768
    ds_read_b128 v[132:135], v19 offset:36864
    s_waitcnt lgkmcnt(6)
    v_mfma_f32_32x32x16_bf16 v[40:55], v[104:107], v[120:123], v[40:55]
    v_mfma_f32_32x32x16_bf16 v[56:71], v[104:107], v[124:127], v[56:71]
    v_mfma_f32_32x32x16_bf16 v[72:87], v[108:111], v[120:123], v[72:87]
    v_mfma_f32_32x32x16_bf16 v[88:103], v[108:111], v[124:127], v[88:103]
    v_mfma_f32_16x16x32_bf16 v[32:35], v[104:107], v[28:31], v[32:35]
    s_add_u32 m0, s37, 81920
    s_add_u32 s38, s36, 1474560
    buffer_load_dwordx4 v6, s[60:63], s38 offen lds
    ds_read_b64_tr_b16 v[104:105], v23 offset:40960
    ds_read_b64_tr_b16 v[106:107], v23 offset:41984
    ds_read_b64_tr_b16 v[108:109], v25 offset:40960
    ds_read_b64_tr_b16 v[110:111], v25 offset:41984
    ds_read_b128 v[120:123], v20 offset:32768
    ds_read_b128 v[124:127], v20 offset:36864
    s_waitcnt lgkmcnt(6)
    v_mfma_f32_32x32x16_bf16 v[40:55], v[112:115], v[128:131], v[40:55]
    v_mfma_f32_32x32x16_bf16 v[56:71], v[112:115], v[132:135], v[56:71]
    v_mfma_f32_32x32x16_bf16 v[72:87], v[116:119], v[128:131], v[72:87]
    v_mfma_f32_32x32x16_bf16 v[88:103], v[116:119], v[132:135], v[88:103]
    v_mfma_f32_16x16x32_bf16 v[32:35], v[112:115], v[28:31], v[32:35]
    s_add_u32 m0, s37, 86016
    s_add_u32 s38, s36, 1536000
    buffer_load_dwordx4 v6, s[60:63], s38 offen lds
    ds_read_b64_tr_b16 v[112:113], v23 offset:45056
    ds_read_b64_tr_b16 v[114:115], v23 offset:46080
    ds_read_b64_tr_b16 v[116:117], v25 offset:45056
    ds_read_b64_tr_b16 v[118:119], v25 offset:46080
    ds_read_b128 v[128:131], v21 offset:32768
    ds_read_b128 v[132:135], v21 offset:36864
    s_waitcnt lgkmcnt(6)
    v_mfma_f32_32x32x16_bf16 v[40:55], v[104:107], v[120:123], v[40:55]
    v_mfma_f32_32x32x16_bf16 v[56:71], v[104:107], v[124:127], v[56:71]
    v_mfma_f32_32x32x16_bf16 v[72:87], v[108:111], v[120:123], v[72:87]
    v_mfma_f32_32x32x16_bf16 v[88:103], v[108:111], v[124:127], v[88:103]
    v_mfma_f32_16x16x32_bf16 v[32:35], v[104:107], v[28:31], v[32:35]
    s_add_u32 m0, s37, 90112
    s_add_u32 s38, s36, 1597440
    buffer_load_dwordx4 v6, s[60:63], s38 offen lds
    s_waitcnt lgkmcnt(0)
    s_waitcnt vmcnt(7)
    s_barrier
    ds_read_b64_tr_b16 v[104:105], v22 offset:0
    ds_read_b64_tr_b16 v[106:107], v22 offset:1024
    ds_read_b64_tr_b16 v[108:109], v24 offset:0
    ds_read_b64_tr_b16 v[110:111], v24 offset:1024
    ds_read_b128 v[120:123], v14 offset:0
    ds_read_b128 v[124:127], v14 offset:4096
    v_mfma_f32_32x32x16_bf16 v[40:55], v[112:115], v[128:131], v[40:55]
    v_mfma_f32_32x32x16_bf16 v[56:71], v[112:115], v[132:135], v[56:71]
    v_mfma_f32_32x32x16_bf16 v[72:87], v[116:119], v[128:131], v[72:87]
    v_mfma_f32_32x32x16_bf16 v[88:103], v[116:119], v[132:135], v[88:103]
    v_mfma_f32_16x16x32_bf16 v[32:35], v[112:115], v[28:31], v[32:35]
    s_add_u32 m0, s37, 94208
    s_add_u32 s38, s36, 1658880
    buffer_load_dwordx4 v6, s[60:63], s38 offen lds
    ds_read_b64_tr_b16 v[112:113], v22 offset:4096
    ds_read_b64_tr_b16 v[114:115], v22 offset:5120
    ds_read_b64_tr_b16 v[116:117], v24 offset:4096
    ds_read_b64_tr_b16 v[118:119], v24 offset:5120
    ds_read_b128 v[128:131], v15 offset:0
    ds_read_b128 v[132:135], v15 offset:4096
    s_waitcnt lgkmcnt(6)
    v_mfma_f32_32x32x16_bf16 v[40:55], v[104:107], v[120:123], v[40:55]
    v_mfma_f32_32x32x16_bf16 v[56:71], v[104:107], v[124:127], v[56:71]
    v_mfma_f32_32x32x16_bf16 v[72:87], v[108:111], v[120:123], v[72:87]
    v_mfma_f32_32x32x16_bf16 v[88:103], v[108:111], v[124:127], v[88:103]
    v_mfma_f32_16x16x32_bf16 v[32:35], v[104:107], v[28:31], v[32:35]
    s_add_u32 m0, s37, 114688
    s_add_u32 s38, s36, 1720320
    buffer_load_dwordx4 v6, s[60:63], s38 offen lds
    ds_read_b64_tr_b16 v[104:105], v22 offset:8192
    ds_read_b64_tr_b16 v[106:107], v22 offset:9216
    ds_read_b64_tr_b16 v[108:109], v24 offset:8192
    ds_read_b64_tr_b16 v[110:111], v24 offset:9216
    ds_read_b128 v[120:123], v16 offset:0
    ds_read_b128 v[124:127], v16 offset:4096
    s_waitcnt lgkmcnt(6)
    v_mfma_f32_32x32x16_bf16 v[40:55], v[112:115], v[128:131], v[40:55]
    v_mfma_f32_32x32x16_bf16 v[56:71], v[112:115], v[132:135], v[56:71]
    v_mfma_f32_32x32x16_bf16 v[72:87], v[116:119], v[128:131], v[72:87]
    v_mfma_f32_32x32x16_bf16 v[88:103], v[116:119], v[132:135], v[88:103]
    v_mfma_f32_16x16x32_bf16 v[32:35], v[112:115], v[28:31], v[32:35]
    s_add_u32 m0, s37, 118784
    s_add_u32 s38, s36, 1781760
    buffer_load_dwordx4 v6, s[60:63], s38 offen lds
    ds_read_b64_tr_b16 v[112:113], v22 offset:12288
    ds_read_b64_tr_b16 v[114:115], v22 offset:13312
    ds_read_b64_tr_b16 v[116:117], v24 offset:12288
    ds_read_b64_tr_b16 v[118:119], v24 offset:13312
    ds_read_b128 v[128:131], v17 offset:0
    ds_read_b128 v[132:135], v17 offset:4096
    s_waitcnt lgkmcnt(6)
    v_mfma_f32_32x32x16_bf16 v[40:55], v[104:107], v[120:123], v[40:55]
    v_mfma_f32_32x32x16_bf16 v[56:71], v[104:107], v[124:127], v[56:71]
    v_mfma_f32_32x32x16_bf16 v[72:87], v[108:111], v[120:123], v[72:87]
    v_mfma_f32_32x32x16_bf16 v[88:103], v[108:111], v[124:127], v[88:103]
    v_mfma_f32_16x16x32_bf16 v[32:35], v[104:107], v[28:31], v[32:35]
    s_add_u32 m0, s37, 122880
    s_add_u32 s38, s36, 1843200
    buffer_load_dwordx4 v6, s[60:63], s38 offen lds
    s_waitcnt lgkmcnt(0)
    s_waitcnt vmcnt(7)
    s_barrier
    ds_read_b64_tr_b16 v[104:105], v22 offset:32768
    ds_read_b64_tr_b16 v[106:107], v22 offset:33792
    ds_read_b64_tr_b16 v[108:109], v24 offset:32768
    ds_read_b64_tr_b16 v[110:111], v24 offset:33792
    ds_read_b128 v[120:123], v14 offset:32768
    ds_read_b128 v[124:127], v14 offset:36864
    v_mfma_f32_32x32x16_bf16 v[40:55], v[112:115], v[128:131], v[40:55]
    v_mfma_f32_32x32x16_bf16 v[56:71], v[112:115], v[132:135], v[56:71]
    v_mfma_f32_32x32x16_bf16 v[72:87], v[116:119], v[128:131], v[72:87]
    v_mfma_f32_32x32x16_bf16 v[88:103], v[116:119], v[132:135], v[88:103]
    v_mfma_f32_16x16x32_bf16 v[32:35], v[112:115], v[28:31], v[32:35]
    s_add_u32 m0, s37, 126976
    s_add_u32 s38, s36, 1904640
    buffer_load_dwordx4 v6, s[60:63], s38 offen lds
    ds_read_b64_tr_b16 v[112:113], v22 offset:36864
    ds_read_b64_tr_b16 v[114:115], v22 offset:37888
    ds_read_b64_tr_b16 v[116:117], v24 offset:36864
    ds_read_b64_tr_b16 v[118:119], v24 offset:37888
    ds_read_b128 v[128:131], v15 offset:32768
    ds_read_b128 v[132:135], v15 offset:36864
    s_waitcnt lgkmcnt(6)
    v_mfma_f32_32x32x16_bf16 v[40:55], v[104:107], v[120:123], v[40:55]
    v_mfma_f32_32x32x16_bf16 v[56:71], v[104:107], v[124:127], v[56:71]
    v_mfma_f32_32x32x16_bf16 v[72:87], v[108:111], v[120:123], v[72:87]
    v_mfma_f32_32x32x16_bf16 v[88:103], v[108:111], v[124:127], v[88:103]
    v_mfma_f32_16x16x32_bf16 v[32:35], v[104:107], v[28:31], v[32:35]
    s_add_u32 m0, s37, 16384
    s_add_u32 s38, s36, 1966080
    buffer_load_dwordx4 v6, s[60:63], s38 offen lds
    ds_read_b64_tr_b16 v[104:105], v22 offset:40960
    ds_read_b64_tr_b16 v[106:107], v22 offset:41984
    ds_read_b64_tr_b16 v[108:109], v24 offset:40960
    ds_read_b64_tr_b16 v[110:111], v24 offset:41984
    ds_read_b128 v[120:123], v16 offset:32768
    ds_read_b128 v[124:127], v16 offset:36864
    s_waitcnt lgkmcnt(6)
    v_mfma_f32_32x32x16_bf16 v[40:55], v[112:115], v[128:131], v[40:55]
    v_mfma_f32_32x32x16_bf16 v[56:71], v[112:115], v[132:135], v[56:71]
    v_mfma_f32_32x32x16_bf16 v[72:87], v[116:119], v[128:131], v[72:87]
    v_mfma_f32_32x32x16_bf16 v[88:103], v[116:119], v[132:135], v[88:103]
    v_mfma_f32_16x16x32_bf16 v[32:35], v[112:115], v[28:31], v[32:35]
    s_add_u32 m0, s37, 20480
    s_add_u32 s38, s36, 2027520
    buffer_load_dwordx4 v6, s[60:63], s38 offen lds
    ds_read_b64_tr_b16 v[112:113], v22 offset:45056
    ds_read_b64_tr_b16 v[114:115], v22 offset:46080
    ds_read_b64_tr_b16 v[116:117], v24 offset:45056
    ds_read_b64_tr_b16 v[118:119], v24 offset:46080
    ds_read_b128 v[128:131], v17 offset:32768
    ds_read_b128 v[132:135], v17 offset:36864
    s_waitcnt lgkmcnt(6)
    v_mfma_f32_32x32x16_bf16 v[40:55], v[104:107], v[120:123], v[40:55]
    v_mfma_f32_32x32x16_bf16 v[56:71], v[104:107], v[124:127], v[56:71]
    v_mfma_f32_32x32x16_bf16 v[72:87], v[108:111], v[120:123], v[72:87]
    v_mfma_f32_32x32x16_bf16 v[88:103], v[108:111], v[124:127], v[88:103]
    v_mfma_f32_16x16x32_bf16 v[32:35], v[104:107], v[28:31], v[32:35]
    s_add_u32 m0, s37, 24576
    s_add_u32 s38, s36, 2088960
    buffer_load_dwordx4 v6, s[60:63], s38 offen lds
    s_waitcnt lgkmcnt(0)
    s_waitcnt vmcnt(7)
    s_barrier
    ds_read_b64_tr_b16 v[104:105], v23 offset:0
    ds_read_b64_tr_b16 v[106:107], v23 offset:1024
    ds_read_b64_tr_b16 v[108:109], v25 offset:0
    ds_read_b64_tr_b16 v[110:111], v25 offset:1024
    ds_read_b128 v[120:123], v18 offset:0
    ds_read_b128 v[124:127], v18 offset:4096
    v_mfma_f32_32x32x16_bf16 v[40:55], v[112:115], v[128:131], v[40:55]
    v_mfma_f32_32x32x16_bf16 v[56:71], v[112:115], v[132:135], v[56:71]
    v_mfma_f32_32x32x16_bf16 v[72:87], v[116:119], v[128:131], v[72:87]
    v_mfma_f32_32x32x16_bf16 v[88:103], v[116:119], v[132:135], v[88:103]
    v_mfma_f32_16x16x32_bf16 v[32:35], v[112:115], v[28:31], v[32:35]
    s_add_u32 m0, s37, 28672
    s_add_u32 s38, s36, 2150400
    buffer_load_dwordx4 v6, s[60:63], s38 offen lds
    ds_read_b64_tr_b16 v[112:113], v23 offset:4096
    ds_read_b64_tr_b16 v[114:115], v23 offset:5120
    ds_read_b64_tr_b16 v[116:117], v25 offset:4096
    ds_read_b64_tr_b16 v[118:119], v25 offset:5120
    ds_read_b128 v[128:131], v19 offset:0
    ds_read_b128 v[132:135], v19 offset:4096
    s_waitcnt lgkmcnt(6)
    v_mfma_f32_32x32x16_bf16 v[40:55], v[104:107], v[120:123], v[40:55]
    v_mfma_f32_32x32x16_bf16 v[56:71], v[104:107], v[124:127], v[56:71]
    v_mfma_f32_32x32x16_bf16 v[72:87], v[108:111], v[120:123], v[72:87]
    v_mfma_f32_32x32x16_bf16 v[88:103], v[108:111], v[124:127], v[88:103]
    v_mfma_f32_16x16x32_bf16 v[32:35], v[104:107], v[28:31], v[32:35]
    s_add_u32 m0, s37, 49152
    s_add_u32 s38, s36, 2211840
    buffer_load_dwordx4 v6, s[60:63], s38 offen lds
    ds_read_b64_tr_b16 v[104:105], v23 offset:8192
    ds_read_b64_tr_b16 v[106:107], v23 offset:9216
    ds_read_b64_tr_b16 v[108:109], v25 offset:8192
    ds_read_b64_tr_b16 v[110:111], v25 offset:9216
    ds_read_b128 v[120:123], v20 offset:0
    ds_read_b128 v[124:127], v20 offset:4096
    s_waitcnt lgkmcnt(6)
    v_mfma_f32_32x32x16_bf16 v[40:55], v[112:115], v[128:131], v[40:55]
    v_mfma_f32_32x32x16_bf16 v[56:71], v[112:115], v[132:135], v[56:71]
    v_mfma_f32_32x32x16_bf16 v[72:87], v[116:119], v[128:131], v[72:87]
    v_mfma_f32_32x32x16_bf16 v[88:103], v[116:119], v[132:135], v[88:103]
    v_mfma_f32_16x16x32_bf16 v[32:35], v[112:115], v[28:31], v[32:35]
    s_add_u32 m0, s37, 53248
    s_add_u32 s38, s36, 2273280
    buffer_load_dwordx4 v6, s[60:63], s38 offen lds
    ds_read_b64_tr_b16 v[112:113], v23 offset:12288
    ds_read_b64_tr_b16 v[114:115], v23 offset:13312
    ds_read_b64_tr_b16 v[116:117], v25 offset:12288
    ds_read_b64_tr_b16 v[118:119], v25 offset:13312
    ds_read_b128 v[128:131], v21 offset:0
    ds_read_b128 v[132:135], v21 offset:4096
    s_waitcnt lgkmcnt(6)
    v_mfma_f32_32x32x16_bf16 v[40:55], v[104:107], v[120:123], v[40:55]
    v_mfma_f32_32x32x16_bf16 v[56:71], v[104:107], v[124:127], v[56:71]
    v_mfma_f32_32x32x16_bf16 v[72:87], v[108:111], v[120:123], v[72:87]
    v_mfma_f32_32x32x16_bf16 v[88:103], v[108:111], v[124:127], v[88:103]
    v_mfma_f32_16x16x32_bf16 v[32:35], v[104:107], v[28:31], v[32:35]
    s_add_u32 m0, s37, 57344
    s_add_u32 s38, s36, 2334720
    buffer_load_dwordx4 v6, s[60:63], s38 offen lds
    s_waitcnt lgkmcnt(0)
    s_waitcnt vmcnt(7)
    s_barrier
    ds_read_b64_tr_b16 v[104:105], v23 offset:32768
    ds_read_b64_tr_b16 v[106:107], v23 offset:33792
    ds_read_b64_tr_b16 v[108:109], v25 offset:32768
    ds_read_b64_tr_b16 v[110:111], v25 offset:33792
    ds_read_b128 v[120:123], v18 offset:32768
    ds_read_b128 v[124:127], v18 offset:36864
    v_mfma_f32_32x32x16_bf16 v[40:55], v[112:115], v[128:131], v[40:55]
    v_mfma_f32_32x32x16_bf16 v[56:71], v[112:115], v[132:135], v[56:71]
    v_mfma_f32_32x32x16_bf16 v[72:87], v[116:119], v[128:131], v[72:87]
    v_mfma_f32_32x32x16_bf16 v[88:103], v[116:119], v[132:135], v[88:103]
    v_mfma_f32_16x16x32_bf16 v[32:35], v[112:115], v[28:31], v[32:35]
    s_add_u32 m0, s37, 61440
    s_add_u32 s38, s36, 2396160
    buffer_load_dwordx4 v6, s[60:63], s38 offen lds
    ds_read_b64_tr_b16 v[140:141], v12 offset:0
    ds_read_b64_tr_b16 v[142:143], v12 offset:512
    ds_read_b64_tr_b16 v[112:113], v23 offset:36864
    ds_read_b64_tr_b16 v[114:115], v23 offset:37888
    ds_read_b64_tr_b16 v[116:117], v25 offset:36864
    ds_read_b64_tr_b16 v[118:119], v25 offset:37888
    ds_read_b128 v[128:131], v19 offset:32768
    ds_read_b128 v[132:135], v19 offset:36864
    s_waitcnt lgkmcnt(8)
    v_mfma_f32_32x32x16_bf16 v[40:55], v[104:107], v[120:123], v[40:55]
    v_mfma_f32_32x32x16_bf16 v[56:71], v[104:107], v[124:127], v[56:71]
    v_mfma_f32_32x32x16_bf16 v[72:87], v[108:111], v[120:123], v[72:87]
    v_mfma_f32_32x32x16_bf16 v[88:103], v[108:111], v[124:127], v[88:103]
    v_mfma_f32_16x16x32_bf16 v[32:35], v[104:107], v[28:31], v[32:35]
    ds_read_b64_tr_b16 v[104:105], v23 offset:40960
    ds_read_b64_tr_b16 v[106:107], v23 offset:41984
    ds_read_b64_tr_b16 v[108:109], v25 offset:40960
    ds_read_b64_tr_b16 v[110:111], v25 offset:41984
    ds_read_b128 v[120:123], v20 offset:32768
    ds_read_b128 v[124:127], v20 offset:36864
    s_waitcnt lgkmcnt(6)
    v_mfma_f32_32x32x16_bf16 v[40:55], v[112:115], v[128:131], v[40:55]
    v_mfma_f32_32x32x16_bf16 v[56:71], v[112:115], v[132:135], v[56:71]
    v_mfma_f32_32x32x16_bf16 v[72:87], v[116:119], v[128:131], v[72:87]
    v_mfma_f32_32x32x16_bf16 v[88:103], v[116:119], v[132:135], v[88:103]
    v_mfma_f32_16x16x32_bf16 v[32:35], v[112:115], v[28:31], v[32:35]
    s_add_u32 s49, s54, 0
    buffer_store_dwordx4 v[140:143], v10, s[8:11], s49 offen sc1
    v_mfma_f32_16x16x32_bf16 v[152:155], v[140:143], v[156:159], v[152:155]
    ds_read_b64_tr_b16 v[140:141], v12 offset:4096
    ds_read_b64_tr_b16 v[142:143], v12 offset:4608
    ds_read_b64_tr_b16 v[112:113], v23 offset:45056
    ds_read_b64_tr_b16 v[114:115], v23 offset:46080
    ds_read_b64_tr_b16 v[116:117], v25 offset:45056
    ds_read_b64_tr_b16 v[118:119], v25 offset:46080
    ds_read_b128 v[128:131], v21 offset:32768
    ds_read_b128 v[132:135], v21 offset:36864
    s_waitcnt lgkmcnt(8)
    v_mfma_f32_32x32x16_bf16 v[40:55], v[104:107], v[120:123], v[40:55]
    v_mfma_f32_32x32x16_bf16 v[56:71], v[104:107], v[124:127], v[56:71]
    v_mfma_f32_32x32x16_bf16 v[72:87], v[108:111], v[120:123], v[72:87]
    v_mfma_f32_32x32x16_bf16 v[88:103], v[108:111], v[124:127], v[88:103]
    v_mfma_f32_16x16x32_bf16 v[32:35], v[104:107], v[28:31], v[32:35]
    s_waitcnt lgkmcnt(0)
    s_waitcnt vmcnt(5)
    s_barrier
    ds_read_b64_tr_b16 v[104:105], v22 offset:0
    ds_read_b64_tr_b16 v[106:107], v22 offset:1024
    ds_read_b64_tr_b16 v[108:109], v24 offset:0
    ds_read_b64_tr_b16 v[110:111], v24 offset:1024
    ds_read_b128 v[120:123], v14 offset:0
    ds_read_b128 v[124:127], v14 offset:4096
    v_mfma_f32_32x32x16_bf16 v[40:55], v[112:115], v[128:131], v[40:55]
    v_mfma_f32_32x32x16_bf16 v[56:71], v[112:115], v[132:135], v[56:71]
    v_mfma_f32_32x32x16_bf16 v[72:87], v[116:119], v[128:131], v[72:87]
    v_mfma_f32_32x32x16_bf16 v[88:103], v[116:119], v[132:135], v[88:103]
    v_mfma_f32_16x16x32_bf16 v[32:35], v[112:115], v[28:31], v[32:35]
    s_add_u32 s49, s54, 1024
    buffer_store_dwordx4 v[140:143], v10, s[8:11], s49 offen sc1
    v_mfma_f32_16x16x32_bf16 v[152:155], v[140:143], v[156:159], v[152:155]
    ds_read_b64_tr_b16 v[140:141], v12 offset:8192
    ds_read_b64_tr_b16 v[142:143], v12 offset:8704
    ds_read_b64_tr_b16 v[112:113], v22 offset:4096
    ds_read_b64_tr_b16 v[114:115], v22 offset:5120
    ds_read_b64_tr_b16 v[116:117], v24 offset:4096
    ds_read_b64_tr_b16 v[118:119], v24 offset:5120
    ds_read_b128 v[128:131], v15 offset:0
    ds_read_b128 v[132:135], v15 offset:4096
    s_waitcnt lgkmcnt(8)
    v_mfma_f32_32x32x16_bf16 v[40:55], v[104:107], v[120:123], v[40:55]
    v_mfma_f32_32x32x16_bf16 v[56:71], v[104:107], v[124:127], v[56:71]
    v_mfma_f32_32x32x16_bf16 v[72:87], v[108:111], v[120:123], v[72:87]
    v_mfma_f32_32x32x16_bf16 v[88:103], v[108:111], v[124:127], v[88:103]
    v_mfma_f32_16x16x32_bf16 v[32:35], v[104:107], v[28:31], v[32:35]
    ds_read_b64_tr_b16 v[104:105], v22 offset:8192
    ds_read_b64_tr_b16 v[106:107], v22 offset:9216
    ds_read_b64_tr_b16 v[108:109], v24 offset:8192
    ds_read_b64_tr_b16 v[110:111], v24 offset:9216
    ds_read_b128 v[120:123], v16 offset:0
    ds_read_b128 v[124:127], v16 offset:4096
    s_waitcnt lgkmcnt(6)
    v_mfma_f32_32x32x16_bf16 v[40:55], v[112:115], v[128:131], v[40:55]
    v_mfma_f32_32x32x16_bf16 v[56:71], v[112:115], v[132:135], v[56:71]
    v_mfma_f32_32x32x16_bf16 v[72:87], v[116:119], v[128:131], v[72:87]
    v_mfma_f32_32x32x16_bf16 v[88:103], v[116:119], v[132:135], v[88:103]
    v_mfma_f32_16x16x32_bf16 v[32:35], v[112:115], v[28:31], v[32:35]
    s_add_u32 s49, s54, 2048
    buffer_store_dwordx4 v[140:143], v10, s[8:11], s49 offen sc1
    v_mfma_f32_16x16x32_bf16 v[152:155], v[140:143], v[156:159], v[152:155]
    ds_read_b64_tr_b16 v[140:141], v12 offset:12288
    ds_read_b64_tr_b16 v[142:143], v12 offset:12800
    ds_read_b64_tr_b16 v[112:113], v22 offset:12288
    ds_read_b64_tr_b16 v[114:115], v22 offset:13312
    ds_read_b64_tr_b16 v[116:117], v24 offset:12288
    ds_read_b64_tr_b16 v[118:119], v24 offset:13312
    ds_read_b128 v[128:131], v17 offset:0
    ds_read_b128 v[132:135], v17 offset:4096
    s_waitcnt lgkmcnt(8)
    v_mfma_f32_32x32x16_bf16 v[40:55], v[104:107], v[120:123], v[40:55]
    v_mfma_f32_32x32x16_bf16 v[56:71], v[104:107], v[124:127], v[56:71]
    v_mfma_f32_32x32x16_bf16 v[72:87], v[108:111], v[120:123], v[72:87]
    v_mfma_f32_32x32x16_bf16 v[88:103], v[108:111], v[124:127], v[88:103]
    v_mfma_f32_16x16x32_bf16 v[32:35], v[104:107], v[28:31], v[32:35]
    s_waitcnt lgkmcnt(0)
    s_waitcnt vmcnt(3)
    s_barrier
    ds_read_b64_tr_b16 v[104:105], v22 offset:32768
    ds_read_b64_tr_b16 v[106:107], v22 offset:33792
    ds_read_b64_tr_b16 v[108:109], v24 offset:32768
    ds_read_b64_tr_b16 v[110:111], v24 offset:33792
    ds_read_b128 v[120:123], v14 offset:32768
    ds_read_b128 v[124:127], v14 offset:36864
    v_mfma_f32_32x32x16_bf16 v[40:55], v[112:115], v[128:131], v[40:55]
    v_mfma_f32_32x32x16_bf16 v[56:71], v[112:115], v[132:135], v[56:71]
    v_mfma_f32_32x32x16_bf16 v[72:87], v[116:119], v[128:131], v[72:87]
    v_mfma_f32_32x32x16_bf16 v[88:103], v[116:119], v[132:135], v[88:103]
    v_mfma_f32_16x16x32_bf16 v[32:35], v[112:115], v[28:31], v[32:35]
    s_add_u32 s49, s54, 3072
    buffer_store_dwordx4 v[140:143], v10, s[8:11], s49 offen sc1
    v_mfma_f32_16x16x32_bf16 v[152:155], v[140:143], v[156:159], v[152:155]
    ds_read_b64_tr_b16 v[140:141], v12 offset:16384
    ds_read_b64_tr_b16 v[142:143], v12 offset:16896
    ds_read_b64_tr_b16 v[112:113], v22 offset:36864
    ds_read_b64_tr_b16 v[114:115], v22 offset:37888
    ds_read_b64_tr_b16 v[116:117], v24 offset:36864
    ds_read_b64_tr_b16 v[118:119], v24 offset:37888
    ds_read_b128 v[128:131], v15 offset:32768
    ds_read_b128 v[132:135], v15 offset:36864
    s_waitcnt lgkmcnt(8)
    v_mfma_f32_32x32x16_bf16 v[40:55], v[104:107], v[120:123], v[40:55]
    v_mfma_f32_32x32x16_bf16 v[56:71], v[104:107], v[124:127], v[56:71]
    v_mfma_f32_32x32x16_bf16 v[72:87], v[108:111], v[120:123], v[72:87]
    v_mfma_f32_32x32x16_bf16 v[88:103], v[108:111], v[124:127], v[88:103]
    v_mfma_f32_16x16x32_bf16 v[32:35], v[104:107], v[28:31], v[32:35]
    ds_read_b64_tr_b16 v[104:105], v22 offset:40960
    ds_read_b64_tr_b16 v[106:107], v22 offset:41984
    ds_read_b64_tr_b16 v[108:109], v24 offset:40960
    ds_read_b64_tr_b16 v[110:111], v24 offset:41984
    ds_read_b128 v[120:123], v16 offset:32768
    ds_read_b128 v[124:127], v16 offset:36864
    s_waitcnt lgkmcnt(6)
    v_mfma_f32_32x32x16_bf16 v[40:55], v[112:115], v[128:131], v[40:55]
    v_mfma_f32_32x32x16_bf16 v[56:71], v[112:115], v[132:135], v[56:71]
    v_mfma_f32_32x32x16_bf16 v[72:87], v[116:119], v[128:131], v[72:87]
    v_mfma_f32_32x32x16_bf16 v[88:103], v[116:119], v[132:135], v[88:103]
    v_mfma_f32_16x16x32_bf16 v[32:35], v[112:115], v[28:31], v[32:35]
    s_add_u32 s49, s54, 4096
    buffer_store_dwordx4 v[140:143], v10, s[8:11], s49 offen sc1
    v_mfma_f32_16x16x32_bf16 v[152:155], v[140:143], v[156:159], v[152:155]
    ds_read_b64_tr_b16 v[140:141], v12 offset:20480
    ds_read_b64_tr_b16 v[142:143], v12 offset:20992
    ds_read_b64_tr_b16 v[112:113], v22 offset:45056
    ds_read_b64_tr_b16 v[114:115], v22 offset:46080
    ds_read_b64_tr_b16 v[116:117], v24 offset:45056
    ds_read_b64_tr_b16 v[118:119], v24 offset:46080
    ds_read_b128 v[128:131], v17 offset:32768
    ds_read_b128 v[132:135], v17 offset:36864
    s_waitcnt lgkmcnt(8)
    v_mfma_f32_32x32x16_bf16 v[40:55], v[104:107], v[120:123], v[40:55]
    v_mfma_f32_32x32x16_bf16 v[56:71], v[104:107], v[124:127], v[56:71]
    v_mfma_f32_32x32x16_bf16 v[72:87], v[108:111], v[120:123], v[72:87]
    v_mfma_f32_32x32x16_bf16 v[88:103], v[108:111], v[124:127], v[88:103]
    v_mfma_f32_16x16x32_bf16 v[32:35], v[104:107], v[28:31], v[32:35]
    s_waitcnt lgkmcnt(0)
    v_mfma_f32_32x32x16_bf16 v[40:55], v[112:115], v[128:131], v[40:55]
    v_mfma_f32_32x32x16_bf16 v[56:71], v[112:115], v[132:135], v[56:71]
    v_mfma_f32_32x32x16_bf16 v[72:87], v[116:119], v[128:131], v[72:87]
    v_mfma_f32_32x32x16_bf16 v[88:103], v[116:119], v[132:135], v[88:103]
    v_mfma_f32_16x16x32_bf16 v[32:35], v[112:115], v[28:31], v[32:35]
    s_add_u32 s49, s55, 5120
    buffer_store_dwordx4 v[140:143], v10, s[8:11], s49 offen sc1
    s_sub_u32 s40, s2, 40
    s_mul_i32 s58, s46, 6912
    s_lshl_b32 s59, s47, 8
    s_add_u32 s58, s58, s59
    s_lshl_b32 s59, s23, 6
    s_add_u32 s58, s58, s59
    s_add_u32 s58, s58, 30507008
    s_cmp_lt_u32 s40, 108
    s_cselect_b32 s58, s58, 0x7ff00000
    v_lshrrev_b32 v11, 4, v2
    v_lshlrev_b32 v11, 4, v11
    s_mov_b32 s52, 0x00010001
    s_mov_b32 s53, 0x00010001
    s_mov_b64 exec, s[52:53]
    buffer_store_dwordx4 v[152:155], v11, s[8:11], s58 offen sc1
    s_mov_b64 exec, -1
    s_lshl_b32 s40, s56, 7
    s_add_u32 s40, s40, 156672
    v_and_b32 v8, 1, v2
    v_lshlrev_b32 v8, 6, v8
    v_lshrrev_b32 v9, 4, v2
    v_lshl_add_u32 v8, v9, 4, v8
    v_add_u32 v8, s40, v8
    s_mov_b32 s52, 0x00030003
    s_mov_b32 s53, 0x00030003
    s_nop 7
    s_mov_b64 exec, s[52:53]
    ds_write_b128 v8, v[32:35]
    s_mov_b64 exec, -1
    s_waitcnt lgkmcnt(0)
    s_barrier
    s_lshl_b32 s40, s22, 8
    s_add_u32 s40, s40, 155648
    v_lshlrev_b32 v7, 2, v3
    v_add_u32 v7, s40, v7
    ds_read_b32 v136, v7 offset:0
    ds_read_b32 v137, v7 offset:512
    ds_read_b32 v138, v7 offset:128
    ds_read_b32 v139, v7 offset:640
    s_lshl_b32 s40, s56, 7
    s_add_u32 s40, s40, 156672
    v_lshlrev_b32 v7, 4, v4
    v_add_u32 v7, s40, v7
    ds_read_b128 v[104:107], v7 offset:0
    ds_read_b128 v[108:111], v7 offset:32
    ds_read_b128 v[112:115], v7 offset:64
    ds_read_b128 v[116:119], v7 offset:96
    s_lshl_b32 s40, s57, 7
    s_add_u32 s40, s40, 156672
    v_lshlrev_b32 v7, 4, v4
    v_add_u32 v7, s40, v7
    ds_read_b128 v[120:123], v7 offset:0
    ds_read_b128 v[124:127], v7 offset:32
    ds_read_b128 v[128:131], v7 offset:64
    ds_read_b128 v[132:135], v7 offset:96
    s_mov_b32 s40, 0x3ea52b5c
    s_cmp_lt_u32 s14, 5
    s_cselect_b32 s40, s40, 1.0
    s_waitcnt lgkmcnt(0)
    v_mul_f32 v136, s40, v136
    v_mul_f32 v137, s40, v137
    v_mul_f32 v138, s40, v138
    v_mul_f32 v139, s40, v139
    v_lshrrev_b32 v13, 4, v3
    s_movk_i32 s17, 20480
    v_mul_lo_u32 v13, v13, s17
    v_and_b32 v14, 15, v3
    v_lshl_add_u32 v13, v14, 4, v13
    v_lshl_add_u32 v13, v4, 8, v13
    s_lshl_b32 s17, s13, 3
    s_lshl_b32 s18, s22, 2
    s_add_u32 s17, s17, s18
    s_mul_i32 s17, s17, 20480
    s_mov_b32 s18, 10321920
    s_mov_b32 s19, 12922880
    s_cmp_lt_u32 s14, 5
    s_cselect_b32 s18, s18, s19
    s_add_u32 s17, s17, s18
    s_lshl_b32 s18, s14, 12
    s_add_u32 s17, s17, s18
    v_mul_f32 v140, v136, v104
    v_fma_f32 v40, v137, v40, -v140
    v_mul_f32 v140, v136, v105
    v_fma_f32 v41, v137, v41, -v140
    v_mul_f32 v140, v136, v106
    v_fma_f32 v42, v137, v42, -v140
    v_mul_f32 v140, v136, v107
    v_fma_f32 v43, v137, v43, -v140
    v_mul_f32 v140, v136, v108
    v_fma_f32 v44, v137, v44, -v140
    v_mul_f32 v140, v136, v109
    v_fma_f32 v45, v137, v45, -v140
    v_mul_f32 v140, v136, v110
    v_fma_f32 v46, v137, v46, -v140
    v_mul_f32 v140, v136, v111
    v_fma_f32 v47, v137, v47, -v140
    v_mul_f32 v140, v136, v112
    v_fma_f32 v48, v137, v48, -v140
    v_mul_f32 v140, v136, v113
    v_fma_f32 v49, v137, v49, -v140
    v_mul_f32 v140, v136, v114
    v_fma_f32 v50, v137, v50, -v140
    v_mul_f32 v140, v136, v115
    v_fma_f32 v51, v137, v51, -v140
    v_mul_f32 v140, v136, v116
    v_fma_f32 v52, v137, v52, -v140
    v_mul_f32 v140, v136, v117
    v_fma_f32 v53, v137, v53, -v140
    v_mul_f32 v140, v136, v118
    v_fma_f32 v54, v137, v54, -v140
    v_mul_f32 v140, v136, v119
    v_fma_f32 v55, v137, v55, -v140
    v_cvt_pk_bf16_f32 v144, v40, v41
    v_cvt_pk_bf16_f32 v145, v42, v43
    v_cvt_pk_bf16_f32 v146, v44, v45
    v_cvt_pk_bf16_f32 v147, v46, v47
    v_cvt_pk_bf16_f32 v148, v48, v49
    v_cvt_pk_bf16_f32 v149, v50, v51
    v_cvt_pk_bf16_f32 v150, v52, v53
    v_cvt_pk_bf16_f32 v151, v54, v55
    s_lshl_b32 s18, s56, 10
    s_add_u32 s18, s18, s17
    buffer_store_dwordx4 v[144:147], v13, s[8:11], s18 offen sc1
    buffer_store_dwordx4 v[148:151], v13, s[8:11], s18 offen offset:512 sc1
    v_mul_f32 v140, v138, v104
    v_fma_f32 v56, v139, v56, -v140
    v_mul_f32 v140, v138, v105
    v_fma_f32 v57, v139, v57, -v140
    v_mul_f32 v140, v138, v106
    v_fma_f32 v58, v139, v58, -v140
    v_mul_f32 v140, v138, v107
    v_fma_f32 v59, v139, v59, -v140
    v_mul_f32 v140, v138, v108
    v_fma_f32 v60, v139, v60, -v140
    v_mul_f32 v140, v138, v109
    v_fma_f32 v61, v139, v61, -v140
    v_mul_f32 v140, v138, v110
    v_fma_f32 v62, v139, v62, -v140
    v_mul_f32 v140, v138, v111
    v_fma_f32 v63, v139, v63, -v140
    v_mul_f32 v140, v138, v112
    v_fma_f32 v64, v139, v64, -v140
    v_mul_f32 v140, v138, v113
    v_fma_f32 v65, v139, v65, -v140
    v_mul_f32 v140, v138, v114
    v_fma_f32 v66, v139, v66, -v140
    v_mul_f32 v140, v138, v115
    v_fma_f32 v67, v139, v67, -v140
    v_mul_f32 v140, v138, v116
    v_fma_f32 v68, v139, v68, -v140
    v_mul_f32 v140, v138, v117
    v_fma_f32 v69, v139, v69, -v140
    v_mul_f32 v140, v138, v118
    v_fma_f32 v70, v139, v70, -v140
    v_mul_f32 v140, v138, v119
    v_fma_f32 v71, v139, v71, -v140
    v_cvt_pk_bf16_f32 v152, v56, v57
    v_cvt_pk_bf16_f32 v153, v58, v59
    v_cvt_pk_bf16_f32 v154, v60, v61
    v_cvt_pk_bf16_f32 v155, v62, v63
    v_cvt_pk_bf16_f32 v156, v64, v65
    v_cvt_pk_bf16_f32 v157, v66, v67
    v_cvt_pk_bf16_f32 v158, v68, v69
    v_cvt_pk_bf16_f32 v159, v70, v71
    s_lshl_b32 s18, s56, 10
    s_add_u32 s18, s18, s17
    s_add_u32 s18, s18, 40960
    buffer_store_dwordx4 v[152:155], v13, s[8:11], s18 offen sc1
    buffer_store_dwordx4 v[156:159], v13, s[8:11], s18 offen offset:512 sc1
    v_mul_f32 v140, v136, v120
    v_fma_f32 v72, v137, v72, -v140
    v_mul_f32 v140, v136, v121
    v_fma_f32 v73, v137, v73, -v140
    v_mul_f32 v140, v136, v122
    v_fma_f32 v74, v137, v74, -v140
    v_mul_f32 v140, v136, v123
    v_fma_f32 v75, v137, v75, -v140
    v_mul_f32 v140, v136, v124
    v_fma_f32 v76, v137, v76, -v140
    v_mul_f32 v140, v136, v125
    v_fma_f32 v77, v137, v77, -v140
    v_mul_f32 v140, v136, v126
    v_fma_f32 v78, v137, v78, -v140
    v_mul_f32 v140, v136, v127
    v_fma_f32 v79, v137, v79, -v140
    v_mul_f32 v140, v136, v128
    v_fma_f32 v80, v137, v80, -v140
    v_mul_f32 v140, v136, v129
    v_fma_f32 v81, v137, v81, -v140
    v_mul_f32 v140, v136, v130
    v_fma_f32 v82, v137, v82, -v140
    v_mul_f32 v140, v136, v131
    v_fma_f32 v83, v137, v83, -v140
    v_mul_f32 v140, v136, v132
    v_fma_f32 v84, v137, v84, -v140
    v_mul_f32 v140, v136, v133
    v_fma_f32 v85, v137, v85, -v140
    v_mul_f32 v140, v136, v134
    v_fma_f32 v86, v137, v86, -v140
    v_mul_f32 v140, v136, v135
    v_fma_f32 v87, v137, v87, -v140
    v_cvt_pk_bf16_f32 v144, v72, v73
    v_cvt_pk_bf16_f32 v145, v74, v75
    v_cvt_pk_bf16_f32 v146, v76, v77
    v_cvt_pk_bf16_f32 v147, v78, v79
    v_cvt_pk_bf16_f32 v148, v80, v81
    v_cvt_pk_bf16_f32 v149, v82, v83
    v_cvt_pk_bf16_f32 v150, v84, v85
    v_cvt_pk_bf16_f32 v151, v86, v87
    s_lshl_b32 s18, s57, 10
    s_add_u32 s18, s18, s17
    buffer_store_dwordx4 v[144:147], v13, s[8:11], s18 offen sc1
    buffer_store_dwordx4 v[148:151], v13, s[8:11], s18 offen offset:512 sc1
    v_mul_f32 v140, v138, v120
    v_fma_f32 v88, v139, v88, -v140
    v_mul_f32 v140, v138, v121
    v_fma_f32 v89, v139, v89, -v140
    v_mul_f32 v140, v138, v122
    v_fma_f32 v90, v139, v90, -v140
    v_mul_f32 v140, v138, v123
    v_fma_f32 v91, v139, v91, -v140
    v_mul_f32 v140, v138, v124
    v_fma_f32 v92, v139, v92, -v140
    v_mul_f32 v140, v138, v125
    v_fma_f32 v93, v139, v93, -v140
    v_mul_f32 v140, v138, v126
    v_fma_f32 v94, v139, v94, -v140
    v_mul_f32 v140, v138, v127
    v_fma_f32 v95, v139, v95, -v140
    v_mul_f32 v140, v138, v128
    v_fma_f32 v96, v139, v96, -v140
    v_mul_f32 v140, v138, v129
    v_fma_f32 v97, v139, v97, -v140
    v_mul_f32 v140, v138, v130
    v_fma_f32 v98, v139, v98, -v140
    v_mul_f32 v140, v138, v131
    v_fma_f32 v99, v139, v99, -v140
    v_mul_f32 v140, v138, v132
    v_fma_f32 v100, v139, v100, -v140
    v_mul_f32 v140, v138, v133
    v_fma_f32 v101, v139, v101, -v140
    v_mul_f32 v140, v138, v134
    v_fma_f32 v102, v139, v102, -v140
    v_mul_f32 v140, v138, v135
    v_fma_f32 v103, v139, v103, -v140
    v_cvt_pk_bf16_f32 v152, v88, v89
    v_cvt_pk_bf16_f32 v153, v90, v91
    v_cvt_pk_bf16_f32 v154, v92, v93
    v_cvt_pk_bf16_f32 v155, v94, v95
    v_cvt_pk_bf16_f32 v156, v96, v97
    v_cvt_pk_bf16_f32 v157, v98, v99
    v_cvt_pk_bf16_f32 v158, v100, v101
    v_cvt_pk_bf16_f32 v159, v102, v103
    s_lshl_b32 s18, s57, 10
    s_add_u32 s18, s18, s17
    s_add_u32 s18, s18, 40960
    buffer_store_dwordx4 v[152:155], v13, s[8:11], s18 offen sc1
    buffer_store_dwordx4 v[156:159], v13, s[8:11], s18 offen offset:512 sc1
    s_endpgm
k1_kernel_v:
    s_waitcnt vmcnt(4)
    s_barrier
    ds_read_b64_tr_b16 v[104:105], v22 offset:0
    ds_read_b64_tr_b16 v[106:107], v22 offset:1024
    ds_read_b64_tr_b16 v[108:109], v24 offset:0
    ds_read_b64_tr_b16 v[110:111], v24 offset:1024
    ds_read_b128 v[120:123], v14 offset:0
    ds_read_b128 v[124:127], v14 offset:4096
    ds_read_b64_tr_b16 v[112:113], v22 offset:4096
    ds_read_b64_tr_b16 v[114:115], v22 offset:5120
    ds_read_b64_tr_b16 v[116:117], v24 offset:4096
    ds_read_b64_tr_b16 v[118:119], v24 offset:5120
    ds_read_b128 v[128:131], v15 offset:0
    ds_read_b128 v[132:135], v15 offset:4096
    s_waitcnt lgkmcnt(6)
    v_mfma_f32_32x32x16_bf16 v[40:55], v[120:123], v[104:107], 0
    v_mfma_f32_32x32x16_bf16 v[56:71], v[124:127], v[104:107], 0
    v_mfma_f32_32x32x16_bf16 v[72:87], v[120:123], v[108:111], 0
    v_mfma_f32_32x32x16_bf16 v[88:103], v[124:127], v[108:111], 0
    v_mfma_f32_16x16x32_bf16 v[32:35], v[104:107], v[28:31], v[32:35]
    s_add_u32 m0, s37, 81920
    s_add_u32 s38, s36, 491520
    buffer_load_dwordx4 v6, s[60:63], s38 offen lds
    s_add_u32 m0, s37, 86016
    s_add_u32 s38, s36, 552960
    buffer_load_dwordx4 v6, s[60:63], s38 offen lds
    ds_read_b64_tr_b16 v[104:105], v22 offset:8192
    ds_read_b64_tr_b16 v[106:107], v22 offset:9216
    ds_read_b64_tr_b16 v[108:109], v24 offset:8192
    ds_read_b64_tr_b16 v[110:111], v24 offset:9216
    ds_read_b128 v[120:123], v16 offset:0
    ds_read_b128 v[124:127], v16 offset:4096
    s_waitcnt lgkmcnt(6)
    v_mfma_f32_32x32x16_bf16 v[40:55], v[128:131], v[112:115], v[40:55]
    v_mfma_f32_32x32x16_bf16 v[56:71], v[132:135], v[112:115], v[56:71]
    v_mfma_f32_32x32x16_bf16 v[72:87], v[128:131], v[116:119], v[72:87]
    v_mfma_f32_32x32x16_bf16 v[88:103], v[132:135], v[116:119], v[88:103]
    v_mfma_f32_16x16x32_bf16 v[32:35], v[112:115], v[28:31], v[32:35]
    s_add_u32 m0, s37, 90112
    s_add_u32 s38, s36, 614400
    buffer_load_dwordx4 v6, s[60:63], s38 offen lds
    s_add_u32 m0, s37, 94208
    s_add_u32 s38, s36, 675840
    buffer_load_dwordx4 v6, s[60:63], s38 offen lds
    ds_read_b64_tr_b16 v[112:113], v22 offset:12288
    ds_read_b64_tr_b16 v[114:115], v22 offset:13312
    ds_read_b64_tr_b16 v[116:117], v24 offset:12288
    ds_read_b64_tr_b16 v[118:119], v24 offset:13312
    ds_read_b128 v[128:131], v17 offset:0
    ds_read_b128 v[132:135], v17 offset:4096
    s_waitcnt lgkmcnt(6)
    v_mfma_f32_32x32x16_bf16 v[40:55], v[120:123], v[104:107], v[40:55]
    v_mfma_f32_32x32x16_bf16 v[56:71], v[124:127], v[104:107], v[56:71]
    v_mfma_f32_32x32x16_bf16 v[72:87], v[120:123], v[108:111], v[72:87]
    v_mfma_f32_32x32x16_bf16 v[88:103], v[124:127], v[108:111], v[88:103]
    v_mfma_f32_16x16x32_bf16 v[32:35], v[104:107], v[28:31], v[32:35]
    s_add_u32 m0, s37, 114688
    s_add_u32 s38, s36, 737280
    buffer_load_dwordx4 v6, s[60:63], s38 offen lds
    s_add_u32 m0, s37, 118784
    s_add_u32 s38, s36, 798720
    buffer_load_dwordx4 v6, s[60:63], s38 offen lds
    s_waitcnt lgkmcnt(0)
    s_waitcnt vmcnt(6)
    s_barrier
    ds_read_b64_tr_b16 v[104:105], v22 offset:32768
    ds_read_b64_tr_b16 v[106:107], v22 offset:33792
    ds_read_b64_tr_b16 v[108:109], v24 offset:32768
    ds_read_b64_tr_b16 v[110:111], v24 offset:33792
    ds_read_b128 v[120:123], v14 offset:32768
    ds_read_b128 v[124:127], v14 offset:36864
    v_mfma_f32_32x32x16_bf16 v[40:55], v[128:131], v[112:115], v[40:55]
    v_mfma_f32_32x32x16_bf16 v[56:71], v[132:135], v[112:115], v[56:71]
    v_mfma_f32_32x32x16_bf16 v[72:87], v[128:131], v[116:119], v[72:87]
    v_mfma_f32_32x32x16_bf16 v[88:103], v[132:135], v[116:119], v[88:103]
    v_mfma_f32_16x16x32_bf16 v[32:35], v[112:115], v[28:31], v[32:35]
    s_add_u32 m0, s37, 122880
    s_add_u32 s38, s36, 860160
    buffer_load_dwordx4 v6, s[60:63], s38 offen lds
    s_add_u32 m0, s37, 126976
    s_add_u32 s38, s36, 921600
    buffer_load_dwordx4 v6, s[60:63], s38 offen lds
    ds_read_b64_tr_b16 v[112:113], v22 offset:36864
    ds_read_b64_tr_b16 v[114:115], v22 offset:37888
    ds_read_b64_tr_b16 v[116:117], v24 offset:36864
    ds_read_b64_tr_b16 v[118:119], v24 offset:37888
    ds_read_b128 v[128:131], v15 offset:32768
    ds_read_b128 v[132:135], v15 offset:36864
    s_waitcnt lgkmcnt(6)
    v_mfma_f32_32x32x16_bf16 v[40:55], v[120:123], v[104:107], v[40:55]
    v_mfma_f32_32x32x16_bf16 v[56:71], v[124:127], v[104:107], v[56:71]
    v_mfma_f32_32x32x16_bf16 v[72:87], v[120:123], v[108:111], v[72:87]
    v_mfma_f32_32x32x16_bf16 v[88:103], v[124:127], v[108:111], v[88:103]
    v_mfma_f32_16x16x32_bf16 v[32:35], v[104:107], v[28:31], v[32:35]
    s_add_u32 m0, s37, 16384
    s_add_u32 s38, s36, 983040
    buffer_load_dwordx4 v6, s[60:63], s38 offen lds
    ds_read_b64_tr_b16 v[104:105], v22 offset:40960
    ds_read_b64_tr_b16 v[106:107], v22 offset:41984
    ds_read_b64_tr_b16 v[108:109], v24 offset:40960
    ds_read_b64_tr_b16 v[110:111], v24 offset:41984
    ds_read_b128 v[120:123], v16 offset:32768
    ds_read_b128 v[124:127], v16 offset:36864
    s_waitcnt lgkmcnt(6)
    v_mfma_f32_32x32x16_bf16 v[40:55], v[128:131], v[112:115], v[40:55]
    v_mfma_f32_32x32x16_bf16 v[56:71], v[132:135], v[112:115], v[56:71]
    v_mfma_f32_32x32x16_bf16 v[72:87], v[128:131], v[116:119], v[72:87]
    v_mfma_f32_32x32x16_bf16 v[88:103], v[132:135], v[116:119], v[88:103]
    v_mfma_f32_16x16x32_bf16 v[32:35], v[112:115], v[28:31], v[32:35]
    s_add_u32 m0, s37, 20480
    s_add_u32 s38, s36, 1044480
    buffer_load_dwordx4 v6, s[60:63], s38 offen lds
    ds_read_b64_tr_b16 v[112:113], v22 offset:45056
    ds_read_b64_tr_b16 v[114:115], v22 offset:46080
    ds_read_b64_tr_b16 v[116:117], v24 offset:45056
    ds_read_b64_tr_b16 v[118:119], v24 offset:46080
    ds_read_b128 v[128:131], v17 offset:32768
    ds_read_b128 v[132:135], v17 offset:36864
    s_waitcnt lgkmcnt(6)
    v_mfma_f32_32x32x16_bf16 v[40:55], v[120:123], v[104:107], v[40:55]
    v_mfma_f32_32x32x16_bf16 v[56:71], v[124:127], v[104:107], v[56:71]
    v_mfma_f32_32x32x16_bf16 v[72:87], v[120:123], v[108:111], v[72:87]
    v_mfma_f32_32x32x16_bf16 v[88:103], v[124:127], v[108:111], v[88:103]
    v_mfma_f32_16x16x32_bf16 v[32:35], v[104:107], v[28:31], v[32:35]
    s_add_u32 m0, s37, 24576
    s_add_u32 s38, s36, 1105920
    buffer_load_dwordx4 v6, s[60:63], s38 offen lds
    s_waitcnt lgkmcnt(0)
    s_waitcnt vmcnt(7)
    s_barrier
    ds_read_b64_tr_b16 v[104:105], v23 offset:0
    ds_read_b64_tr_b16 v[106:107], v23 offset:1024
    ds_read_b64_tr_b16 v[108:109], v25 offset:0
    ds_read_b64_tr_b16 v[110:111], v25 offset:1024
    ds_read_b128 v[120:123], v18 offset:0
    ds_read_b128 v[124:127], v18 offset:4096
    v_mfma_f32_32x32x16_bf16 v[40:55], v[128:131], v[112:115], v[40:55]
    v_mfma_f32_32x32x16_bf16 v[56:71], v[132:135], v[112:115], v[56:71]
    v_mfma_f32_32x32x16_bf16 v[72:87], v[128:131], v[116:119], v[72:87]
    v_mfma_f32_32x32x16_bf16 v[88:103], v[132:135], v[116:119], v[88:103]
    v_mfma_f32_16x16x32_bf16 v[32:35], v[112:115], v[28:31], v[32:35]
    s_add_u32 m0, s37, 28672
    s_add_u32 s38, s36, 1167360
    buffer_load_dwordx4 v6, s[60:63], s38 offen lds
    ds_read_b64_tr_b16 v[112:113], v23 offset:4096
    ds_read_b64_tr_b16 v[114:115], v23 offset:5120
    ds_read_b64_tr_b16 v[116:117], v25 offset:4096
    ds_read_b64_tr_b16 v[118:119], v25 offset:5120
    ds_read_b128 v[128:131], v19 offset:0
    ds_read_b128 v[132:135], v19 offset:4096
    s_waitcnt lgkmcnt(6)
    v_mfma_f32_32x32x16_bf16 v[40:55], v[120:123], v[104:107], v[40:55]
    v_mfma_f32_32x32x16_bf16 v[56:71], v[124:127], v[104:107], v[56:71]
    v_mfma_f32_32x32x16_bf16 v[72:87], v[120:123], v[108:111], v[72:87]
    v_mfma_f32_32x32x16_bf16 v[88:103], v[124:127], v[108:111], v[88:103]
    v_mfma_f32_16x16x32_bf16 v[32:35], v[104:107], v[28:31], v[32:35]
    s_add_u32 m0, s37, 49152
    s_add_u32 s38, s36, 1228800
    buffer_load_dwordx4 v6, s[60:63], s38 offen lds
    ds_read_b64_tr_b16 v[104:105], v23 offset:8192
    ds_read_b64_tr_b16 v[106:107], v23 offset:9216
    ds_read_b64_tr_b16 v[108:109], v25 offset:8192
    ds_read_b64_tr_b16 v[110:111], v25 offset:9216
    ds_read_b128 v[120:123], v20 offset:0
    ds_read_b128 v[124:127], v20 offset:4096
    s_waitcnt lgkmcnt(6)
    v_mfma_f32_32x32x16_bf16 v[40:55], v[128:131], v[112:115], v[40:55]
    v_mfma_f32_32x32x16_bf16 v[56:71], v[132:135], v[112:115], v[56:71]
    v_mfma_f32_32x32x16_bf16 v[72:87], v[128:131], v[116:119], v[72:87]
    v_mfma_f32_32x32x16_bf16 v[88:103], v[132:135], v[116:119], v[88:103]
    v_mfma_f32_16x16x32_bf16 v[32:35], v[112:115], v[28:31], v[32:35]
    s_add_u32 m0, s37, 53248
    s_add_u32 s38, s36, 1290240
    buffer_load_dwordx4 v6, s[60:63], s38 offen lds
    ds_read_b64_tr_b16 v[112:113], v23 offset:12288
    ds_read_b64_tr_b16 v[114:115], v23 offset:13312
    ds_read_b64_tr_b16 v[116:117], v25 offset:12288
    ds_read_b64_tr_b16 v[118:119], v25 offset:13312
    ds_read_b128 v[128:131], v21 offset:0
    ds_read_b128 v[132:135], v21 offset:4096
    s_waitcnt lgkmcnt(6)
    v_mfma_f32_32x32x16_bf16 v[40:55], v[120:123], v[104:107], v[40:55]
    v_mfma_f32_32x32x16_bf16 v[56:71], v[124:127], v[104:107], v[56:71]
    v_mfma_f32_32x32x16_bf16 v[72:87], v[120:123], v[108:111], v[72:87]
    v_mfma_f32_32x32x16_bf16 v[88:103], v[124:127], v[108:111], v[88:103]
    v_mfma_f32_16x16x32_bf16 v[32:35], v[104:107], v[28:31], v[32:35]
    s_add_u32 m0, s37, 57344
    s_add_u32 s38, s36, 1351680
    buffer_load_dwordx4 v6, s[60:63], s38 offen lds
    s_waitcnt lgkmcnt(0)
    s_waitcnt vmcnt(7)
    s_barrier
    ds_read_b64_tr_b16 v[104:105], v23 offset:32768
    ds_read_b64_tr_b16 v[106:107], v23 offset:33792
    ds_read_b64_tr_b16 v[108:109], v25 offset:32768
    ds_read_b64_tr_b16 v[110:111], v25 offset:33792
    ds_read_b128 v[120:123], v18 offset:32768
    ds_read_b128 v[124:127], v18 offset:36864
    v_mfma_f32_32x32x16_bf16 v[40:55], v[128:131], v[112:115], v[40:55]
    v_mfma_f32_32x32x16_bf16 v[56:71], v[132:135], v[112:115], v[56:71]
    v_mfma_f32_32x32x16_bf16 v[72:87], v[128:131], v[116:119], v[72:87]
    v_mfma_f32_32x32x16_bf16 v[88:103], v[132:135], v[116:119], v[88:103]
    v_mfma_f32_16x16x32_bf16 v[32:35], v[112:115], v[28:31], v[32:35]
    s_add_u32 m0, s37, 61440
    s_add_u32 s38, s36, 1413120
    buffer_load_dwordx4 v6, s[60:63], s38 offen lds
    ds_read_b64_tr_b16 v[112:113], v23 offset:36864
    ds_read_b64_tr_b16 v[114:115], v23 offset:37888
    ds_read_b64_tr_b16 v[116:117], v25 offset:36864
    ds_read_b64_tr_b16 v[118:119], v25 offset:37888
    ds_read_b128 v[128:131], v19 offset:32768
    ds_read_b128 v[132:135], v19 offset:36864
    s_waitcnt lgkmcnt(6)
    v_mfma_f32_32x32x16_bf16 v[40:55], v[120:123], v[104:107], v[40:55]
    v_mfma_f32_32x32x16_bf16 v[56:71], v[124:127], v[104:107], v[56:71]
    v_mfma_f32_32x32x16_bf16 v[72:87], v[120:123], v[108:111], v[72:87]
    v_mfma_f32_32x32x16_bf16 v[88:103], v[124:127], v[108:111], v[88:103]
    v_mfma_f32_16x16x32_bf16 v[32:35], v[104:107], v[28:31], v[32:35]
    s_add_u32 m0, s37, 81920
    s_add_u32 s38, s36, 1474560
    buffer_load_dwordx4 v6, s[60:63], s38 offen lds
    ds_read_b64_tr_b16 v[104:105], v23 offset:40960
    ds_read_b64_tr_b16 v[106:107], v23 offset:41984
    ds_read_b64_tr_b16 v[108:109], v25 offset:40960
    ds_read_b64_tr_b16 v[110:111], v25 offset:41984
    ds_read_b128 v[120:123], v20 offset:32768
    ds_read_b128 v[124:127], v20 offset:36864
    s_waitcnt lgkmcnt(6)
    v_mfma_f32_32x32x16_bf16 v[40:55], v[128:131], v[112:115], v[40:55]
    v_mfma_f32_32x32x16_bf16 v[56:71], v[132:135], v[112:115], v[56:71]
    v_mfma_f32_32x32x16_bf16 v[72:87], v[128:131], v[116:119], v[72:87]
    v_mfma_f32_32x32x16_bf16 v[88:103], v[132:135], v[116:119], v[88:103]
    v_mfma_f32_16x16x32_bf16 v[32:35], v[112:115], v[28:31], v[32:35]
    s_add_u32 m0, s37, 86016
    s_add_u32 s38, s36, 1536000
    buffer_load_dwordx4 v6, s[60:63], s38 offen lds
    ds_read_b64_tr_b16 v[112:113], v23 offset:45056
    ds_read_b64_tr_b16 v[114:115], v23 offset:46080
    ds_read_b64_tr_b16 v[116:117], v25 offset:45056
    ds_read_b64_tr_b16 v[118:119], v25 offset:46080
    ds_read_b128 v[128:131], v21 offset:32768
    ds_read_b128 v[132:135], v21 offset:36864
    s_waitcnt lgkmcnt(6)
    v_mfma_f32_32x32x16_bf16 v[40:55], v[120:123], v[104:107], v[40:55]
    v_mfma_f32_32x32x16_bf16 v[56:71], v[124:127], v[104:107], v[56:71]
    v_mfma_f32_32x32x16_bf16 v[72:87], v[120:123], v[108:111], v[72:87]
    v_mfma_f32_32x32x16_bf16 v[88:103], v[124:127], v[108:111], v[88:103]
    v_mfma_f32_16x16x32_bf16 v[32:35], v[104:107], v[28:31], v[32:35]
    s_add_u32 m0, s37, 90112
    s_add_u32 s38, s36, 1597440
    buffer_load_dwordx4 v6, s[60:63], s38 offen lds
    s_waitcnt lgkmcnt(0)
    s_waitcnt vmcnt(7)
    s_barrier
    ds_read_b64_tr_b16 v[104:105], v22 offset:0
    ds_read_b64_tr_b16 v[106:107], v22 offset:1024
    ds_read_b64_tr_b16 v[108:109], v24 offset:0
    ds_read_b64_tr_b16 v[110:111], v24 offset:1024
    ds_read_b128 v[120:123], v14 offset:0
    ds_read_b128 v[124:127], v14 offset:4096
    v_mfma_f32_32x32x16_bf16 v[40:55], v[128:131], v[112:115], v[40:55]
    v_mfma_f32_32x32x16_bf16 v[56:71], v[132:135], v[112:115], v[56:71]
    v_mfma_f32_32x32x16_bf16 v[72:87], v[128:131], v[116:119], v[72:87]
    v_mfma_f32_32x32x16_bf16 v[88:103], v[132:135], v[116:119], v[88:103]
    v_mfma_f32_16x16x32_bf16 v[32:35], v[112:115], v[28:31], v[32:35]
    s_add_u32 m0, s37, 94208
    s_add_u32 s38, s36, 1658880
    buffer_load_dwordx4 v6, s[60:63], s38 offen lds
    ds_read_b64_tr_b16 v[112:113], v22 offset:4096
    ds_read_b64_tr_b16 v[114:115], v22 offset:5120
    ds_read_b64_tr_b16 v[116:117], v24 offset:4096
    ds_read_b64_tr_b16 v[118:119], v24 offset:5120
    ds_read_b128 v[128:131], v15 offset:0
    ds_read_b128 v[132:135], v15 offset:4096
    s_waitcnt lgkmcnt(6)
    v_mfma_f32_32x32x16_bf16 v[40:55], v[120:123], v[104:107], v[40:55]
    v_mfma_f32_32x32x16_bf16 v[56:71], v[124:127], v[104:107], v[56:71]
    v_mfma_f32_32x32x16_bf16 v[72:87], v[120:123], v[108:111], v[72:87]
    v_mfma_f32_32x32x16_bf16 v[88:103], v[124:127], v[108:111], v[88:103]
    v_mfma_f32_16x16x32_bf16 v[32:35], v[104:107], v[28:31], v[32:35]
    s_add_u32 m0, s37, 114688
    s_add_u32 s38, s36, 1720320
    buffer_load_dwordx4 v6, s[60:63], s38 offen lds
    ds_read_b64_tr_b16 v[104:105], v22 offset:8192
    ds_read_b64_tr_b16 v[106:107], v22 offset:9216
    ds_read_b64_tr_b16 v[108:109], v24 offset:8192
    ds_read_b64_tr_b16 v[110:111], v24 offset:9216
    ds_read_b128 v[120:123], v16 offset:0
    ds_read_b128 v[124:127], v16 offset:4096
    s_waitcnt lgkmcnt(6)
    v_mfma_f32_32x32x16_bf16 v[40:55], v[128:131], v[112:115], v[40:55]
    v_mfma_f32_32x32x16_bf16 v[56:71], v[132:135], v[112:115], v[56:71]
    v_mfma_f32_32x32x16_bf16 v[72:87], v[128:131], v[116:119], v[72:87]
    v_mfma_f32_32x32x16_bf16 v[88:103], v[132:135], v[116:119], v[88:103]
    v_mfma_f32_16x16x32_bf16 v[32:35], v[112:115], v[28:31], v[32:35]
    s_add_u32 m0, s37, 118784
    s_add_u32 s38, s36, 1781760
    buffer_load_dwordx4 v6, s[60:63], s38 offen lds
    ds_read_b64_tr_b16 v[112:113], v22 offset:12288
    ds_read_b64_tr_b16 v[114:115], v22 offset:13312
    ds_read_b64_tr_b16 v[116:117], v24 offset:12288
    ds_read_b64_tr_b16 v[118:119], v24 offset:13312
    ds_read_b128 v[128:131], v17 offset:0
    ds_read_b128 v[132:135], v17 offset:4096
    s_waitcnt lgkmcnt(6)
    v_mfma_f32_32x32x16_bf16 v[40:55], v[120:123], v[104:107], v[40:55]
    v_mfma_f32_32x32x16_bf16 v[56:71], v[124:127], v[104:107], v[56:71]
    v_mfma_f32_32x32x16_bf16 v[72:87], v[120:123], v[108:111], v[72:87]
    v_mfma_f32_32x32x16_bf16 v[88:103], v[124:127], v[108:111], v[88:103]
    v_mfma_f32_16x16x32_bf16 v[32:35], v[104:107], v[28:31], v[32:35]
    s_add_u32 m0, s37, 122880
    s_add_u32 s38, s36, 1843200
    buffer_load_dwordx4 v6, s[60:63], s38 offen lds
    s_waitcnt lgkmcnt(0)
    s_waitcnt vmcnt(7)
    s_barrier
    ds_read_b64_tr_b16 v[104:105], v22 offset:32768
    ds_read_b64_tr_b16 v[106:107], v22 offset:33792
    ds_read_b64_tr_b16 v[108:109], v24 offset:32768
    ds_read_b64_tr_b16 v[110:111], v24 offset:33792
    ds_read_b128 v[120:123], v14 offset:32768
    ds_read_b128 v[124:127], v14 offset:36864
    v_mfma_f32_32x32x16_bf16 v[40:55], v[128:131], v[112:115], v[40:55]
    v_mfma_f32_32x32x16_bf16 v[56:71], v[132:135], v[112:115], v[56:71]
    v_mfma_f32_32x32x16_bf16 v[72:87], v[128:131], v[116:119], v[72:87]
    v_mfma_f32_32x32x16_bf16 v[88:103], v[132:135], v[116:119], v[88:103]
    v_mfma_f32_16x16x32_bf16 v[32:35], v[112:115], v[28:31], v[32:35]
    s_add_u32 m0, s37, 126976
    s_add_u32 s38, s36, 1904640
    buffer_load_dwordx4 v6, s[60:63], s38 offen lds
    ds_read_b64_tr_b16 v[112:113], v22 offset:36864
    ds_read_b64_tr_b16 v[114:115], v22 offset:37888
    ds_read_b64_tr_b16 v[116:117], v24 offset:36864
    ds_read_b64_tr_b16 v[118:119], v24 offset:37888
    ds_read_b128 v[128:131], v15 offset:32768
    ds_read_b128 v[132:135], v15 offset:36864
    s_waitcnt lgkmcnt(6)
    v_mfma_f32_32x32x16_bf16 v[40:55], v[120:123], v[104:107], v[40:55]
    v_mfma_f32_32x32x16_bf16 v[56:71], v[124:127], v[104:107], v[56:71]
    v_mfma_f32_32x32x16_bf16 v[72:87], v[120:123], v[108:111], v[72:87]
    v_mfma_f32_32x32x16_bf16 v[88:103], v[124:127], v[108:111], v[88:103]
    v_mfma_f32_16x16x32_bf16 v[32:35], v[104:107], v[28:31], v[32:35]
    s_add_u32 m0, s37, 16384
    s_add_u32 s38, s36, 1966080
    buffer_load_dwordx4 v6, s[60:63], s38 offen lds
    ds_read_b64_tr_b16 v[104:105], v22 offset:40960
    ds_read_b64_tr_b16 v[106:107], v22 offset:41984
    ds_read_b64_tr_b16 v[108:109], v24 offset:40960
    ds_read_b64_tr_b16 v[110:111], v24 offset:41984
    ds_read_b128 v[120:123], v16 offset:32768
    ds_read_b128 v[124:127], v16 offset:36864
    s_waitcnt lgkmcnt(6)
    v_mfma_f32_32x32x16_bf16 v[40:55], v[128:131], v[112:115], v[40:55]
    v_mfma_f32_32x32x16_bf16 v[56:71], v[132:135], v[112:115], v[56:71]
    v_mfma_f32_32x32x16_bf16 v[72:87], v[128:131], v[116:119], v[72:87]
    v_mfma_f32_32x32x16_bf16 v[88:103], v[132:135], v[116:119], v[88:103]
    v_mfma_f32_16x16x32_bf16 v[32:35], v[112:115], v[28:31], v[32:35]
    s_add_u32 m0, s37, 20480
    s_add_u32 s38, s36, 2027520
    buffer_load_dwordx4 v6, s[60:63], s38 offen lds
    ds_read_b64_tr_b16 v[112:113], v22 offset:45056
    ds_read_b64_tr_b16 v[114:115], v22 offset:46080
    ds_read_b64_tr_b16 v[116:117], v24 offset:45056
    ds_read_b64_tr_b16 v[118:119], v24 offset:46080
    ds_read_b128 v[128:131], v17 offset:32768
    ds_read_b128 v[132:135], v17 offset:36864
    s_waitcnt lgkmcnt(6)
    v_mfma_f32_32x32x16_bf16 v[40:55], v[120:123], v[104:107], v[40:55]
    v_mfma_f32_32x32x16_bf16 v[56:71], v[124:127], v[104:107], v[56:71]
    v_mfma_f32_32x32x16_bf16 v[72:87], v[120:123], v[108:111], v[72:87]
    v_mfma_f32_32x32x16_bf16 v[88:103], v[124:127], v[108:111], v[88:103]
    v_mfma_f32_16x16x32_bf16 v[32:35], v[104:107], v[28:31], v[32:35]
    s_add_u32 m0, s37, 24576
    s_add_u32 s38, s36, 2088960
    buffer_load_dwordx4 v6, s[60:63], s38 offen lds
    s_waitcnt lgkmcnt(0)
    s_waitcnt vmcnt(7)
    s_barrier
    ds_read_b64_tr_b16 v[104:105], v23 offset:0
    ds_read_b64_tr_b16 v[106:107], v23 offset:1024
    ds_read_b64_tr_b16 v[108:109], v25 offset:0
    ds_read_b64_tr_b16 v[110:111], v25 offset:1024
    ds_read_b128 v[120:123], v18 offset:0
    ds_read_b128 v[124:127], v18 offset:4096
    v_mfma_f32_32x32x16_bf16 v[40:55], v[128:131], v[112:115], v[40:55]
    v_mfma_f32_32x32x16_bf16 v[56:71], v[132:135], v[112:115], v[56:71]
    v_mfma_f32_32x32x16_bf16 v[72:87], v[128:131], v[116:119], v[72:87]
    v_mfma_f32_32x32x16_bf16 v[88:103], v[132:135], v[116:119], v[88:103]
    v_mfma_f32_16x16x32_bf16 v[32:35], v[112:115], v[28:31], v[32:35]
    s_add_u32 m0, s37, 28672
    s_add_u32 s38, s36, 2150400
    buffer_load_dwordx4 v6, s[60:63], s38 offen lds
    ds_read_b64_tr_b16 v[112:113], v23 offset:4096
    ds_read_b64_tr_b16 v[114:115], v23 offset:5120
    ds_read_b64_tr_b16 v[116:117], v25 offset:4096
    ds_read_b64_tr_b16 v[118:119], v25 offset:5120
    ds_read_b128 v[128:131], v19 offset:0
    ds_read_b128 v[132:135], v19 offset:4096
    s_waitcnt lgkmcnt(6)
    v_mfma_f32_32x32x16_bf16 v[40:55], v[120:123], v[104:107], v[40:55]
    v_mfma_f32_32x32x16_bf16 v[56:71], v[124:127], v[104:107], v[56:71]
    v_mfma_f32_32x32x16_bf16 v[72:87], v[120:123], v[108:111], v[72:87]
    v_mfma_f32_32x32x16_bf16 v[88:103], v[124:127], v[108:111], v[88:103]
    v_mfma_f32_16x16x32_bf16 v[32:35], v[104:107], v[28:31], v[32:35]
    s_add_u32 m0, s37, 49152
    s_add_u32 s38, s36, 2211840
    buffer_load_dwordx4 v6, s[60:63], s38 offen lds
    ds_read_b64_tr_b16 v[104:105], v23 offset:8192
    ds_read_b64_tr_b16 v[106:107], v23 offset:9216
    ds_read_b64_tr_b16 v[108:109], v25 offset:8192
    ds_read_b64_tr_b16 v[110:111], v25 offset:9216
    ds_read_b128 v[120:123], v20 offset:0
    ds_read_b128 v[124:127], v20 offset:4096
    s_waitcnt lgkmcnt(6)
    v_mfma_f32_32x32x16_bf16 v[40:55], v[128:131], v[112:115], v[40:55]
    v_mfma_f32_32x32x16_bf16 v[56:71], v[132:135], v[112:115], v[56:71]
    v_mfma_f32_32x32x16_bf16 v[72:87], v[128:131], v[116:119], v[72:87]
    v_mfma_f32_32x32x16_bf16 v[88:103], v[132:135], v[116:119], v[88:103]
    v_mfma_f32_16x16x32_bf16 v[32:35], v[112:115], v[28:31], v[32:35]
    s_add_u32 m0, s37, 53248
    s_add_u32 s38, s36, 2273280
    buffer_load_dwordx4 v6, s[60:63], s38 offen lds
    ds_read_b64_tr_b16 v[112:113], v23 offset:12288
    ds_read_b64_tr_b16 v[114:115], v23 offset:13312
    ds_read_b64_tr_b16 v[116:117], v25 offset:12288
    ds_read_b64_tr_b16 v[118:119], v25 offset:13312
    ds_read_b128 v[128:131], v21 offset:0
    ds_read_b128 v[132:135], v21 offset:4096
    s_waitcnt lgkmcnt(6)
    v_mfma_f32_32x32x16_bf16 v[40:55], v[120:123], v[104:107], v[40:55]
    v_mfma_f32_32x32x16_bf16 v[56:71], v[124:127], v[104:107], v[56:71]
    v_mfma_f32_32x32x16_bf16 v[72:87], v[120:123], v[108:111], v[72:87]
    v_mfma_f32_32x32x16_bf16 v[88:103], v[124:127], v[108:111], v[88:103]
    v_mfma_f32_16x16x32_bf16 v[32:35], v[104:107], v[28:31], v[32:35]
    s_add_u32 m0, s37, 57344
    s_add_u32 s38, s36, 2334720
    buffer_load_dwordx4 v6, s[60:63], s38 offen lds
    s_waitcnt lgkmcnt(0)
    s_waitcnt vmcnt(7)
    s_barrier
    ds_read_b64_tr_b16 v[104:105], v23 offset:32768
    ds_read_b64_tr_b16 v[106:107], v23 offset:33792
    ds_read_b64_tr_b16 v[108:109], v25 offset:32768
    ds_read_b64_tr_b16 v[110:111], v25 offset:33792
    ds_read_b128 v[120:123], v18 offset:32768
    ds_read_b128 v[124:127], v18 offset:36864
    v_mfma_f32_32x32x16_bf16 v[40:55], v[128:131], v[112:115], v[40:55]
    v_mfma_f32_32x32x16_bf16 v[56:71], v[132:135], v[112:115], v[56:71]
    v_mfma_f32_32x32x16_bf16 v[72:87], v[128:131], v[116:119], v[72:87]
    v_mfma_f32_32x32x16_bf16 v[88:103], v[132:135], v[116:119], v[88:103]
    v_mfma_f32_16x16x32_bf16 v[32:35], v[112:115], v[28:31], v[32:35]
    s_add_u32 m0, s37, 61440
    s_add_u32 s38, s36, 2396160
    buffer_load_dwordx4 v6, s[60:63], s38 offen lds
    ds_read_b64_tr_b16 v[140:141], v12 offset:0
    ds_read_b64_tr_b16 v[142:143], v12 offset:512
    ds_read_b64_tr_b16 v[112:113], v23 offset:36864
    ds_read_b64_tr_b16 v[114:115], v23 offset:37888
    ds_read_b64_tr_b16 v[116:117], v25 offset:36864
    ds_read_b64_tr_b16 v[118:119], v25 offset:37888
    ds_read_b128 v[128:131], v19 offset:32768
    ds_read_b128 v[132:135], v19 offset:36864
    s_waitcnt lgkmcnt(8)
    v_mfma_f32_32x32x16_bf16 v[40:55], v[120:123], v[104:107], v[40:55]
    v_mfma_f32_32x32x16_bf16 v[56:71], v[124:127], v[104:107], v[56:71]
    v_mfma_f32_32x32x16_bf16 v[72:87], v[120:123], v[108:111], v[72:87]
    v_mfma_f32_32x32x16_bf16 v[88:103], v[124:127], v[108:111], v[88:103]
    v_mfma_f32_16x16x32_bf16 v[32:35], v[104:107], v[28:31], v[32:35]
    ds_read_b64_tr_b16 v[104:105], v23 offset:40960
    ds_read_b64_tr_b16 v[106:107], v23 offset:41984
    ds_read_b64_tr_b16 v[108:109], v25 offset:40960
    ds_read_b64_tr_b16 v[110:111], v25 offset:41984
    ds_read_b128 v[120:123], v20 offset:32768
    ds_read_b128 v[124:127], v20 offset:36864
    s_waitcnt lgkmcnt(6)
    v_mfma_f32_32x32x16_bf16 v[40:55], v[128:131], v[112:115], v[40:55]
    v_mfma_f32_32x32x16_bf16 v[56:71], v[132:135], v[112:115], v[56:71]
    v_mfma_f32_32x32x16_bf16 v[72:87], v[128:131], v[116:119], v[72:87]
    v_mfma_f32_32x32x16_bf16 v[88:103], v[132:135], v[116:119], v[88:103]
    v_mfma_f32_16x16x32_bf16 v[32:35], v[112:115], v[28:31], v[32:35]
    s_add_u32 s49, s54, 0
    buffer_store_dwordx4 v[140:143], v10, s[8:11], s49 offen sc1
    v_mfma_f32_16x16x32_bf16 v[152:155], v[140:143], v[156:159], v[152:155]
    ds_read_b64_tr_b16 v[140:141], v12 offset:4096
    ds_read_b64_tr_b16 v[142:143], v12 offset:4608
    ds_read_b64_tr_b16 v[112:113], v23 offset:45056
    ds_read_b64_tr_b16 v[114:115], v23 offset:46080
    ds_read_b64_tr_b16 v[116:117], v25 offset:45056
    ds_read_b64_tr_b16 v[118:119], v25 offset:46080
    ds_read_b128 v[128:131], v21 offset:32768
    ds_read_b128 v[132:135], v21 offset:36864
    s_waitcnt lgkmcnt(8)
    v_mfma_f32_32x32x16_bf16 v[40:55], v[120:123], v[104:107], v[40:55]
    v_mfma_f32_32x32x16_bf16 v[56:71], v[124:127], v[104:107], v[56:71]
    v_mfma_f32_32x32x16_bf16 v[72:87], v[120:123], v[108:111], v[72:87]
    v_mfma_f32_32x32x16_bf16 v[88:103], v[124:127], v[108:111], v[88:103]
    v_mfma_f32_16x16x32_bf16 v[32:35], v[104:107], v[28:31], v[32:35]
    s_waitcnt lgkmcnt(0)
    s_waitcnt vmcnt(5)
    s_barrier
    ds_read_b64_tr_b16 v[104:105], v22 offset:0
    ds_read_b64_tr_b16 v[106:107], v22 offset:1024
    ds_read_b64_tr_b16 v[108:109], v24 offset:0
    ds_read_b64_tr_b16 v[110:111], v24 offset:1024
    ds_read_b128 v[120:123], v14 offset:0
    ds_read_b128 v[124:127], v14 offset:4096
    v_mfma_f32_32x32x16_bf16 v[40:55], v[128:131], v[112:115], v[40:55]
    v_mfma_f32_32x32x16_bf16 v[56:71], v[132:135], v[112:115], v[56:71]
    v_mfma_f32_32x32x16_bf16 v[72:87], v[128:131], v[116:119], v[72:87]
    v_mfma_f32_32x32x16_bf16 v[88:103], v[132:135], v[116:119], v[88:103]
    v_mfma_f32_16x16x32_bf16 v[32:35], v[112:115], v[28:31], v[32:35]
    s_add_u32 s49, s54, 1024
    buffer_store_dwordx4 v[140:143], v10, s[8:11], s49 offen sc1
    v_mfma_f32_16x16x32_bf16 v[152:155], v[140:143], v[156:159], v[152:155]
    ds_read_b64_tr_b16 v[140:141], v12 offset:8192
    ds_read_b64_tr_b16 v[142:143], v12 offset:8704
    ds_read_b64_tr_b16 v[112:113], v22 offset:4096
    ds_read_b64_tr_b16 v[114:115], v22 offset:5120
    ds_read_b64_tr_b16 v[116:117], v24 offset:4096
    ds_read_b64_tr_b16 v[118:119], v24 offset:5120
    ds_read_b128 v[128:131], v15 offset:0
    ds_read_b128 v[132:135], v15 offset:4096
    s_waitcnt lgkmcnt(8)
    v_mfma_f32_32x32x16_bf16 v[40:55], v[120:123], v[104:107], v[40:55]
    v_mfma_f32_32x32x16_bf16 v[56:71], v[124:127], v[104:107], v[56:71]
    v_mfma_f32_32x32x16_bf16 v[72:87], v[120:123], v[108:111], v[72:87]
    v_mfma_f32_32x32x16_bf16 v[88:103], v[124:127], v[108:111], v[88:103]
    v_mfma_f32_16x16x32_bf16 v[32:35], v[104:107], v[28:31], v[32:35]
    ds_read_b64_tr_b16 v[104:105], v22 offset:8192
    ds_read_b64_tr_b16 v[106:107], v22 offset:9216
    ds_read_b64_tr_b16 v[108:109], v24 offset:8192
    ds_read_b64_tr_b16 v[110:111], v24 offset:9216
    ds_read_b128 v[120:123], v16 offset:0
    ds_read_b128 v[124:127], v16 offset:4096
    s_waitcnt lgkmcnt(6)
    v_mfma_f32_32x32x16_bf16 v[40:55], v[128:131], v[112:115], v[40:55]
    v_mfma_f32_32x32x16_bf16 v[56:71], v[132:135], v[112:115], v[56:71]
    v_mfma_f32_32x32x16_bf16 v[72:87], v[128:131], v[116:119], v[72:87]
    v_mfma_f32_32x32x16_bf16 v[88:103], v[132:135], v[116:119], v[88:103]
    v_mfma_f32_16x16x32_bf16 v[32:35], v[112:115], v[28:31], v[32:35]
    s_add_u32 s49, s54, 2048
    buffer_store_dwordx4 v[140:143], v10, s[8:11], s49 offen sc1
    v_mfma_f32_16x16x32_bf16 v[152:155], v[140:143], v[156:159], v[152:155]
    ds_read_b64_tr_b16 v[140:141], v12 offset:12288
    ds_read_b64_tr_b16 v[142:143], v12 offset:12800
    ds_read_b64_tr_b16 v[112:113], v22 offset:12288
    ds_read_b64_tr_b16 v[114:115], v22 offset:13312
    ds_read_b64_tr_b16 v[116:117], v24 offset:12288
    ds_read_b64_tr_b16 v[118:119], v24 offset:13312
    ds_read_b128 v[128:131], v17 offset:0
    ds_read_b128 v[132:135], v17 offset:4096
    s_waitcnt lgkmcnt(8)
    v_mfma_f32_32x32x16_bf16 v[40:55], v[120:123], v[104:107], v[40:55]
    v_mfma_f32_32x32x16_bf16 v[56:71], v[124:127], v[104:107], v[56:71]
    v_mfma_f32_32x32x16_bf16 v[72:87], v[120:123], v[108:111], v[72:87]
    v_mfma_f32_32x32x16_bf16 v[88:103], v[124:127], v[108:111], v[88:103]
    v_mfma_f32_16x16x32_bf16 v[32:35], v[104:107], v[28:31], v[32:35]
    s_waitcnt lgkmcnt(0)
    s_waitcnt vmcnt(3)
    s_barrier
    ds_read_b64_tr_b16 v[104:105], v22 offset:32768
    ds_read_b64_tr_b16 v[106:107], v22 offset:33792
    ds_read_b64_tr_b16 v[108:109], v24 offset:32768
    ds_read_b64_tr_b16 v[110:111], v24 offset:33792
    ds_read_b128 v[120:123], v14 offset:32768
    ds_read_b128 v[124:127], v14 offset:36864
    v_mfma_f32_32x32x16_bf16 v[40:55], v[128:131], v[112:115], v[40:55]
    v_mfma_f32_32x32x16_bf16 v[56:71], v[132:135], v[112:115], v[56:71]
    v_mfma_f32_32x32x16_bf16 v[72:87], v[128:131], v[116:119], v[72:87]
    v_mfma_f32_32x32x16_bf16 v[88:103], v[132:135], v[116:119], v[88:103]
    v_mfma_f32_16x16x32_bf16 v[32:35], v[112:115], v[28:31], v[32:35]
    s_add_u32 s49, s54, 3072
    buffer_store_dwordx4 v[140:143], v10, s[8:11], s49 offen sc1
    v_mfma_f32_16x16x32_bf16 v[152:155], v[140:143], v[156:159], v[152:155]
    ds_read_b64_tr_b16 v[140:141], v12 offset:16384
    ds_read_b64_tr_b16 v[142:143], v12 offset:16896
    ds_read_b64_tr_b16 v[112:113], v22 offset:36864
    ds_read_b64_tr_b16 v[114:115], v22 offset:37888
    ds_read_b64_tr_b16 v[116:117], v24 offset:36864
    ds_read_b64_tr_b16 v[118:119], v24 offset:37888
    ds_read_b128 v[128:131], v15 offset:32768
    ds_read_b128 v[132:135], v15 offset:36864
    s_waitcnt lgkmcnt(8)
    v_mfma_f32_32x32x16_bf16 v[40:55], v[120:123], v[104:107], v[40:55]
    v_mfma_f32_32x32x16_bf16 v[56:71], v[124:127], v[104:107], v[56:71]
    v_mfma_f32_32x32x16_bf16 v[72:87], v[120:123], v[108:111], v[72:87]
    v_mfma_f32_32x32x16_bf16 v[88:103], v[124:127], v[108:111], v[88:103]
    v_mfma_f32_16x16x32_bf16 v[32:35], v[104:107], v[28:31], v[32:35]
    ds_read_b64_tr_b16 v[104:105], v22 offset:40960
    ds_read_b64_tr_b16 v[106:107], v22 offset:41984
    ds_read_b64_tr_b16 v[108:109], v24 offset:40960
    ds_read_b64_tr_b16 v[110:111], v24 offset:41984
    ds_read_b128 v[120:123], v16 offset:32768
    ds_read_b128 v[124:127], v16 offset:36864
    s_waitcnt lgkmcnt(6)
    v_mfma_f32_32x32x16_bf16 v[40:55], v[128:131], v[112:115], v[40:55]
    v_mfma_f32_32x32x16_bf16 v[56:71], v[132:135], v[112:115], v[56:71]
    v_mfma_f32_32x32x16_bf16 v[72:87], v[128:131], v[116:119], v[72:87]
    v_mfma_f32_32x32x16_bf16 v[88:103], v[132:135], v[116:119], v[88:103]
    v_mfma_f32_16x16x32_bf16 v[32:35], v[112:115], v[28:31], v[32:35]
    s_add_u32 s49, s54, 4096
    buffer_store_dwordx4 v[140:143], v10, s[8:11], s49 offen sc1
    v_mfma_f32_16x16x32_bf16 v[152:155], v[140:143], v[156:159], v[152:155]
    ds_read_b64_tr_b16 v[140:141], v12 offset:20480
    ds_read_b64_tr_b16 v[142:143], v12 offset:20992
    ds_read_b64_tr_b16 v[112:113], v22 offset:45056
    ds_read_b64_tr_b16 v[114:115], v22 offset:46080
    ds_read_b64_tr_b16 v[116:117], v24 offset:45056
    ds_read_b64_tr_b16 v[118:119], v24 offset:46080
    ds_read_b128 v[128:131], v17 offset:32768
    ds_read_b128 v[132:135], v17 offset:36864
    s_waitcnt lgkmcnt(8)
    v_mfma_f32_32x32x16_bf16 v[40:55], v[120:123], v[104:107], v[40:55]
    v_mfma_f32_32x32x16_bf16 v[56:71], v[124:127], v[104:107], v[56:71]
    v_mfma_f32_32x32x16_bf16 v[72:87], v[120:123], v[108:111], v[72:87]
    v_mfma_f32_32x32x16_bf16 v[88:103], v[124:127], v[108:111], v[88:103]
    v_mfma_f32_16x16x32_bf16 v[32:35], v[104:107], v[28:31], v[32:35]
    s_waitcnt lgkmcnt(0)
    v_mfma_f32_32x32x16_bf16 v[40:55], v[128:131], v[112:115], v[40:55]
    v_mfma_f32_32x32x16_bf16 v[56:71], v[132:135], v[112:115], v[56:71]
    v_mfma_f32_32x32x16_bf16 v[72:87], v[128:131], v[116:119], v[72:87]
    v_mfma_f32_32x32x16_bf16 v[88:103], v[132:135], v[116:119], v[88:103]
    v_mfma_f32_16x16x32_bf16 v[32:35], v[112:115], v[28:31], v[32:35]
    s_add_u32 s49, s55, 5120
    buffer_store_dwordx4 v[140:143], v10, s[8:11], s49 offen sc1
    s_sub_u32 s40, s2, 40
    s_mul_i32 s58, s46, 6912
    s_lshl_b32 s59, s47, 8
    s_add_u32 s58, s58, s59
    s_lshl_b32 s59, s23, 6
    s_add_u32 s58, s58, s59
    s_add_u32 s58, s58, 30507008
    s_cmp_lt_u32 s40, 108
    s_cselect_b32 s58, s58, 0x7ff00000
    v_lshrrev_b32 v11, 4, v2
    v_lshlrev_b32 v11, 4, v11
    s_mov_b32 s52, 0x00010001
    s_mov_b32 s53, 0x00010001
    s_mov_b64 exec, s[52:53]
    buffer_store_dwordx4 v[152:155], v11, s[8:11], s58 offen sc1
    s_mov_b64 exec, -1
    s_lshl_b32 s40, s56, 7
    s_add_u32 s40, s40, 156672
    v_and_b32 v8, 1, v2
    v_lshlrev_b32 v8, 6, v8
    v_lshrrev_b32 v9, 4, v2
    v_lshl_add_u32 v8, v9, 4, v8
    v_add_u32 v8, s40, v8
    s_mov_b32 s52, 0x00030003
    s_mov_b32 s53, 0x00030003
    s_nop 7
    s_mov_b64 exec, s[52:53]
    ds_write_b128 v8, v[32:35]
    s_mov_b64 exec, -1
    s_waitcnt lgkmcnt(0)
    s_barrier
    s_lshl_b32 s40, s56, 7
    s_add_u32 s40, s40, 156672
    v_lshlrev_b32 v8, 2, v3
    v_add_u32 v8, s40, v8
    ds_read_b32 v136, v8
    s_lshl_b32 s40, s57, 7
    s_add_u32 s40, s40, 156672
    v_lshlrev_b32 v8, 2, v3
    v_add_u32 v8, s40, v8
    ds_read_b32 v137, v8
    s_lshl_b32 s40, s22, 8
    s_add_u32 s40, s40, 155648
    v_lshlrev_b32 v7, 4, v4
    v_add_u32 v7, s40, v7
    s_sub_u32 s17, s14, 10
    s_lshl_b32 s17, s17, 7
    s_lshl_b32 s18, s56, 5
    s_add_u32 s17, s17, s18
    v_add_u32 v13, s17, v3
    s_mov_b32 s17, 214748365
    v_mul_hi_u32 v14, v13, s17
    v_mul_u32_u24 v15, 20, v14
    v_sub_u32 v15, v13, v15
    s_mov_b32 s17, 81920
    v_mul_lo_u32 v14, v14, s17
    v_lshl_add_u32 v14, v15, 4, v14
    v_mul_u32_u24 v15, 320, v4
    v_add_u32 v138, v14, v15
    s_sub_u32 s17, s14, 10
    s_lshl_b32 s17, s17, 7
    s_lshl_b32 s18, s57, 5
    s_add_u32 s17, s17, s18
    v_add_u32 v13, s17, v3
    s_mov_b32 s17, 214748365
    v_mul_hi_u32 v14, v13, s17
    v_mul_u32_u24 v15, 20, v14
    v_sub_u32 v15, v13, v15
    s_mov_b32 s17, 81920
    v_mul_lo_u32 v14, v14, s17
    v_lshl_add_u32 v14, v15, 4, v14
    v_mul_u32_u24 v15, 320, v4
    v_add_u32 v139, v14, v15
    s_lshl_b32 s17, s13, 3
    s_lshl_b32 s18, s22, 2
    s_add_u32 s17, s17, s18
    s_mul_i32 s17, s17, 640
    s_add_u32 s17, s17, 15564800
    ds_read_b128 v[104:107], v7 offset:0
    ds_read_b128 v[120:123], v7 offset:512
    ds_read_b128 v[108:111], v7 offset:32
    ds_read_b128 v[124:127], v7 offset:544
    ds_read_b128 v[112:115], v7 offset:64
    ds_read_b128 v[128:131], v7 offset:576
    ds_read_b128 v[116:119], v7 offset:96
    ds_read_b128 v[132:135], v7 offset:608
    s_waitcnt lgkmcnt(0)
    v_mul_f32 v140, v104, v136
    v_fma_f32 v40, v120, v40, -v140
    v_mul_f32 v140, v105, v136
    v_fma_f32 v41, v121, v41, -v140
    v_mul_f32 v140, v106, v136
    v_fma_f32 v42, v122, v42, -v140
    v_mul_f32 v140, v107, v136
    v_fma_f32 v43, v123, v43, -v140
    v_mul_f32 v140, v108, v136
    v_fma_f32 v44, v124, v44, -v140
    v_mul_f32 v140, v109, v136
    v_fma_f32 v45, v125, v45, -v140
    v_mul_f32 v140, v110, v136
    v_fma_f32 v46, v126, v46, -v140
    v_mul_f32 v140, v111, v136
    v_fma_f32 v47, v127, v47, -v140
    v_mul_f32 v140, v112, v136
    v_fma_f32 v48, v128, v48, -v140
    v_mul_f32 v140, v113, v136
    v_fma_f32 v49, v129, v49, -v140
    v_mul_f32 v140, v114, v136
    v_fma_f32 v50, v130, v50, -v140
    v_mul_f32 v140, v115, v136
    v_fma_f32 v51, v131, v51, -v140
    v_mul_f32 v140, v116, v136
    v_fma_f32 v52, v132, v52, -v140
    v_mul_f32 v140, v117, v136
    v_fma_f32 v53, v133, v53, -v140
    v_mul_f32 v140, v118, v136
    v_fma_f32 v54, v134, v54, -v140
    v_mul_f32 v140, v119, v136
    v_fma_f32 v55, v135, v55, -v140
    v_cvt_pk_bf16_f32 v144, v40, v41
    v_cvt_pk_bf16_f32 v145, v42, v43
    v_cvt_pk_bf16_f32 v146, v44, v45
    v_cvt_pk_bf16_f32 v147, v46, v47
    v_cvt_pk_bf16_f32 v148, v48, v49
    v_cvt_pk_bf16_f32 v149, v50, v51
    v_cvt_pk_bf16_f32 v150, v52, v53
    v_cvt_pk_bf16_f32 v151, v54, v55
    buffer_store_dwordx4 v[144:147], v138, s[8:11], s17 offen offset:0 sc1
    buffer_store_dwordx4 v[148:151], v138, s[8:11], s17 offen offset:640 sc1
    v_mul_f32 v140, v104, v137
    v_fma_f32 v72, v120, v72, -v140
    v_mul_f32 v140, v105, v137
    v_fma_f32 v73, v121, v73, -v140
    v_mul_f32 v140, v106, v137
    v_fma_f32 v74, v122, v74, -v140
    v_mul_f32 v140, v107, v137
    v_fma_f32 v75, v123, v75, -v140
    v_mul_f32 v140, v108, v137
    v_fma_f32 v76, v124, v76, -v140
    v_mul_f32 v140, v109, v137
    v_fma_f32 v77, v125, v77, -v140
    v_mul_f32 v140, v110, v137
    v_fma_f32 v78, v126, v78, -v140
    v_mul_f32 v140, v111, v137
    v_fma_f32 v79, v127, v79, -v140
    v_mul_f32 v140, v112, v137
    v_fma_f32 v80, v128, v80, -v140
    v_mul_f32 v140, v113, v137
    v_fma_f32 v81, v129, v81, -v140
    v_mul_f32 v140, v114, v137
    v_fma_f32 v82, v130, v82, -v140
    v_mul_f32 v140, v115, v137
    v_fma_f32 v83, v131, v83, -v140
    v_mul_f32 v140, v116, v137
    v_fma_f32 v84, v132, v84, -v140
    v_mul_f32 v140, v117, v137
    v_fma_f32 v85, v133, v85, -v140
    v_mul_f32 v140, v118, v137
    v_fma_f32 v86, v134, v86, -v140
    v_mul_f32 v140, v119, v137
    v_fma_f32 v87, v135, v87, -v140
    v_cvt_pk_bf16_f32 v152, v72, v73
    v_cvt_pk_bf16_f32 v153, v74, v75
    v_cvt_pk_bf16_f32 v154, v76, v77
    v_cvt_pk_bf16_f32 v155, v78, v79
    v_cvt_pk_bf16_f32 v156, v80, v81
    v_cvt_pk_bf16_f32 v157, v82, v83
    v_cvt_pk_bf16_f32 v158, v84, v85
    v_cvt_pk_bf16_f32 v159, v86, v87
    buffer_store_dwordx4 v[152:155], v139, s[8:11], s17 offen offset:0 sc1
    buffer_store_dwordx4 v[156:159], v139, s[8:11], s17 offen offset:640 sc1
    ds_read_b128 v[104:107], v7 offset:128
    ds_read_b128 v[120:123], v7 offset:640
    ds_read_b128 v[108:111], v7 offset:160
    ds_read_b128 v[124:127], v7 offset:672
    ds_read_b128 v[112:115], v7 offset:192
    ds_read_b128 v[128:131], v7 offset:704
    ds_read_b128 v[116:119], v7 offset:224
    ds_read_b128 v[132:135], v7 offset:736
    s_waitcnt lgkmcnt(0)
    v_mul_f32 v140, v104, v136
    v_fma_f32 v56, v120, v56, -v140
    v_mul_f32 v140, v105, v136
    v_fma_f32 v57, v121, v57, -v140
    v_mul_f32 v140, v106, v136
    v_fma_f32 v58, v122, v58, -v140
    v_mul_f32 v140, v107, v136
    v_fma_f32 v59, v123, v59, -v140
    v_mul_f32 v140, v108, v136
    v_fma_f32 v60, v124, v60, -v140
    v_mul_f32 v140, v109, v136
    v_fma_f32 v61, v125, v61, -v140
    v_mul_f32 v140, v110, v136
    v_fma_f32 v62, v126, v62, -v140
    v_mul_f32 v140, v111, v136
    v_fma_f32 v63, v127, v63, -v140
    v_mul_f32 v140, v112, v136
    v_fma_f32 v64, v128, v64, -v140
    v_mul_f32 v140, v113, v136
    v_fma_f32 v65, v129, v65, -v140
    v_mul_f32 v140, v114, v136
    v_fma_f32 v66, v130, v66, -v140
    v_mul_f32 v140, v115, v136
    v_fma_f32 v67, v131, v67, -v140
    v_mul_f32 v140, v116, v136
    v_fma_f32 v68, v132, v68, -v140
    v_mul_f32 v140, v117, v136
    v_fma_f32 v69, v133, v69, -v140
    v_mul_f32 v140, v118, v136
    v_fma_f32 v70, v134, v70, -v140
    v_mul_f32 v140, v119, v136
    v_fma_f32 v71, v135, v71, -v140
    v_cvt_pk_bf16_f32 v144, v56, v57
    v_cvt_pk_bf16_f32 v145, v58, v59
    v_cvt_pk_bf16_f32 v146, v60, v61
    v_cvt_pk_bf16_f32 v147, v62, v63
    v_cvt_pk_bf16_f32 v148, v64, v65
    v_cvt_pk_bf16_f32 v149, v66, v67
    v_cvt_pk_bf16_f32 v150, v68, v69
    v_cvt_pk_bf16_f32 v151, v70, v71
    buffer_store_dwordx4 v[144:147], v138, s[8:11], s17 offen offset:1280 sc1
    buffer_store_dwordx4 v[148:151], v138, s[8:11], s17 offen offset:1920 sc1
    v_mul_f32 v140, v104, v137
    v_fma_f32 v88, v120, v88, -v140
    v_mul_f32 v140, v105, v137
    v_fma_f32 v89, v121, v89, -v140
    v_mul_f32 v140, v106, v137
    v_fma_f32 v90, v122, v90, -v140
    v_mul_f32 v140, v107, v137
    v_fma_f32 v91, v123, v91, -v140
    v_mul_f32 v140, v108, v137
    v_fma_f32 v92, v124, v92, -v140
    v_mul_f32 v140, v109, v137
    v_fma_f32 v93, v125, v93, -v140
    v_mul_f32 v140, v110, v137
    v_fma_f32 v94, v126, v94, -v140
    v_mul_f32 v140, v111, v137
    v_fma_f32 v95, v127, v95, -v140
    v_mul_f32 v140, v112, v137
    v_fma_f32 v96, v128, v96, -v140
    v_mul_f32 v140, v113, v137
    v_fma_f32 v97, v129, v97, -v140
    v_mul_f32 v140, v114, v137
    v_fma_f32 v98, v130, v98, -v140
    v_mul_f32 v140, v115, v137
    v_fma_f32 v99, v131, v99, -v140
    v_mul_f32 v140, v116, v137
    v_fma_f32 v100, v132, v100, -v140
    v_mul_f32 v140, v117, v137
    v_fma_f32 v101, v133, v101, -v140
    v_mul_f32 v140, v118, v137
    v_fma_f32 v102, v134, v102, -v140
    v_mul_f32 v140, v119, v137
    v_fma_f32 v103, v135, v103, -v140
    v_cvt_pk_bf16_f32 v152, v88, v89
    v_cvt_pk_bf16_f32 v153, v90, v91
    v_cvt_pk_bf16_f32 v154, v92, v93
    v_cvt_pk_bf16_f32 v155, v94, v95
    v_cvt_pk_bf16_f32 v156, v96, v97
    v_cvt_pk_bf16_f32 v157, v98, v99
    v_cvt_pk_bf16_f32 v158, v100, v101
    v_cvt_pk_bf16_f32 v159, v102, v103
    buffer_store_dwordx4 v[152:155], v139, s[8:11], s17 offen offset:1280 sc1
    buffer_store_dwordx4 v[156:159], v139, s[8:11], s17 offen offset:1920 sc1
k1_kernel_end:
    s_endpgm

.globl kf_kernel
.p2align 8
.type kf_kernel,@function
kf_kernel:
    s_cmp_ge_u32 s2, 256
    s_cbranch_scc1 kf_kernel_end
    s_getpc_b64 s[40:41]
.Lpc_kf:
    s_sub_u32 s40, s40, (.Lpc_kf - kf_kernel)
    s_subb_u32 s41, s41, 0
    v_lshlrev_b32 v144, 6, v0
    s_mov_b32 s42, (.Lkf_last - kf_kernel - 4)
    v_add_u32 v146, 0, v144
    v_min_u32 v146, s42, v146
    v_mov_b32 v147, s41
    v_add_co_u32 v146, vcc, s40, v146
    s_nop 1
    v_addc_co_u32 v147, vcc, 0, v147, vcc
    global_load_dword v151, v[146:147], off
    v_add_u32 v146, 32768, v144
    v_min_u32 v146, s42, v146
    v_mov_b32 v147, s41
    v_add_co_u32 v146, vcc, s40, v146
    s_nop 1
    v_addc_co_u32 v147, vcc, 0, v147, vcc
    global_load_dword v151, v[146:147], off
    s_load_dwordx2 s[4:5], s[0:1], 80
    s_load_dwordx2 s[68:69], s[0:1], 0
    s_load_dwordx2 s[70:71], s[0:1], 64
    s_and_b32 s64, s2, 7
    s_lshr_b32 s65, s2, 3
    s_mov_b32 s36, s65
    s_mov_b32 s37, s64
    v_lshrrev_b32 v1, 6, v0
    v_and_b32 v2, 63, v0
    v_readfirstlane_b32 s12, v1
    v_and_b32 v3, 31, v2
    v_lshrrev_b32 v4, 5, v2
    s_getreg_b32 s66, hwreg(HW_REG_XCC_ID, 0, 4)
    s_add_u32 s66, s66, 1
    s_lshr_b32 s40, s36, 1
    s_and_b32 s41, s36, 1
    s_mul_i32 s42, s40, 5
    s_add_u32 s43, s42, 2
    s_mul_i32 s44, s41, 3
    s_add_u32 s42, s42, s44
    s_and_b32 s45, s12, 3
    s_lshr_b32 s46, s12, 2
    v_lshrrev_b32 v5, 4, v3
    s_movk_i32 s47, 20480
    v_mul_lo_u32 v5, v5, s47
    v_and_b32 v6, 15, v3
    v_lshl_add_u32 v5, v6, 4, v5
    v_lshl_add_u32 v7, v4, 8, v5
    s_lshl_b32 s47, s37, 4
    s_lshl_b32 s48, s45, 2
    s_add_u32 s47, s47, s48
    s_mul_i32 s47, s47, 20480
    s_add_u32 s48, s47, 10321920
    s_lshl_b32 s49, s42, 8
    s_add_u32 s49, s49, s48
    s_lshl_b32 s50, s43, 8
    s_add_u32 s50, s50, s48
    s_lshl_b32 s51, s41, 3
    s_add_u32 s50, s50, s51
    v_and_b32 v8, 0x13, v3
    v_and_b32 v9, 4, v3
    v_lshl_or_b32 v8, v9, 1, v8
    v_and_b32 v9, 8, v3
    v_lshrrev_b32 v9, 1, v9
    v_or_b32 v8, v8, v9
    v_cmp_gt_u32 vcc, 16, v3
    s_nop 1
    v_cndmask_b32 v8, v3, v8, vcc
    s_lshl_b32 s51, s41, 2
    v_add_u32 v8, s51, v8
    v_subrev_u32 v9, 20, v8
    v_cmp_le_u32 vcc, 20, v8
    s_nop 1
    v_cndmask_b32 v8, v8, v9, vcc
    v_mul_u32_u24 v9, 320, v4
    v_lshl_add_u32 v8, v8, 4, v9
    s_mul_i32 s52, s36, 81920
    s_mul_i32 s53, s12, 640
    s_add_u32 s52, s52, s53
    s_add_u32 s52, s52, 15564800
    s_cmp_lt_u32 s12, 4
    s_cbranch_scc0 .Lat_kc
    v_mov_b32 v9, v7
    s_lshl_b32 s53, s12, 1
    s_mul_i32 s53, s53, 20480
    s_lshl_b32 s54, s42, 8
    s_add_u32 s53, s53, s54
    s_lshl_b32 s55, s12, 10
    s_branch .Lat_kd
.Lat_kc:
    v_lshrrev_b32 v9, 4, v2
    s_movk_i32 s53, 20480
    v_mul_lo_u32 v9, v9, s53
    v_lshl_add_u32 v9, v6, 4, v9
    s_and_b32 s55, s12, 1
    s_lshl_b32 s53, s55, 2
    s_mul_i32 s53, s53, 20480
    s_lshl_b32 s54, s43, 8
    s_add_u32 s53, s53, s54
    s_lshl_b32 s55, s55, 10
    s_add_u32 s55, s55, 4096
.Lat_kd:
    s_add_u32 s53, s53, 12943360
    s_lshl_b32 s54, s12, 10
    s_add_u32 s54, s54, 6144
    v_lshlrev_b32 v10, 4, v2
    s_lshl_b32 s56, s46, 11
    v_add_u32 v11, s56, v10
    v_lshlrev_b32 v12, 4, v3
    s_lshl_b32 s56, s46, 10
    s_lshl_b32 s57, s41, 3
    s_add_u32 s56, s56, s57
    s_add_u32 s56, s56, 4096
    v_add_u32 v12, s56, v12
    s_lshl_b32 s56, s46, 12
    s_add_u32 s56, s56, 6144
    v_add_u32 v13, s56, v10
    s_mov_b32 s58, 0x000fffff
    s_mov_b32 s59, 0x000fffff
    s_waitcnt lgkmcnt(0)
    s_mov_b32 s8, s4
    s_and_b32 s9, s5, 0xffff
    s_mov_b32 s10, 31932416
    s_mov_b32 s11, 0x20000
    s_add_u32 m0, s54, 0
    s_mov_b64 exec, s[58:59]
    buffer_load_dwordx4 v8, s[8:11], s52 offen lds
    s_mov_b64 exec, -1
    s_add_u32 m0, s55, 0
    s_add_u32 s52, s52, 5120
    buffer_load_dwordx4 v9, s[8:11], s53 offen lds
    s_add_u32 s53, s53, 163840
    buffer_load_dwordx4 v[16:19], v7, s[8:11], s49 offen
    buffer_load_dwordx2 v[24:25], v5, s[8:11], s50 offen
    s_add_u32 s49, s49, 40960
    s_add_u32 s50, s50, 40960
    buffer_load_dwordx4 v[20:23], v7, s[8:11], s49 offen
    buffer_load_dwordx2 v[26:27], v5, s[8:11], s50 offen
    s_mov_b32 s72, s68
    s_and_b32 s73, s69, 0xffff
    s_mov_b32 s74, 2621440
    s_mov_b32 s75, 0x20000
    s_mov_b32 s76, s70
    s_and_b32 s77, s71, 0xffff
    s_mov_b32 s78, 2621440
    s_mov_b32 s79, 0x20000
    s_load_dwordx2 s[68:69], s[0:1], 40
    s_load_dwordx2 s[70:71], s[0:1], 56
    v_mov_b32 v132, 0x3f803f80
    v_cmp_eq_u32 vcc, 20, v3
    s_nop 1
    v_cndmask_b32 v132, 0, v132, vcc
    v_mov_b32 v133, v132
    v_mov_b32 v134, v132
    v_mov_b32 v135, v132
    v_add_u32 v14, s54, v10
    s_mov_b32 s40, 0xfff00000
    s_mov_b32 s41, 0xfff00000
    s_mov_b64 exec, s[40:41]
    ds_write_b128 v14, v[132:135] offset:0
    ds_write_b128 v14, v[132:135] offset:14336
    ds_write_b128 v14, v[132:135] offset:28672
    ds_write_b128 v14, v[132:135] offset:43008
    s_mov_b64 exec, -1
    s_lshr_b32 s62, s65, 2
    s_mul_i32 s62, s62, 102400
    s_add_u32 s62, s62, 5079040
    s_lshl_b32 s61, s12, 10
    s_add_u32 s62, s62, s61
    s_cmp_lt_u32 s12, 4
    s_mov_b32 s63, 90112
    s_cselect_b32 s63, 98304, s63
    s_add_u32 s63, s63, s62
    s_add_u32 s61, s61, 57344
    s_mov_b32 s39, 0
    v_mov_b32 v14, 159744
    v_mov_b32 v15, 0
    ds_write_b32 v14, v15
    s_waitcnt vmcnt(0)
    s_add_u32 m0, s54, 14336
    s_mov_b64 exec, s[58:59]
    buffer_load_dwordx4 v8, s[8:11], s52 offen lds
    s_mov_b64 exec, -1
    s_add_u32 m0, s55, 14336
    s_add_u32 s52, s52, 5120
    buffer_load_dwordx4 v9, s[8:11], s53 offen lds
    s_add_u32 s53, s53, 163840
    s_add_u32 m0, s54, 28672
    s_mov_b64 exec, s[58:59]
    buffer_load_dwordx4 v8, s[8:11], s52 offen lds
    s_mov_b64 exec, -1
    s_add_u32 m0, s55, 28672
    s_add_u32 s52, s52, 5120
    buffer_load_dwordx4 v9, s[8:11], s53 offen lds
    s_add_u32 s53, s53, 163840
    s_mov_b32 m0, s61
    s_nop 0
    buffer_load_dwordx4 v10, s[8:11], s62 offen lds
    s_cmp_lt_u32 s62, s63
    s_cselect_b32 s67, 8192, 0
    s_add_u32 s62, s62, s67
    s_add_u32 s61, s61, s67
    s_lshl_b32 s40, s64, 7
    s_lshl_b32 s41, s65, 2
    s_add_u32 s40, s40, s41
    s_add_u32 s40, s40, 30822400
    s_cmp_eq_u32 s12, 0
    s_cselect_b32 s40, s40, 0x7ff00000
    v_mov_b32 v14, 0
    v_mov_b32 v15, s66
    s_mov_b64 exec, 1
    buffer_store_dword v15, v14, s[8:11], s40 offen sc1
    s_mov_b64 exec, -1
    v_cmp_gt_u32 vcc, 32, v2
    s_nop 1
    v_cndmask_b32 v24, 0, v24, vcc
    v_cndmask_b32 v25, 0, v25, vcc
    v_cndmask_b32 v26, 0, v26, vcc
    v_cndmask_b32 v27, 0, v27, vcc
    s_waitcnt lgkmcnt(0)
    s_barrier
    ds_read_b128 v[28:31], v11 offset:0
    ds_read_b64 v[36:37], v12 offset:0
    s_waitcnt lgkmcnt(0)
    v_mfma_f32_32x32x16_bf16 v[56:71], v[28:31], v[16:19], 0
    v_mfma_f32_32x32x8bf16_1k v[56:71], v[36:37], v[24:25], v[56:71]
    s_setprio 1
    ds_read_b128 v[32:35], v11 offset:1024
    s_nop 9
    v_exp_f32 v56, v56
    v_exp_f32 v57, v57
    ds_read_b64 v[38:39], v12 offset:512
    v_exp_f32 v58, v58
    v_exp_f32 v59, v59
    v_mfma_f32_32x32x16_bf16 v[72:87], v[28:31], v[20:23], 0
    v_exp_f32 v60, v60
    ds_read_b128 v[40:43], v13 offset:0
    v_exp_f32 v61, v61
    s_mov_b32 m0, s61
    s_nop 0
    buffer_load_dwordx4 v10, s[8:11], s62 offen lds
    s_cmp_lt_u32 s62, s63
    s_cselect_b32 s67, 8192, 0
    s_add_u32 s62, s62, s67
    s_add_u32 s61, s61, s67
    v_cvt_pk_bf16_f32 v88, v56, v57
    ds_read_b128 v[44:47], v13 offset:1024
    v_exp_f32 v62, v62
    v_exp_f32 v63, v63
    v_cvt_pk_bf16_f32 v89, v58, v59
    v_exp_f32 v64, v64
    v_exp_f32 v65, v65
    v_cvt_pk_bf16_f32 v90, v60, v61
    v_exp_f32 v66, v66
    v_exp_f32 v67, v67
    v_cvt_pk_bf16_f32 v91, v62, v63
    v_mfma_f32_32x32x8bf16_1k v[72:87], v[36:37], v[26:27], v[72:87]
    v_exp_f32 v68, v68
    v_exp_f32 v69, v69
    v_exp_f32 v70, v70
    v_exp_f32 v71, v71
    v_cvt_pk_bf16_f32 v92, v64, v65
    v_cvt_pk_bf16_f32 v93, v66, v67
    v_cvt_pk_bf16_f32 v94, v68, v69
    v_cvt_pk_bf16_f32 v95, v70, v71
    s_setprio 0
    s_waitcnt lgkmcnt(0)
    v_mfma_f32_32x32x16_bf16 v[104:119], v[40:43], v[88:91], 0
    s_nop 0
    v_exp_f32 v72, v72
    v_exp_f32 v73, v73
    v_exp_f32 v74, v74
    v_exp_f32 v75, v75
    v_mfma_f32_32x32x16_bf16 v[56:71], v[32:35], v[16:19], 0
    v_exp_f32 v76, v76
    v_exp_f32 v77, v77
    v_cvt_pk_bf16_f32 v96, v72, v73
    v_and_b32 v14, 0x13, v3
    v_and_b32 v15, 4, v3
    v_lshl_or_b32 v14, v15, 1, v14
    v_and_b32 v15, 8, v3
    v_lshrrev_b32 v15, 1, v15
    v_or_b32 v14, v14, v15
    v_lshrrev_b32 v15, 4, v14
    s_movk_i32 s40, 20480
    v_mul_lo_u32 v15, v15, s40
    v_and_b32 v14, 15, v14
    v_lshl_add_u32 v15, v14, 4, v15
    v_lshl_add_u32 v1, v4, 8, v15
    s_lshr_b32 s40, s65, 1
    s_lshl_b32 s40, s40, 2
    s_and_b32 s41, s12, 3
    s_add_u32 s40, s40, s41
    s_mul_i32 s41, s40, 40960
    s_add_u32 s41, s41, 5898240
    s_cmp_lt_u32 s40, 54
    s_cselect_b32 s98, s41, 0x7ff00000
    v_exp_f32 v78, v78
    v_exp_f32 v79, v79
    v_cvt_pk_bf16_f32 v97, v74, v75
    v_mfma_f32_32x32x16_bf16 v[104:119], v[44:47], v[92:95], v[104:119]
    v_exp_f32 v80, v80
    v_exp_f32 v81, v81
    v_cvt_pk_bf16_f32 v98, v76, v77
    v_exp_f32 v82, v82
    v_exp_f32 v83, v83
    v_cvt_pk_bf16_f32 v99, v78, v79
    v_mfma_f32_32x32x8bf16_1k v[56:71], v[38:39], v[24:25], v[56:71]
    v_exp_f32 v84, v84
    v_exp_f32 v85, v85
    v_exp_f32 v86, v86
    v_exp_f32 v87, v87
    v_cvt_pk_bf16_f32 v100, v80, v81
    v_cvt_pk_bf16_f32 v101, v82, v83
    v_cvt_pk_bf16_f32 v102, v84, v85
    v_cvt_pk_bf16_f32 v103, v86, v87
    s_setprio 3
    s_waitcnt vmcnt(5)
    s_barrier
    v_mfma_f32_32x32x16_bf16 v[120:135], v[40:43], v[96:99], 0
    ds_read_b128 v[28:31], v11 offset:14336
    v_exp_f32 v56, v56
    v_exp_f32 v57, v57
    ds_read_b64 v[36:37], v12 offset:14336
    v_exp_f32 v58, v58
    v_exp_f32 v59, v59
    v_mfma_f32_32x32x16_bf16 v[72:87], v[32:35], v[20:23], 0
    v_exp_f32 v60, v60
    ds_read_b128 v[48:51], v13 offset:2048
    v_exp_f32 v61, v61
    v_cvt_pk_bf16_f32 v88, v56, v57
    ds_read_b128 v[52:55], v13 offset:3072
    v_exp_f32 v62, v62
    v_exp_f32 v63, v63
    v_cvt_pk_bf16_f32 v89, v58, v59
    v_mfma_f32_32x32x16_bf16 v[120:135], v[44:47], v[100:103], v[120:135]
    v_exp_f32 v64, v64
    v_exp_f32 v65, v65
    v_cvt_pk_bf16_f32 v90, v60, v61
    v_exp_f32 v66, v66
    v_exp_f32 v67, v67
    v_cvt_pk_bf16_f32 v91, v62, v63
    v_mfma_f32_32x32x8bf16_1k v[72:87], v[38:39], v[26:27], v[72:87]
    v_exp_f32 v68, v68
    v_exp_f32 v69, v69
    v_exp_f32 v70, v70
    v_exp_f32 v71, v71
    v_cvt_pk_bf16_f32 v92, v64, v65
    v_cvt_pk_bf16_f32 v93, v66, v67
    v_cvt_pk_bf16_f32 v94, v68, v69
    v_cvt_pk_bf16_f32 v95, v70, v71
    s_setprio 2
    s_waitcnt lgkmcnt(0)
    v_mfma_f32_32x32x16_bf16 v[104:119], v[48:51], v[88:91], v[104:119]
    s_nop 0
    v_exp_f32 v72, v72
    v_exp_f32 v73, v73
    s_add_u32 m0, s54, 43008
    s_mov_b64 exec, s[58:59]
    buffer_load_dwordx4 v8, s[8:11], s52 offen lds
    s_mov_b64 exec, -1
    s_add_u32 s52, s52, 5120
    v_exp_f32 v74, v74
    v_exp_f32 v75, v75
    v_mfma_f32_32x32x16_bf16 v[56:71], v[28:31], v[16:19], 0
    v_exp_f32 v76, v76
    v_exp_f32 v77, v77
    v_cvt_pk_bf16_f32 v96, v72, v73
    v_exp_f32 v78, v78
    v_exp_f32 v79, v79
    v_cvt_pk_bf16_f32 v97, v74, v75
    v_mfma_f32_32x32x16_bf16 v[104:119], v[52:55], v[92:95], v[104:119]
    v_exp_f32 v80, v80
    v_exp_f32 v81, v81
    s_add_u32 m0, s55, 43008
    s_nop 0
    buffer_load_dwordx4 v9, s[8:11], s53 offen lds
    s_add_u32 s53, s53, 163840
    v_cvt_pk_bf16_f32 v98, v76, v77
    v_exp_f32 v82, v82
    v_exp_f32 v83, v83
    v_cvt_pk_bf16_f32 v99, v78, v79
    v_mfma_f32_32x32x8bf16_1k v[56:71], v[36:37], v[24:25], v[56:71]
    v_exp_f32 v84, v84
    v_exp_f32 v85, v85
    v_exp_f32 v86, v86
    v_exp_f32 v87, v87
    v_cvt_pk_bf16_f32 v100, v80, v81
    v_cvt_pk_bf16_f32 v101, v82, v83
    v_cvt_pk_bf16_f32 v102, v84, v85
    v_cvt_pk_bf16_f32 v103, v86, v87
    s_setprio 1
    v_mfma_f32_32x32x16_bf16 v[120:135], v[48:51], v[96:99], v[120:135]
    ds_read_b128 v[32:35], v11 offset:15360
    s_nop 0
    v_exp_f32 v56, v56
    v_exp_f32 v57, v57
    ds_read_b64 v[38:39], v12 offset:14848
    v_exp_f32 v58, v58
    v_exp_f32 v59, v59
    v_mfma_f32_32x32x16_bf16 v[72:87], v[28:31], v[20:23], 0
    v_exp_f32 v60, v60
    ds_read_b128 v[40:43], v13 offset:14336
    v_exp_f32 v61, v61
    s_mov_b32 m0, s61
    s_nop 0
    buffer_load_dwordx4 v10, s[8:11], s62 offen lds
    s_cmp_lt_u32 s62, s63
    s_cselect_b32 s67, 8192, 0
    s_add_u32 s62, s62, s67
    s_add_u32 s61, s61, s67
    v_cvt_pk_bf16_f32 v88, v56, v57
    ds_read_b128 v[44:47], v13 offset:15360
    v_exp_f32 v62, v62
    v_exp_f32 v63, v63
    v_cvt_pk_bf16_f32 v89, v58, v59
    v_mfma_f32_32x32x16_bf16 v[120:135], v[52:55], v[100:103], v[120:135]
    v_exp_f32 v64, v64
    v_exp_f32 v65, v65
    v_cvt_pk_bf16_f32 v90, v60, v61
    v_exp_f32 v66, v66
    v_exp_f32 v67, v67
    v_cvt_pk_bf16_f32 v91, v62, v63
    v_mfma_f32_32x32x8bf16_1k v[72:87], v[36:37], v[26:27], v[72:87]
    v_exp_f32 v68, v68
    v_exp_f32 v69, v69
    v_exp_f32 v70, v70
    v_exp_f32 v71, v71
    v_cvt_pk_bf16_f32 v92, v64, v65
    v_cvt_pk_bf16_f32 v93, v66, v67
    v_cvt_pk_bf16_f32 v94, v68, v69
    v_cvt_pk_bf16_f32 v95, v70, v71
    s_setprio 0
    s_waitcnt lgkmcnt(0)
    v_mfma_f32_32x32x16_bf16 v[104:119], v[40:43], v[88:91], v[104:119]
    s_nop 0
    v_exp_f32 v72, v72
    v_exp_f32 v73, v73
    v_exp_f32 v74, v74
    v_exp_f32 v75, v75
    v_mfma_f32_32x32x16_bf16 v[56:71], v[32:35], v[16:19], 0
    v_exp_f32 v76, v76
    v_exp_f32 v77, v77
    v_cvt_pk_bf16_f32 v96, v72, v73
    s_mov_b32 s38, 0x7ff00000
    v_lshlrev_b32 v148, 7, v2
    s_cmp_ge_u32 s12, 4
    s_cbranch_scc1 .Ltc10
    s_mul_i32 s50, s64, 327680
    s_mul_i32 s40, s65, 10240
    s_add_u32 s50, s50, s40
    s_and_b32 s40, s12, 1
    s_mul_i32 s40, s40, 5120
    s_add_u32 s50, s50, s40
    s_lshr_b32 s40, s12, 1
    s_mul_i32 s40, s40, 2621440
    s_add_u32 s50, s50, s40
    s_add_u32 s50, s50, 18186240
    v_add_u32 v148, s50, v148
    s_lshr_b32 s40, s65, 1
    s_lshl_b32 s40, s40, 14
    s_lshl_b32 s41, s64, 11
    s_add_u32 s40, s40, s41
    s_and_b32 s41, s65, 1
    s_lshl_b32 s41, s41, 10
    s_add_u32 s40, s40, s41
    s_add_u32 s40, s40, 30551040
    s_cmp_eq_u32 s12, 2
    s_cselect_b32 s40, s40, 0x7ff00000
    v_lshlrev_b32 v149, 7, v2
    v_add_u32 v149, s40, v149
    v_mov_b32 v14, 0x7ff00000
    v_cmp_gt_u32 vcc, 48, v2
    s_nop 1
    v_cndmask_b32 v149, v14, v149, vcc
    v_cmp_gt_u32 vcc, 40, v2
    s_nop 1
    v_cndmask_b32 v148, v149, v148, vcc
    s_branch .Ltc11
.Ltc10:
    s_sub_u32 s40, s12, 4
    s_lshl_b32 s40, s40, 5
    s_add_u32 s40, s40, s65
    s_mul_i32 s50, s40, 20480
    s_add_u32 s50, s50, 5911552
    s_cmp_lt_u32 s40, 108
    s_cselect_b32 s50, s50, 0x7ff00000
    v_add_u32 v148, s50, v148
    v_mov_b32 v14, 0x7ff00000
    v_cmp_gt_u32 vcc, 56, v2
    s_nop 1
    v_cndmask_b32 v148, v14, v148, vcc
.Ltc11:
    v_lshlrev_b32 v147, 7, v2
    s_lshl_b32 s40, s12, 13
    s_mul_i32 s51, s64, 884736
    s_mul_i32 s41, s65, 27648
    s_add_u32 s51, s51, s41
    s_add_u32 s51, s51, s40
    s_add_u32 s51, s51, 23429120
    s_cmp_ge_u32 s12, 4
    s_cselect_b32 s51, 0x7ff00000, s51
    s_and_b32 s40, s65, 3
    s_lshl_b32 s40, s40, 2
    s_lshl_b32 s41, s64, 4
    s_add_u32 s40, s40, s41
    s_and_b32 s41, s12, 3
    s_add_u32 s40, s40, s41
    s_lshl_b32 s40, s40, 4
    v_and_b32 v0, 15, v2
    v_add_u32 v0, s40, v0
    s_movk_i32 s41, 1280
    v_mul_lo_u32 v0, v0, s41
    v_lshrrev_b32 v14, 4, v2
    v_lshl_add_u32 v0, v14, 3, v0
    s_lshr_b32 s57, s65, 2
    s_mul_i32 s57, s57, 160
    s_lshr_b32 s40, s12, 2
    s_mul_i32 s40, s40, 96
    s_add_u32 s57, s57, s40
    v_exp_f32 v78, v78
    v_exp_f32 v79, v79
    v_cvt_pk_bf16_f32 v97, v74, v75
    v_mfma_f32_32x32x16_bf16 v[104:119], v[44:47], v[92:95], v[104:119]
    v_exp_f32 v80, v80
    v_exp_f32 v81, v81
    v_cvt_pk_bf16_f32 v98, v76, v77
    v_exp_f32 v82, v82
    v_exp_f32 v83, v83
    v_cvt_pk_bf16_f32 v99, v78, v79
    v_mfma_f32_32x32x8bf16_1k v[56:71], v[38:39], v[24:25], v[56:71]
    v_exp_f32 v84, v84
    v_exp_f32 v85, v85
    v_exp_f32 v86, v86
    v_exp_f32 v87, v87
    v_cvt_pk_bf16_f32 v100, v80, v81
    v_cvt_pk_bf16_f32 v101, v82, v83
    v_cvt_pk_bf16_f32 v102, v84, v85
    v_cvt_pk_bf16_f32 v103, v86, v87
    s_setprio 3
    s_waitcnt vmcnt(6)
    s_barrier
    v_mfma_f32_32x32x16_bf16 v[120:135], v[40:43], v[96:99], v[120:135]
    ds_read_b128 v[28:31], v11 offset:28672
    v_exp_f32 v56, v56
    v_exp_f32 v57, v57
    ds_read_b64 v[36:37], v12 offset:28672
    v_exp_f32 v58, v58
    v_exp_f32 v59, v59
    v_mfma_f32_32x32x16_bf16 v[72:87], v[32:35], v[20:23], 0
    v_exp_f32 v60, v60
    ds_read_b128 v[48:51], v13 offset:16384
    v_exp_f32 v61, v61
    v_cvt_pk_bf16_f32 v88, v56, v57
    ds_read_b128 v[52:55], v13 offset:17408
    v_exp_f32 v62, v62
    v_exp_f32 v63, v63
    v_cvt_pk_bf16_f32 v89, v58, v59
    v_mfma_f32_32x32x16_bf16 v[120:135], v[44:47], v[100:103], v[120:135]
    v_exp_f32 v64, v64
    v_exp_f32 v65, v65
    v_cvt_pk_bf16_f32 v90, v60, v61
    v_exp_f32 v66, v66
    v_exp_f32 v67, v67
    v_cvt_pk_bf16_f32 v91, v62, v63
    v_mfma_f32_32x32x8bf16_1k v[72:87], v[38:39], v[26:27], v[72:87]
    v_exp_f32 v68, v68
    v_exp_f32 v69, v69
    v_exp_f32 v70, v70
    v_exp_f32 v71, v71
    v_cvt_pk_bf16_f32 v92, v64, v65
    v_cvt_pk_bf16_f32 v93, v66, v67
    v_cvt_pk_bf16_f32 v94, v68, v69
    v_cvt_pk_bf16_f32 v95, v70, v71
    s_setprio 2
    s_waitcnt lgkmcnt(0)
    v_mfma_f32_32x32x16_bf16 v[104:119], v[48:51], v[88:91], v[104:119]
    s_nop 0
    v_exp_f32 v72, v72
    v_exp_f32 v73, v73
    s_add_u32 m0, s54, 0
    s_mov_b64 exec, s[58:59]
    buffer_load_dwordx4 v8, s[8:11], s52 offen lds
    s_mov_b64 exec, -1
    s_add_u32 s52, s52, 5120
    v_exp_f32 v74, v74
    v_exp_f32 v75, v75
    v_mfma_f32_32x32x16_bf16 v[56:71], v[28:31], v[16:19], 0
    v_exp_f32 v76, v76
    v_exp_f32 v77, v77
    v_cvt_pk_bf16_f32 v96, v72, v73
    v_exp_f32 v78, v78
    v_exp_f32 v79, v79
    v_cvt_pk_bf16_f32 v97, v74, v75
    v_mfma_f32_32x32x16_bf16 v[104:119], v[52:55], v[92:95], v[104:119]
    v_exp_f32 v80, v80
    v_exp_f32 v81, v81
    s_add_u32 m0, s55, 0
    s_nop 0
    buffer_load_dwordx4 v9, s[8:11], s53 offen lds
    s_add_u32 s53, s53, 163840
    v_cvt_pk_bf16_f32 v98, v76, v77
    v_exp_f32 v82, v82
    v_exp_f32 v83, v83
    v_cvt_pk_bf16_f32 v99, v78, v79
    v_mfma_f32_32x32x8bf16_1k v[56:71], v[36:37], v[24:25], v[56:71]
    v_exp_f32 v84, v84
    v_exp_f32 v85, v85
    v_exp_f32 v86, v86
    v_exp_f32 v87, v87
    v_cvt_pk_bf16_f32 v100, v80, v81
    v_cvt_pk_bf16_f32 v101, v82, v83
    v_cvt_pk_bf16_f32 v102, v84, v85
    v_cvt_pk_bf16_f32 v103, v86, v87
    s_setprio 1
    v_mfma_f32_32x32x16_bf16 v[120:135], v[48:51], v[96:99], v[120:135]
    ds_read_b128 v[32:35], v11 offset:29696
    s_nop 0
    v_exp_f32 v56, v56
    v_exp_f32 v57, v57
    ds_read_b64 v[38:39], v12 offset:29184
    v_exp_f32 v58, v58
    v_exp_f32 v59, v59
    v_mfma_f32_32x32x16_bf16 v[72:87], v[28:31], v[20:23], 0
    v_exp_f32 v60, v60
    ds_read_b128 v[40:43], v13 offset:28672
    v_exp_f32 v61, v61
    s_mov_b32 m0, s61
    s_nop 0
    buffer_load_dwordx4 v10, s[8:11], s62 offen lds
    s_cmp_lt_u32 s62, s63
    s_cselect_b32 s67, 8192, 0
    s_add_u32 s62, s62, s67
    s_add_u32 s61, s61, s67
    v_cvt_pk_bf16_f32 v88, v56, v57
    ds_read_b128 v[44:47], v13 offset:29696
    v_exp_f32 v62, v62
    v_exp_f32 v63, v63
    v_cvt_pk_bf16_f32 v89, v58, v59
    v_mfma_f32_32x32x16_bf16 v[120:135], v[52:55], v[100:103], v[120:135]
    v_exp_f32 v64, v64
    v_exp_f32 v65, v65
    v_cvt_pk_bf16_f32 v90, v60, v61
    v_exp_f32 v66, v66
    v_exp_f32 v67, v67
    v_cvt_pk_bf16_f32 v91, v62, v63
    v_mfma_f32_32x32x8bf16_1k v[72:87], v[36:37], v[26:27], v[72:87]
    s_add_u32 s40, s98, 0
    buffer_load_dwordx4 v[152:155], v1, s[8:11], s40 offen
    v_exp_f32 v68, v68
    v_exp_f32 v69, v69
    v_exp_f32 v70, v70
    v_exp_f32 v71, v71
    v_cvt_pk_bf16_f32 v92, v64, v65
    v_cvt_pk_bf16_f32 v93, v66, v67
    v_cvt_pk_bf16_f32 v94, v68, v69
    v_cvt_pk_bf16_f32 v95, v70, v71
    s_setprio 0
    s_waitcnt lgkmcnt(0)
    v_mfma_f32_32x32x16_bf16 v[104:119], v[40:43], v[88:91], v[104:119]
    v_exp_f32 v72, v72
    v_exp_f32 v73, v73
    v_exp_f32 v74, v74
    v_exp_f32 v75, v75
    v_mfma_f32_32x32x16_bf16 v[56:71], v[32:35], v[16:19], 0
    v_exp_f32 v76, v76
    v_exp_f32 v77, v77
    s_add_u32 s40, s98, 512
    buffer_load_dwordx4 v[156:159], v1, s[8:11], s40 offen
    v_cvt_pk_bf16_f32 v96, v72, v73
    v_exp_f32 v78, v78
    v_exp_f32 v79, v79
    v_cvt_pk_bf16_f32 v97, v74, v75
    v_mfma_f32_32x32x16_bf16 v[104:119], v[44:47], v[92:95], v[104:119]
    v_exp_f32 v80, v80
    v_exp_f32 v81, v81
    v_cvt_pk_bf16_f32 v98, v76, v77
    v_exp_f32 v82, v82
    v_exp_f32 v83, v83
    v_cvt_pk_bf16_f32 v99, v78, v79
    v_mfma_f32_32x32x8bf16_1k v[56:71], v[38:39], v[24:25], v[56:71]
    s_add_u32 s40, s98, 1024
    buffer_load_dwordx4 v[160:163], v1, s[8:11], s40 offen
    v_exp_f32 v84, v84
    v_exp_f32 v85, v85
    v_exp_f32 v86, v86
    v_exp_f32 v87, v87
    v_cvt_pk_bf16_f32 v100, v80, v81
    v_cvt_pk_bf16_f32 v101, v82, v83
    v_cvt_pk_bf16_f32 v102, v84, v85
    v_cvt_pk_bf16_f32 v103, v86, v87
    s_setprio 3
    s_waitcnt vmcnt(7)
    s_barrier
    v_mfma_f32_32x32x16_bf16 v[120:135], v[40:43], v[96:99], v[120:135]
    ds_read_b128 v[28:31], v11 offset:43008
    v_exp_f32 v56, v56
    v_exp_f32 v57, v57
    ds_read_b64 v[36:37], v12 offset:43008
    v_exp_f32 v58, v58
    v_exp_f32 v59, v59
    v_mfma_f32_32x32x16_bf16 v[72:87], v[32:35], v[20:23], 0
    v_exp_f32 v60, v60
    ds_read_b128 v[48:51], v13 offset:30720
    v_exp_f32 v61, v61
    v_cvt_pk_bf16_f32 v88, v56, v57
    ds_read_b128 v[52:55], v13 offset:31744
    v_exp_f32 v62, v62
    v_exp_f32 v63, v63
    v_cvt_pk_bf16_f32 v89, v58, v59
    v_mfma_f32_32x32x16_bf16 v[120:135], v[44:47], v[100:103], v[120:135]
    v_exp_f32 v64, v64
    v_exp_f32 v65, v65
    v_cvt_pk_bf16_f32 v90, v60, v61
    v_exp_f32 v66, v66
    v_exp_f32 v67, v67
    v_cvt_pk_bf16_f32 v91, v62, v63
    v_mfma_f32_32x32x8bf16_1k v[72:87], v[38:39], v[26:27], v[72:87]
    v_exp_f32 v68, v68
    v_exp_f32 v69, v69
    v_exp_f32 v70, v70
    v_exp_f32 v71, v71
    v_cvt_pk_bf16_f32 v92, v64, v65
    v_cvt_pk_bf16_f32 v93, v66, v67
    v_cvt_pk_bf16_f32 v94, v68, v69
    v_cvt_pk_bf16_f32 v95, v70, v71
    s_setprio 2
    s_waitcnt lgkmcnt(0)
    v_mfma_f32_32x32x16_bf16 v[104:119], v[48:51], v[88:91], v[104:119]
    s_nop 0
    v_exp_f32 v72, v72
    v_exp_f32 v73, v73
    s_add_u32 m0, s54, 14336
    s_mov_b64 exec, s[58:59]
    buffer_load_dwordx4 v8, s[8:11], s52 offen lds
    s_mov_b64 exec, -1
    s_add_u32 s52, s52, 5120
    v_exp_f32 v74, v74
    v_exp_f32 v75, v75
    v_mfma_f32_32x32x16_bf16 v[56:71], v[28:31], v[16:19], 0
    v_exp_f32 v76, v76
    v_exp_f32 v77, v77
    v_cvt_pk_bf16_f32 v96, v72, v73
    v_exp_f32 v78, v78
    v_exp_f32 v79, v79
    v_cvt_pk_bf16_f32 v97, v74, v75
    v_mfma_f32_32x32x16_bf16 v[104:119], v[52:55], v[92:95], v[104:119]
    v_exp_f32 v80, v80
    v_exp_f32 v81, v81
    s_add_u32 m0, s55, 14336
    s_nop 0
    buffer_load_dwordx4 v9, s[8:11], s53 offen lds
    s_add_u32 s53, s53, 163840
    v_cvt_pk_bf16_f32 v98, v76, v77
    v_exp_f32 v82, v82
    v_exp_f32 v83, v83
    v_cvt_pk_bf16_f32 v99, v78, v79
    v_mfma_f32_32x32x8bf16_1k v[56:71], v[36:37], v[24:25], v[56:71]
    v_exp_f32 v84, v84
    v_exp_f32 v85, v85
    v_exp_f32 v86, v86
    v_exp_f32 v87, v87
    v_cvt_pk_bf16_f32 v100, v80, v81
    v_cvt_pk_bf16_f32 v101, v82, v83
    v_cvt_pk_bf16_f32 v102, v84, v85
    v_cvt_pk_bf16_f32 v103, v86, v87
    s_setprio 1
    v_mfma_f32_32x32x16_bf16 v[120:135], v[48:51], v[96:99], v[120:135]
    ds_read_b128 v[32:35], v11 offset:44032
    s_nop 0
    v_exp_f32 v56, v56
    v_exp_f32 v57, v57
    ds_read_b64 v[38:39], v12 offset:43520
    v_exp_f32 v58, v58
    v_exp_f32 v59, v59
    v_mfma_f32_32x32x16_bf16 v[72:87], v[28:31], v[20:23], 0
    v_exp_f32 v60, v60
    ds_read_b128 v[40:43], v13 offset:43008
    v_exp_f32 v61, v61
    s_mov_b32 m0, s61
    s_nop 0
    buffer_load_dwordx4 v10, s[8:11], s62 offen lds
    s_cmp_lt_u32 s62, s63
    s_cselect_b32 s67, 8192, 0
    s_add_u32 s62, s62, s67
    s_add_u32 s61, s61, s67
    v_cvt_pk_bf16_f32 v88, v56, v57
    ds_read_b128 v[44:47], v13 offset:44032
    v_exp_f32 v62, v62
    v_exp_f32 v63, v63
    v_cvt_pk_bf16_f32 v89, v58, v59
    v_mfma_f32_32x32x16_bf16 v[120:135], v[52:55], v[100:103], v[120:135]
    v_exp_f32 v64, v64
    v_exp_f32 v65, v65
    v_cvt_pk_bf16_f32 v90, v60, v61
    v_exp_f32 v66, v66
    v_exp_f32 v67, v67
    v_cvt_pk_bf16_f32 v91, v62, v63
    v_mfma_f32_32x32x8bf16_1k v[72:87], v[36:37], v[26:27], v[72:87]
    s_add_u32 s40, s98, 1536
    buffer_load_dwordx4 v[164:167], v1, s[8:11], s40 offen
    v_exp_f32 v68, v68
    v_exp_f32 v69, v69
    v_exp_f32 v70, v70
    v_exp_f32 v71, v71
    v_cvt_pk_bf16_f32 v92, v64, v65
    v_cvt_pk_bf16_f32 v93, v66, v67
    v_cvt_pk_bf16_f32 v94, v68, v69
    v_cvt_pk_bf16_f32 v95, v70, v71
    s_setprio 0
    s_waitcnt lgkmcnt(0)
    v_mfma_f32_32x32x16_bf16 v[104:119], v[40:43], v[88:91], v[104:119]
    v_exp_f32 v72, v72
    v_exp_f32 v73, v73
    v_exp_f32 v74, v74
    v_exp_f32 v75, v75
    v_mfma_f32_32x32x16_bf16 v[56:71], v[32:35], v[16:19], 0
    v_exp_f32 v76, v76
    v_exp_f32 v77, v77
    s_add_u32 s40, s98, 2048
    buffer_load_dwordx4 v[168:171], v1, s[8:11], s40 offen
    v_cvt_pk_bf16_f32 v96, v72, v73
    v_exp_f32 v78, v78
    v_exp_f32 v79, v79
    v_cvt_pk_bf16_f32 v97, v74, v75
    v_mfma_f32_32x32x16_bf16 v[104:119], v[44:47], v[92:95], v[104:119]
    v_exp_f32 v80, v80
    v_exp_f32 v81, v81
    v_cvt_pk_bf16_f32 v98, v76, v77
    v_exp_f32 v82, v82
    v_exp_f32 v83, v83
    v_cvt_pk_bf16_f32 v99, v78, v79
    v_mfma_f32_32x32x8bf16_1k v[56:71], v[38:39], v[24:25], v[56:71]
    s_add_u32 s40, s98, 2560
    buffer_load_dwordx4 v[172:175], v1, s[8:11], s40 offen
    v_exp_f32 v84, v84
    v_exp_f32 v85, v85
    v_exp_f32 v86, v86
    v_exp_f32 v87, v87
    v_cvt_pk_bf16_f32 v100, v80, v81
    v_cvt_pk_bf16_f32 v101, v82, v83
    v_cvt_pk_bf16_f32 v102, v84, v85
    v_cvt_pk_bf16_f32 v103, v86, v87
    s_setprio 3
    s_waitcnt vmcnt(10)
    s_barrier
    v_mfma_f32_32x32x16_bf16 v[120:135], v[40:43], v[96:99], v[120:135]
    ds_read_b128 v[28:31], v11 offset:0
    v_exp_f32 v56, v56
    v_exp_f32 v57, v57
    ds_read_b64 v[36:37], v12 offset:0
    v_exp_f32 v58, v58
    v_exp_f32 v59, v59
    v_mfma_f32_32x32x16_bf16 v[72:87], v[32:35], v[20:23], 0
    v_exp_f32 v60, v60
    ds_read_b128 v[48:51], v13 offset:45056
    v_exp_f32 v61, v61
    v_cvt_pk_bf16_f32 v88, v56, v57
    ds_read_b128 v[52:55], v13 offset:46080
    v_exp_f32 v62, v62
    v_exp_f32 v63, v63
    v_cvt_pk_bf16_f32 v89, v58, v59
    v_mfma_f32_32x32x16_bf16 v[120:135], v[44:47], v[100:103], v[120:135]
    v_exp_f32 v64, v64
    v_exp_f32 v65, v65
    v_cvt_pk_bf16_f32 v90, v60, v61
    v_exp_f32 v66, v66
    v_exp_f32 v67, v67
    v_cvt_pk_bf16_f32 v91, v62, v63
    v_mfma_f32_32x32x8bf16_1k v[72:87], v[38:39], v[26:27], v[72:87]
    v_exp_f32 v68, v68
    v_exp_f32 v69, v69
    v_exp_f32 v70, v70
    v_exp_f32 v71, v71
    v_cvt_pk_bf16_f32 v92, v64, v65
    v_cvt_pk_bf16_f32 v93, v66, v67
    v_cvt_pk_bf16_f32 v94, v68, v69
    v_cvt_pk_bf16_f32 v95, v70, v71
    s_setprio 2
    s_waitcnt lgkmcnt(0)
    v_mfma_f32_32x32x16_bf16 v[104:119], v[48:51], v[88:91], v[104:119]
    s_nop 0
    v_exp_f32 v72, v72
    v_exp_f32 v73, v73
    s_add_u32 m0, s54, 28672
    s_mov_b64 exec, s[58:59]
    buffer_load_dwordx4 v8, s[8:11], s52 offen lds
    s_mov_b64 exec, -1
    s_add_u32 s52, s52, 5120
    v_exp_f32 v74, v74
    v_exp_f32 v75, v75
    v_mfma_f32_32x32x16_bf16 v[56:71], v[28:31], v[16:19], 0
    v_exp_f32 v76, v76
    v_exp_f32 v77, v77
    v_cvt_pk_bf16_f32 v96, v72, v73
    v_exp_f32 v78, v78
    v_exp_f32 v79, v79
    v_cvt_pk_bf16_f32 v97, v74, v75
    v_mfma_f32_32x32x16_bf16 v[104:119], v[52:55], v[92:95], v[104:119]
    v_exp_f32 v80, v80
    v_exp_f32 v81, v81
    s_add_u32 m0, s55, 28672
    s_nop 0
    buffer_load_dwordx4 v9, s[8:11], s53 offen lds
    s_add_u32 s53, s53, 163840
    v_cvt_pk_bf16_f32 v98, v76, v77
    v_exp_f32 v82, v82
    v_exp_f32 v83, v83
    v_cvt_pk_bf16_f32 v99, v78, v79
    v_mfma_f32_32x32x8bf16_1k v[56:71], v[36:37], v[24:25], v[56:71]
    v_exp_f32 v84, v84
    v_exp_f32 v85, v85
    v_exp_f32 v86, v86
    v_exp_f32 v87, v87
    v_cvt_pk_bf16_f32 v100, v80, v81
    v_cvt_pk_bf16_f32 v101, v82, v83
    v_cvt_pk_bf16_f32 v102, v84, v85
    v_cvt_pk_bf16_f32 v103, v86, v87
    s_setprio 1
    v_mfma_f32_32x32x16_bf16 v[120:135], v[48:51], v[96:99], v[120:135]
    ds_read_b128 v[32:35], v11 offset:1024
    s_nop 0
    v_exp_f32 v56, v56
    v_exp_f32 v57, v57
    ds_read_b64 v[38:39], v12 offset:512
    v_exp_f32 v58, v58
    v_exp_f32 v59, v59
    v_mfma_f32_32x32x16_bf16 v[72:87], v[28:31], v[20:23], 0
    v_exp_f32 v60, v60
    ds_read_b128 v[40:43], v13 offset:0
    v_exp_f32 v61, v61
    s_mov_b32 m0, s61
    s_nop 0
    buffer_load_dwordx4 v10, s[8:11], s62 offen lds
    s_cmp_lt_u32 s62, s63
    s_cselect_b32 s67, 8192, 0
    s_add_u32 s62, s62, s67
    s_add_u32 s61, s61, s67
    v_cvt_pk_bf16_f32 v88, v56, v57
    ds_read_b128 v[44:47], v13 offset:1024
    v_exp_f32 v62, v62
    v_exp_f32 v63, v63
    v_cvt_pk_bf16_f32 v89, v58, v59
    v_mfma_f32_32x32x16_bf16 v[120:135], v[52:55], v[100:103], v[120:135]
    v_exp_f32 v64, v64
    v_exp_f32 v65, v65
    v_cvt_pk_bf16_f32 v90, v60, v61
    v_exp_f32 v66, v66
    v_exp_f32 v67, v67
    v_cvt_pk_bf16_f32 v91, v62, v63
    v_mfma_f32_32x32x8bf16_1k v[72:87], v[36:37], v[26:27], v[72:87]
    s_add_u32 s40, s98, 3072
    buffer_load_dwordx4 v[176:179], v1, s[8:11], s40 offen
    v_exp_f32 v68, v68
    v_exp_f32 v69, v69
    v_exp_f32 v70, v70
    v_exp_f32 v71, v71
    v_cvt_pk_bf16_f32 v92, v64, v65
    v_cvt_pk_bf16_f32 v93, v66, v67
    v_cvt_pk_bf16_f32 v94, v68, v69
    v_cvt_pk_bf16_f32 v95, v70, v71
    s_setprio 0
    s_waitcnt lgkmcnt(0)
    v_mfma_f32_32x32x16_bf16 v[104:119], v[40:43], v[88:91], v[104:119]
    v_exp_f32 v72, v72
    v_exp_f32 v73, v73
    v_exp_f32 v74, v74
    v_exp_f32 v75, v75
    v_mfma_f32_32x32x16_bf16 v[56:71], v[32:35], v[16:19], 0
    v_exp_f32 v76, v76
    v_exp_f32 v77, v77
    s_add_u32 s40, s98, 3584
    buffer_load_dwordx4 v[180:183], v1, s[8:11], s40 offen
    v_cvt_pk_bf16_f32 v96, v72, v73
    v_exp_f32 v78, v78
    v_exp_f32 v79, v79
    v_cvt_pk_bf16_f32 v97, v74, v75
    v_mfma_f32_32x32x16_bf16 v[104:119], v[44:47], v[92:95], v[104:119]
    v_exp_f32 v80, v80
    v_exp_f32 v81, v81
    v_cvt_pk_bf16_f32 v98, v76, v77
    v_exp_f32 v82, v82
    v_exp_f32 v83, v83
    v_cvt_pk_bf16_f32 v99, v78, v79
    v_mfma_f32_32x32x8bf16_1k v[56:71], v[38:39], v[24:25], v[56:71]
    s_add_u32 s40, s98, 4096
    buffer_load_dwordx4 v[184:187], v1, s[8:11], s40 offen
    v_exp_f32 v84, v84
    v_exp_f32 v85, v85
    v_exp_f32 v86, v86
    v_exp_f32 v87, v87
    v_cvt_pk_bf16_f32 v100, v80, v81
    v_cvt_pk_bf16_f32 v101, v82, v83
    v_cvt_pk_bf16_f32 v102, v84, v85
    v_cvt_pk_bf16_f32 v103, v86, v87
    s_setprio 3
    s_waitcnt vmcnt(10)
    s_barrier
    v_mfma_f32_32x32x16_bf16 v[120:135], v[40:43], v[96:99], v[120:135]
    ds_read_b128 v[28:31], v11 offset:14336
    v_exp_f32 v56, v56
    v_exp_f32 v57, v57
    ds_read_b64 v[36:37], v12 offset:14336
    v_exp_f32 v58, v58
    v_exp_f32 v59, v59
    v_mfma_f32_32x32x16_bf16 v[72:87], v[32:35], v[20:23], 0
    v_exp_f32 v60, v60
    ds_read_b128 v[48:51], v13 offset:2048
    v_exp_f32 v61, v61
    v_cvt_pk_bf16_f32 v88, v56, v57
    ds_read_b128 v[52:55], v13 offset:3072
    v_exp_f32 v62, v62
    v_exp_f32 v63, v63
    v_cvt_pk_bf16_f32 v89, v58, v59
    v_mfma_f32_32x32x16_bf16 v[120:135], v[44:47], v[100:103], v[120:135]
    v_exp_f32 v64, v64
    v_exp_f32 v65, v65
    v_cvt_pk_bf16_f32 v90, v60, v61
    v_exp_f32 v66, v66
    v_exp_f32 v67, v67
    v_cvt_pk_bf16_f32 v91, v62, v63
    v_mfma_f32_32x32x8bf16_1k v[72:87], v[38:39], v[26:27], v[72:87]
    v_exp_f32 v68, v68
    v_exp_f32 v69, v69
    v_exp_f32 v70, v70
    v_exp_f32 v71, v71
    v_cvt_pk_bf16_f32 v92, v64, v65
    v_cvt_pk_bf16_f32 v93, v66, v67
    v_cvt_pk_bf16_f32 v94, v68, v69
    v_cvt_pk_bf16_f32 v95, v70, v71
    s_setprio 2
    s_waitcnt lgkmcnt(0)
    v_mfma_f32_32x32x16_bf16 v[104:119], v[48:51], v[88:91], v[104:119]
    s_nop 0
    v_exp_f32 v72, v72
    v_exp_f32 v73, v73
    s_add_u32 m0, s54, 43008
    s_mov_b64 exec, s[58:59]
    buffer_load_dwordx4 v8, s[8:11], s52 offen lds
    s_mov_b64 exec, -1
    s_add_u32 s52, s52, 5120
    v_exp_f32 v74, v74
    v_exp_f32 v75, v75
    v_mfma_f32_32x32x16_bf16 v[56:71], v[28:31], v[16:19], 0
    v_exp_f32 v76, v76
    v_exp_f32 v77, v77
    v_cvt_pk_bf16_f32 v96, v72, v73
    v_exp_f32 v78, v78
    v_exp_f32 v79, v79
    v_cvt_pk_bf16_f32 v97, v74, v75
    v_mfma_f32_32x32x16_bf16 v[104:119], v[52:55], v[92:95], v[104:119]
    v_exp_f32 v80, v80
    v_exp_f32 v81, v81
    s_add_u32 m0, s55, 43008
    s_nop 0
    buffer_load_dwordx4 v9, s[8:11], s53 offen lds
    s_add_u32 s53, s53, 163840
    v_cvt_pk_bf16_f32 v98, v76, v77
    v_exp_f32 v82, v82
    v_exp_f32 v83, v83
    v_cvt_pk_bf16_f32 v99, v78, v79
    v_mfma_f32_32x32x8bf16_1k v[56:71], v[36:37], v[24:25], v[56:71]
    v_exp_f32 v84, v84
    v_exp_f32 v85, v85
    v_exp_f32 v86, v86
    v_exp_f32 v87, v87
    v_cvt_pk_bf16_f32 v100, v80, v81
    v_cvt_pk_bf16_f32 v101, v82, v83
    v_cvt_pk_bf16_f32 v102, v84, v85
    v_cvt_pk_bf16_f32 v103, v86, v87
    s_setprio 1
    v_mfma_f32_32x32x16_bf16 v[120:135], v[48:51], v[96:99], v[120:135]
    ds_read_b128 v[32:35], v11 offset:15360
    s_nop 0
    v_exp_f32 v56, v56
    v_exp_f32 v57, v57
    ds_read_b64 v[38:39], v12 offset:14848
    v_exp_f32 v58, v58
    v_exp_f32 v59, v59
    v_mfma_f32_32x32x16_bf16 v[72:87], v[28:31], v[20:23], 0
    v_exp_f32 v60, v60
    ds_read_b128 v[40:43], v13 offset:14336
    v_exp_f32 v61, v61
    s_mov_b32 m0, s61
    s_nop 0
    buffer_load_dwordx4 v10, s[8:11], s62 offen lds
    s_cmp_lt_u32 s62, s63
    s_cselect_b32 s67, 8192, 0
    s_add_u32 s62, s62, s67
    s_add_u32 s61, s61, s67
    v_cvt_pk_bf16_f32 v88, v56, v57
    ds_read_b128 v[44:47], v13 offset:15360
    v_exp_f32 v62, v62
    v_exp_f32 v63, v63
    v_cvt_pk_bf16_f32 v89, v58, v59
    v_mfma_f32_32x32x16_bf16 v[120:135], v[52:55], v[100:103], v[120:135]
    v_exp_f32 v64, v64
    v_exp_f32 v65, v65
    v_cvt_pk_bf16_f32 v90, v60, v61
    v_exp_f32 v66, v66
    v_exp_f32 v67, v67
    v_cvt_pk_bf16_f32 v91, v62, v63
    v_mfma_f32_32x32x8bf16_1k v[72:87], v[36:37], v[26:27], v[72:87]
    s_add_u32 s40, s98, 4608
    buffer_load_dwordx4 v[188:191], v1, s[8:11], s40 offen
    v_exp_f32 v68, v68
    v_exp_f32 v69, v69
    v_exp_f32 v70, v70
    v_exp_f32 v71, v71
    v_cvt_pk_bf16_f32 v92, v64, v65
    v_cvt_pk_bf16_f32 v93, v66, v67
    v_cvt_pk_bf16_f32 v94, v68, v69
    v_cvt_pk_bf16_f32 v95, v70, v71
    s_setprio 0
    s_waitcnt lgkmcnt(0)
    v_mfma_f32_32x32x16_bf16 v[104:119], v[40:43], v[88:91], v[104:119]
    v_exp_f32 v72, v72
    v_exp_f32 v73, v73
    v_exp_f32 v74, v74
    v_exp_f32 v75, v75
    v_mfma_f32_32x32x16_bf16 v[56:71], v[32:35], v[16:19], 0
    v_exp_f32 v76, v76
    v_exp_f32 v77, v77
    s_add_u32 s40, s98, 5120
    buffer_load_dwordx4 v[192:195], v1, s[8:11], s40 offen
    v_cvt_pk_bf16_f32 v96, v72, v73
    v_exp_f32 v78, v78
    v_exp_f32 v79, v79
    v_cvt_pk_bf16_f32 v97, v74, v75
    v_mfma_f32_32x32x16_bf16 v[104:119], v[44:47], v[92:95], v[104:119]
    v_exp_f32 v80, v80
    v_exp_f32 v81, v81
    v_cvt_pk_bf16_f32 v98, v76, v77
    v_exp_f32 v82, v82
    v_exp_f32 v83, v83
    v_cvt_pk_bf16_f32 v99, v78, v79
    v_mfma_f32_32x32x8bf16_1k v[56:71], v[38:39], v[24:25], v[56:71]
    s_add_u32 s40, s98, 5632
    buffer_load_dwordx4 v[196:199], v1, s[8:11], s40 offen
    v_exp_f32 v84, v84
    v_exp_f32 v85, v85
    v_exp_f32 v86, v86
    v_exp_f32 v87, v87
    v_cvt_pk_bf16_f32 v100, v80, v81
    v_cvt_pk_bf16_f32 v101, v82, v83
    v_cvt_pk_bf16_f32 v102, v84, v85
    v_cvt_pk_bf16_f32 v103, v86, v87
    s_setprio 3
    s_waitcnt vmcnt(10)
    s_barrier
    v_mfma_f32_32x32x16_bf16 v[120:135], v[40:43], v[96:99], v[120:135]
    ds_read_b128 v[28:31], v11 offset:28672
    v_exp_f32 v56, v56
    v_exp_f32 v57, v57
    ds_read_b64 v[36:37], v12 offset:28672
    v_exp_f32 v58, v58
    v_exp_f32 v59, v59
    v_mfma_f32_32x32x16_bf16 v[72:87], v[32:35], v[20:23], 0
    v_exp_f32 v60, v60
    ds_read_b128 v[48:51], v13 offset:16384
    v_exp_f32 v61, v61
    v_cvt_pk_bf16_f32 v88, v56, v57
    ds_read_b128 v[52:55], v13 offset:17408
    v_exp_f32 v62, v62
    v_exp_f32 v63, v63
    v_cvt_pk_bf16_f32 v89, v58, v59
    v_mfma_f32_32x32x16_bf16 v[120:135], v[44:47], v[100:103], v[120:135]
    v_exp_f32 v64, v64
    v_exp_f32 v65, v65
    v_cvt_pk_bf16_f32 v90, v60, v61
    v_exp_f32 v66, v66
    v_exp_f32 v67, v67
    v_cvt_pk_bf16_f32 v91, v62, v63
    v_mfma_f32_32x32x8bf16_1k v[72:87], v[38:39], v[26:27], v[72:87]
    v_exp_f32 v68, v68
    v_exp_f32 v69, v69
    v_exp_f32 v70, v70
    v_exp_f32 v71, v71
    v_cvt_pk_bf16_f32 v92, v64, v65
    v_cvt_pk_bf16_f32 v93, v66, v67
    v_cvt_pk_bf16_f32 v94, v68, v69
    v_cvt_pk_bf16_f32 v95, v70, v71
    s_setprio 2
    s_waitcnt lgkmcnt(0)
    v_mfma_f32_32x32x16_bf16 v[104:119], v[48:51], v[88:91], v[104:119]
    s_nop 0
    v_exp_f32 v72, v72
    v_exp_f32 v73, v73
    s_add_u32 m0, s54, 0
    s_mov_b64 exec, s[58:59]
    buffer_load_dwordx4 v8, s[8:11], s52 offen lds
    s_mov_b64 exec, -1
    s_add_u32 s52, s52, 5120
    v_exp_f32 v74, v74
    v_exp_f32 v75, v75
    v_mfma_f32_32x32x16_bf16 v[56:71], v[28:31], v[16:19], 0
    v_exp_f32 v76, v76
    v_exp_f32 v77, v77
    v_cvt_pk_bf16_f32 v96, v72, v73
    v_exp_f32 v78, v78
    v_exp_f32 v79, v79
    v_cvt_pk_bf16_f32 v97, v74, v75
    v_mfma_f32_32x32x16_bf16 v[104:119], v[52:55], v[92:95], v[104:119]
    v_exp_f32 v80, v80
    v_exp_f32 v81, v81
    s_add_u32 m0, s55, 0
    s_nop 0
    buffer_load_dwordx4 v9, s[8:11], s53 offen lds
    s_add_u32 s53, s53, 163840
    v_cvt_pk_bf16_f32 v98, v76, v77
    v_exp_f32 v82, v82
    v_exp_f32 v83, v83
    v_cvt_pk_bf16_f32 v99, v78, v79
    v_mfma_f32_32x32x8bf16_1k v[56:71], v[36:37], v[24:25], v[56:71]
    v_exp_f32 v84, v84
    v_exp_f32 v85, v85
    v_exp_f32 v86, v86
    v_exp_f32 v87, v87
    v_cvt_pk_bf16_f32 v100, v80, v81
    v_cvt_pk_bf16_f32 v101, v82, v83
    v_cvt_pk_bf16_f32 v102, v84, v85
    v_cvt_pk_bf16_f32 v103, v86, v87
    s_setprio 1
    v_mfma_f32_32x32x16_bf16 v[120:135], v[48:51], v[96:99], v[120:135]
    ds_read_b128 v[32:35], v11 offset:29696
    s_nop 0
    v_exp_f32 v56, v56
    v_exp_f32 v57, v57
    ds_read_b64 v[38:39], v12 offset:29184
    v_exp_f32 v58, v58
    v_exp_f32 v59, v59
    v_mfma_f32_32x32x16_bf16 v[72:87], v[28:31], v[20:23], 0
    v_exp_f32 v60, v60
    ds_read_b128 v[40:43], v13 offset:28672
    v_exp_f32 v61, v61
    s_mov_b32 m0, s61
    s_nop 0
    buffer_load_dwordx4 v10, s[8:11], s62 offen lds
    s_cmp_lt_u32 s62, s63
    s_cselect_b32 s67, 8192, 0
    s_add_u32 s62, s62, s67
    s_add_u32 s61, s61, s67
    v_cvt_pk_bf16_f32 v88, v56, v57
    ds_read_b128 v[44:47], v13 offset:29696
    v_exp_f32 v62, v62
    v_exp_f32 v63, v63
    v_cvt_pk_bf16_f32 v89, v58, v59
    v_mfma_f32_32x32x16_bf16 v[120:135], v[52:55], v[100:103], v[120:135]
    v_exp_f32 v64, v64
    v_exp_f32 v65, v65
    v_cvt_pk_bf16_f32 v90, v60, v61
    v_exp_f32 v66, v66
    v_exp_f32 v67, v67
    v_cvt_pk_bf16_f32 v91, v62, v63
    v_mfma_f32_32x32x8bf16_1k v[72:87], v[36:37], v[26:27], v[72:87]
    s_add_u32 s40, s98, 6144
    buffer_load_dwordx4 v[200:203], v1, s[8:11], s40 offen
    v_exp_f32 v68, v68
    v_exp_f32 v69, v69
    v_exp_f32 v70, v70
    v_exp_f32 v71, v71
    v_cvt_pk_bf16_f32 v92, v64, v65
    v_cvt_pk_bf16_f32 v93, v66, v67
    v_cvt_pk_bf16_f32 v94, v68, v69
    v_cvt_pk_bf16_f32 v95, v70, v71
    s_setprio 0
    s_waitcnt lgkmcnt(0)
    v_mfma_f32_32x32x16_bf16 v[104:119], v[40:43], v[88:91], v[104:119]
    v_exp_f32 v72, v72
    v_exp_f32 v73, v73
    v_exp_f32 v74, v74
    v_exp_f32 v75, v75
    v_mfma_f32_32x32x16_bf16 v[56:71], v[32:35], v[16:19], 0
    v_exp_f32 v76, v76
    v_exp_f32 v77, v77
    s_add_u32 s40, s98, 6656
    buffer_load_dwordx4 v[204:207], v1, s[8:11], s40 offen
    v_cvt_pk_bf16_f32 v96, v72, v73
    v_exp_f32 v78, v78
    v_exp_f32 v79, v79
    v_cvt_pk_bf16_f32 v97, v74, v75
    v_mfma_f32_32x32x16_bf16 v[104:119], v[44:47], v[92:95], v[104:119]
    v_exp_f32 v80, v80
    v_exp_f32 v81, v81
    v_cvt_pk_bf16_f32 v98, v76, v77
    v_exp_f32 v82, v82
    v_exp_f32 v83, v83
    v_cvt_pk_bf16_f32 v99, v78, v79
    v_mfma_f32_32x32x8bf16_1k v[56:71], v[38:39], v[24:25], v[56:71]
    s_add_u32 s40, s98, 7168
    buffer_load_dwordx4 v[208:211], v1, s[8:11], s40 offen
    v_exp_f32 v84, v84
    v_exp_f32 v85, v85
    v_exp_f32 v86, v86
    v_exp_f32 v87, v87
    v_cvt_pk_bf16_f32 v100, v80, v81
    v_cvt_pk_bf16_f32 v101, v82, v83
    v_cvt_pk_bf16_f32 v102, v84, v85
    v_cvt_pk_bf16_f32 v103, v86, v87
    s_setprio 3
    s_waitcnt vmcnt(10)
    s_barrier
    v_mfma_f32_32x32x16_bf16 v[120:135], v[40:43], v[96:99], v[120:135]
    ds_read_b128 v[28:31], v11 offset:43008
    v_exp_f32 v56, v56
    v_exp_f32 v57, v57
    ds_read_b64 v[36:37], v12 offset:43008
    v_exp_f32 v58, v58
    v_exp_f32 v59, v59
    v_mfma_f32_32x32x16_bf16 v[72:87], v[32:35], v[20:23], 0
    v_exp_f32 v60, v60
    ds_read_b128 v[48:51], v13 offset:30720
    v_exp_f32 v61, v61
    v_cvt_pk_bf16_f32 v88, v56, v57
    ds_read_b128 v[52:55], v13 offset:31744
    v_exp_f32 v62, v62
    v_exp_f32 v63, v63
    v_cvt_pk_bf16_f32 v89, v58, v59
    v_mfma_f32_32x32x16_bf16 v[120:135], v[44:47], v[100:103], v[120:135]
    v_exp_f32 v64, v64
    v_exp_f32 v65, v65
    v_cvt_pk_bf16_f32 v90, v60, v61
    v_exp_f32 v66, v66
    v_exp_f32 v67, v67
    v_cvt_pk_bf16_f32 v91, v62, v63
    v_mfma_f32_32x32x8bf16_1k v[72:87], v[38:39], v[26:27], v[72:87]
    s_add_u32 s40, s98, 7680
    buffer_load_dwordx4 v[212:215], v1, s[8:11], s40 offen
    v_exp_f32 v68, v68
    v_exp_f32 v69, v69
    v_exp_f32 v70, v70
    v_exp_f32 v71, v71
    v_cvt_pk_bf16_f32 v92, v64, v65
    v_cvt_pk_bf16_f32 v93, v66, v67
    v_cvt_pk_bf16_f32 v94, v68, v69
    v_cvt_pk_bf16_f32 v95, v70, v71
    s_setprio 2
    s_waitcnt lgkmcnt(0)
    v_mfma_f32_32x32x16_bf16 v[104:119], v[48:51], v[88:91], v[104:119]
    v_exp_f32 v72, v72
    v_exp_f32 v73, v73
    s_add_u32 m0, s54, 14336
    s_mov_b64 exec, s[58:59]
    buffer_load_dwordx4 v8, s[8:11], s52 offen lds
    s_mov_b64 exec, -1
    s_add_u32 s52, s52, 5120
    v_exp_f32 v74, v74
    v_exp_f32 v75, v75
    v_mfma_f32_32x32x16_bf16 v[56:71], v[28:31], v[16:19], 0
    v_exp_f32 v76, v76
    v_exp_f32 v77, v77
    v_cvt_pk_bf16_f32 v96, v72, v73
    v_exp_f32 v78, v78
    v_exp_f32 v79, v79
    v_cvt_pk_bf16_f32 v97, v74, v75
    v_mfma_f32_32x32x16_bf16 v[104:119], v[52:55], v[92:95], v[104:119]
    v_exp_f32 v80, v80
    v_exp_f32 v81, v81
    s_add_u32 m0, s55, 14336
    s_nop 0
    buffer_load_dwordx4 v9, s[8:11], s53 offen lds
    s_add_u32 s53, s53, 163840
    v_cvt_pk_bf16_f32 v98, v76, v77
    v_exp_f32 v82, v82
    v_exp_f32 v83, v83
    v_cvt_pk_bf16_f32 v99, v78, v79
    v_mfma_f32_32x32x8bf16_1k v[56:71], v[36:37], v[24:25], v[56:71]
    v_exp_f32 v84, v84
    v_exp_f32 v85, v85
    v_exp_f32 v86, v86
    v_exp_f32 v87, v87
    v_cvt_pk_bf16_f32 v100, v80, v81
    v_cvt_pk_bf16_f32 v101, v82, v83
    v_cvt_pk_bf16_f32 v102, v84, v85
    v_cvt_pk_bf16_f32 v103, v86, v87
    s_setprio 1
    v_mfma_f32_32x32x16_bf16 v[120:135], v[48:51], v[96:99], v[120:135]
    ds_read_b128 v[32:35], v11 offset:44032
    s_nop 0
    v_exp_f32 v56, v56
    v_exp_f32 v57, v57
    ds_read_b64 v[38:39], v12 offset:43520
    v_exp_f32 v58, v58
    v_exp_f32 v59, v59
    v_mfma_f32_32x32x16_bf16 v[72:87], v[28:31], v[20:23], 0
    v_exp_f32 v60, v60
    ds_read_b128 v[40:43], v13 offset:43008
    v_exp_f32 v61, v61
    s_mov_b32 m0, s61
    s_nop 0
    buffer_load_dwordx4 v10, s[8:11], s62 offen lds
    s_cmp_lt_u32 s62, s63
    s_cselect_b32 s67, 8192, 0
    s_add_u32 s62, s62, s67
    s_add_u32 s61, s61, s67
    v_cvt_pk_bf16_f32 v88, v56, v57
    ds_read_b128 v[44:47], v13 offset:44032
    v_exp_f32 v62, v62
    v_exp_f32 v63, v63
    v_cvt_pk_bf16_f32 v89, v58, v59
    v_mfma_f32_32x32x16_bf16 v[120:135], v[52:55], v[100:103], v[120:135]
    v_exp_f32 v64, v64
    v_exp_f32 v65, v65
    v_cvt_pk_bf16_f32 v90, v60, v61
    v_exp_f32 v66, v66
    v_exp_f32 v67, v67
    v_cvt_pk_bf16_f32 v91, v62, v63
    v_mfma_f32_32x32x8bf16_1k v[72:87], v[36:37], v[26:27], v[72:87]
    s_add_u32 s40, s98, 8192
    buffer_load_dwordx4 v[216:219], v1, s[8:11], s40 offen
    v_exp_f32 v68, v68
    v_exp_f32 v69, v69
    v_exp_f32 v70, v70
    v_exp_f32 v71, v71
    v_cvt_pk_bf16_f32 v92, v64, v65
    v_cvt_pk_bf16_f32 v93, v66, v67
    v_cvt_pk_bf16_f32 v94, v68, v69
    v_cvt_pk_bf16_f32 v95, v70, v71
    s_setprio 0
    s_waitcnt lgkmcnt(0)
    v_mfma_f32_32x32x16_bf16 v[104:119], v[40:43], v[88:91], v[104:119]
    v_exp_f32 v72, v72
    v_exp_f32 v73, v73
    v_exp_f32 v74, v74
    v_exp_f32 v75, v75
    v_mfma_f32_32x32x16_bf16 v[56:71], v[32:35], v[16:19], 0
    v_exp_f32 v76, v76
    v_exp_f32 v77, v77
    s_add_u32 s40, s98, 8704
    buffer_load_dwordx4 v[220:223], v1, s[8:11], s40 offen
    v_cvt_pk_bf16_f32 v96, v72, v73
    v_exp_f32 v78, v78
    v_exp_f32 v79, v79
    v_cvt_pk_bf16_f32 v97, v74, v75
    v_mfma_f32_32x32x16_bf16 v[104:119], v[44:47], v[92:95], v[104:119]
    v_exp_f32 v80, v80
    v_exp_f32 v81, v81
    v_cvt_pk_bf16_f32 v98, v76, v77
    v_exp_f32 v82, v82
    v_exp_f32 v83, v83
    v_cvt_pk_bf16_f32 v99, v78, v79
    v_mfma_f32_32x32x8bf16_1k v[56:71], v[38:39], v[24:25], v[56:71]
    s_add_u32 s40, s98, 9216
    buffer_load_dwordx4 v[224:227], v1, s[8:11], s40 offen
    v_exp_f32 v84, v84
    v_exp_f32 v85, v85
    v_exp_f32 v86, v86
    v_exp_f32 v87, v87
    v_cvt_pk_bf16_f32 v100, v80, v81
    v_cvt_pk_bf16_f32 v101, v82, v83
    v_cvt_pk_bf16_f32 v102, v84, v85
    v_cvt_pk_bf16_f32 v103, v86, v87
    s_setprio 3
    s_waitcnt vmcnt(11)
    s_barrier
    v_mfma_f32_32x32x16_bf16 v[120:135], v[40:43], v[96:99], v[120:135]
    ds_read_b128 v[28:31], v11 offset:0
    v_exp_f32 v56, v56
    v_exp_f32 v57, v57
    ds_read_b64 v[36:37], v12 offset:0
    v_exp_f32 v58, v58
    v_exp_f32 v59, v59
    v_mfma_f32_32x32x16_bf16 v[72:87], v[32:35], v[20:23], 0
    v_exp_f32 v60, v60
    ds_read_b128 v[48:51], v13 offset:45056
    v_exp_f32 v61, v61
    v_cvt_pk_bf16_f32 v88, v56, v57
    ds_read_b128 v[52:55], v13 offset:46080
    v_exp_f32 v62, v62
    v_exp_f32 v63, v63
    v_cvt_pk_bf16_f32 v89, v58, v59
    v_mfma_f32_32x32x16_bf16 v[120:135], v[44:47], v[100:103], v[120:135]
    v_exp_f32 v64, v64
    v_exp_f32 v65, v65
    v_cvt_pk_bf16_f32 v90, v60, v61
    v_exp_f32 v66, v66
    v_exp_f32 v67, v67
    v_cvt_pk_bf16_f32 v91, v62, v63
    v_mfma_f32_32x32x8bf16_1k v[72:87], v[38:39], v[26:27], v[72:87]
    s_add_u32 s40, s98, 9728
    buffer_load_dwordx4 v[228:231], v1, s[8:11], s40 offen
    v_exp_f32 v68, v68
    v_exp_f32 v69, v69
    v_exp_f32 v70, v70
    v_exp_f32 v71, v71
    v_cvt_pk_bf16_f32 v92, v64, v65
    v_cvt_pk_bf16_f32 v93, v66, v67
    v_cvt_pk_bf16_f32 v94, v68, v69
    v_cvt_pk_bf16_f32 v95, v70, v71
    s_setprio 2
    s_waitcnt lgkmcnt(0)
    v_mfma_f32_32x32x16_bf16 v[104:119], v[48:51], v[88:91], v[104:119]
    v_exp_f32 v72, v72
    v_exp_f32 v73, v73
    s_add_u32 m0, s54, 28672
    s_mov_b64 exec, s[58:59]
    buffer_load_dwordx4 v8, s[8:11], s52 offen lds
    s_mov_b64 exec, -1
    s_add_u32 s52, s52, 5120
    v_exp_f32 v74, v74
    v_exp_f32 v75, v75
    v_mfma_f32_32x32x16_bf16 v[56:71], v[28:31], v[16:19], 0
    v_exp_f32 v76, v76
    v_exp_f32 v77, v77
    v_cvt_pk_bf16_f32 v96, v72, v73
    v_exp_f32 v78, v78
    v_exp_f32 v79, v79
    v_cvt_pk_bf16_f32 v97, v74, v75
    v_mfma_f32_32x32x16_bf16 v[104:119], v[52:55], v[92:95], v[104:119]
    v_exp_f32 v80, v80
    v_exp_f32 v81, v81
    s_add_u32 m0, s55, 28672
    s_nop 0
    buffer_load_dwordx4 v9, s[8:11], s53 offen lds
    s_add_u32 s53, s53, 163840
    v_cvt_pk_bf16_f32 v98, v76, v77
    v_exp_f32 v82, v82
    v_exp_f32 v83, v83
    v_cvt_pk_bf16_f32 v99, v78, v79
    v_mfma_f32_32x32x8bf16_1k v[56:71], v[36:37], v[24:25], v[56:71]
    v_exp_f32 v84, v84
    v_exp_f32 v85, v85
    v_exp_f32 v86, v86
    v_exp_f32 v87, v87
    v_cvt_pk_bf16_f32 v100, v80, v81
    v_cvt_pk_bf16_f32 v101, v82, v83
    v_cvt_pk_bf16_f32 v102, v84, v85
    v_cvt_pk_bf16_f32 v103, v86, v87
    s_setprio 1
    v_mfma_f32_32x32x16_bf16 v[120:135], v[48:51], v[96:99], v[120:135]
    ds_read_b128 v[32:35], v11 offset:1024
    s_nop 0
    v_exp_f32 v56, v56
    v_exp_f32 v57, v57
    ds_read_b64 v[38:39], v12 offset:512
    v_exp_f32 v58, v58
    v_exp_f32 v59, v59
    v_mfma_f32_32x32x16_bf16 v[72:87], v[28:31], v[20:23], 0
    v_exp_f32 v60, v60
    ds_read_b128 v[40:43], v13 offset:0
    v_exp_f32 v61, v61
    s_mov_b32 m0, s61
    s_nop 0
    buffer_load_dwordx4 v10, s[8:11], s62 offen lds
    s_cmp_lt_u32 s62, s63
    s_cselect_b32 s67, 8192, 0
    s_add_u32 s62, s62, s67
    s_add_u32 s61, s61, s67
    v_cvt_pk_bf16_f32 v88, v56, v57
    ds_read_b128 v[44:47], v13 offset:1024
    v_exp_f32 v62, v62
    v_exp_f32 v63, v63
    v_cvt_pk_bf16_f32 v89, v58, v59
    v_mfma_f32_32x32x16_bf16 v[120:135], v[52:55], v[100:103], v[120:135]
    v_exp_f32 v64, v64
    v_exp_f32 v65, v65
    v_cvt_pk_bf16_f32 v90, v60, v61
    v_exp_f32 v66, v66
    v_exp_f32 v67, v67
    v_cvt_pk_bf16_f32 v91, v62, v63
    v_mfma_f32_32x32x8bf16_1k v[72:87], v[36:37], v[26:27], v[72:87]
    s_add_u32 s40, s98, 10240
    buffer_load_dwordx4 v[232:235], v1, s[8:11], s40 offen
    v_exp_f32 v68, v68
    v_exp_f32 v69, v69
    v_exp_f32 v70, v70
    v_exp_f32 v71, v71
    v_cvt_pk_bf16_f32 v92, v64, v65
    v_cvt_pk_bf16_f32 v93, v66, v67
    v_cvt_pk_bf16_f32 v94, v68, v69
    v_cvt_pk_bf16_f32 v95, v70, v71
    s_setprio 0
    s_waitcnt lgkmcnt(0)
    v_mfma_f32_32x32x16_bf16 v[104:119], v[40:43], v[88:91], v[104:119]
    v_exp_f32 v72, v72
    v_exp_f32 v73, v73
    v_exp_f32 v74, v74
    v_exp_f32 v75, v75
    v_mfma_f32_32x32x16_bf16 v[56:71], v[32:35], v[16:19], 0
    v_exp_f32 v76, v76
    v_exp_f32 v77, v77
    s_add_u32 s40, s98, 10752
    buffer_load_dwordx4 v[236:239], v1, s[8:11], s40 offen
    v_cvt_pk_bf16_f32 v96, v72, v73
    v_exp_f32 v78, v78
    v_exp_f32 v79, v79
    v_cvt_pk_bf16_f32 v97, v74, v75
    v_mfma_f32_32x32x16_bf16 v[104:119], v[44:47], v[92:95], v[104:119]
    v_exp_f32 v80, v80
    v_exp_f32 v81, v81
    v_cvt_pk_bf16_f32 v98, v76, v77
    v_exp_f32 v82, v82
    v_exp_f32 v83, v83
    v_cvt_pk_bf16_f32 v99, v78, v79
    v_mfma_f32_32x32x8bf16_1k v[56:71], v[38:39], v[24:25], v[56:71]
    s_add_u32 s40, s98, 11264
    buffer_load_dwordx4 v[240:243], v1, s[8:11], s40 offen
    v_exp_f32 v84, v84
    v_exp_f32 v85, v85
    v_exp_f32 v86, v86
    v_exp_f32 v87, v87
    v_cvt_pk_bf16_f32 v100, v80, v81
    v_cvt_pk_bf16_f32 v101, v82, v83
    v_cvt_pk_bf16_f32 v102, v84, v85
    v_cvt_pk_bf16_f32 v103, v86, v87
    s_setprio 3
    s_waitcnt vmcnt(11)
    s_barrier
    v_mfma_f32_32x32x16_bf16 v[120:135], v[40:43], v[96:99], v[120:135]
    ds_read_b128 v[28:31], v11 offset:14336
    v_exp_f32 v56, v56
    v_exp_f32 v57, v57
    ds_read_b64 v[36:37], v12 offset:14336
    v_exp_f32 v58, v58
    v_exp_f32 v59, v59
    v_mfma_f32_32x32x16_bf16 v[72:87], v[32:35], v[20:23], 0
    v_exp_f32 v60, v60
    ds_read_b128 v[48:51], v13 offset:2048
    v_exp_f32 v61, v61
    v_cvt_pk_bf16_f32 v88, v56, v57
    ds_read_b128 v[52:55], v13 offset:3072
    v_exp_f32 v62, v62
    v_exp_f32 v63, v63
    v_cvt_pk_bf16_f32 v89, v58, v59
    v_mfma_f32_32x32x16_bf16 v[120:135], v[44:47], v[100:103], v[120:135]
    v_exp_f32 v64, v64
    v_exp_f32 v65, v65
    v_cvt_pk_bf16_f32 v90, v60, v61
    v_exp_f32 v66, v66
    v_exp_f32 v67, v67
    v_cvt_pk_bf16_f32 v91, v62, v63
    v_mfma_f32_32x32x8bf16_1k v[72:87], v[38:39], v[26:27], v[72:87]
    v_exp_f32 v68, v68
    v_exp_f32 v69, v69
    v_exp_f32 v70, v70
    v_exp_f32 v71, v71
    v_cvt_pk_bf16_f32 v92, v64, v65
    v_cvt_pk_bf16_f32 v93, v66, v67
    v_cvt_pk_bf16_f32 v94, v68, v69
    v_cvt_pk_bf16_f32 v95, v70, v71
    s_setprio 2
    s_waitcnt lgkmcnt(0)
    v_mfma_f32_32x32x16_bf16 v[104:119], v[48:51], v[88:91], v[104:119]
    s_nop 0
    v_exp_f32 v72, v72
    v_exp_f32 v73, v73
    s_add_u32 m0, s54, 43008
    s_mov_b64 exec, s[58:59]
    buffer_load_dwordx4 v8, s[8:11], s52 offen lds
    s_mov_b64 exec, -1
    s_add_u32 s52, s52, 5120
    v_exp_f32 v74, v74
    v_exp_f32 v75, v75
    v_mfma_f32_32x32x16_bf16 v[56:71], v[28:31], v[16:19], 0
    v_exp_f32 v76, v76
    v_exp_f32 v77, v77
    v_cvt_pk_bf16_f32 v96, v72, v73
    v_exp_f32 v78, v78
    v_exp_f32 v79, v79
    v_cvt_pk_bf16_f32 v97, v74, v75
    v_mfma_f32_32x32x16_bf16 v[104:119], v[52:55], v[92:95], v[104:119]
    v_exp_f32 v80, v80
    v_exp_f32 v81, v81
    s_add_u32 m0, s55, 43008
    s_nop 0
    buffer_load_dwordx4 v9, s[8:11], s53 offen lds
    s_add_u32 s53, s53, 163840
    v_cvt_pk_bf16_f32 v98, v76, v77
    v_exp_f32 v82, v82
    v_exp_f32 v83, v83
    v_cvt_pk_bf16_f32 v99, v78, v79
    v_mfma_f32_32x32x8bf16_1k v[56:71], v[36:37], v[24:25], v[56:71]
    v_exp_f32 v84, v84
    v_exp_f32 v85, v85
    v_exp_f32 v86, v86
    v_exp_f32 v87, v87
    v_cvt_pk_bf16_f32 v100, v80, v81
    v_cvt_pk_bf16_f32 v101, v82, v83
    v_cvt_pk_bf16_f32 v102, v84, v85
    v_cvt_pk_bf16_f32 v103, v86, v87
    s_setprio 1
    v_mfma_f32_32x32x16_bf16 v[120:135], v[48:51], v[96:99], v[120:135]
    ds_read_b128 v[32:35], v11 offset:15360
    s_nop 0
    v_exp_f32 v56, v56
    v_exp_f32 v57, v57
    ds_read_b64 v[38:39], v12 offset:14848
    v_exp_f32 v58, v58
    v_exp_f32 v59, v59
    v_mfma_f32_32x32x16_bf16 v[72:87], v[28:31], v[20:23], 0
    v_exp_f32 v60, v60
    ds_read_b128 v[40:43], v13 offset:14336
    v_exp_f32 v61, v61
    s_mov_b32 m0, s61
    s_nop 0
    buffer_load_dwordx4 v10, s[8:11], s62 offen lds
    s_cmp_lt_u32 s62, s63
    s_cselect_b32 s67, 8192, 0
    s_add_u32 s62, s62, s67
    s_add_u32 s61, s61, s67
    v_cvt_pk_bf16_f32 v88, v56, v57
    ds_read_b128 v[44:47], v13 offset:15360
    v_exp_f32 v62, v62
    v_exp_f32 v63, v63
    v_cvt_pk_bf16_f32 v89, v58, v59
    v_mfma_f32_32x32x16_bf16 v[120:135], v[52:55], v[100:103], v[120:135]
    v_exp_f32 v64, v64
    v_exp_f32 v65, v65
    v_cvt_pk_bf16_f32 v90, v60, v61
    v_exp_f32 v66, v66
    v_exp_f32 v67, v67
    v_cvt_pk_bf16_f32 v91, v62, v63
    v_mfma_f32_32x32x8bf16_1k v[72:87], v[36:37], v[26:27], v[72:87]
    s_add_u32 s40, s98, 11776
    buffer_load_dwordx4 v[244:247], v1, s[8:11], s40 offen
    v_exp_f32 v68, v68
    v_exp_f32 v69, v69
    v_exp_f32 v70, v70
    v_exp_f32 v71, v71
    v_cvt_pk_bf16_f32 v92, v64, v65
    v_cvt_pk_bf16_f32 v93, v66, v67
    v_cvt_pk_bf16_f32 v94, v68, v69
    v_cvt_pk_bf16_f32 v95, v70, v71
    s_setprio 0
    s_waitcnt lgkmcnt(0)
    v_mfma_f32_32x32x16_bf16 v[104:119], v[40:43], v[88:91], v[104:119]
    v_exp_f32 v72, v72
    v_exp_f32 v73, v73
    v_exp_f32 v74, v74
    v_exp_f32 v75, v75
    v_mfma_f32_32x32x16_bf16 v[56:71], v[32:35], v[16:19], 0
    v_exp_f32 v76, v76
    v_exp_f32 v77, v77
    s_add_u32 s40, s98, 12288
    buffer_load_dwordx4 v[248:251], v1, s[8:11], s40 offen
    v_cvt_pk_bf16_f32 v96, v72, v73
    v_exp_f32 v78, v78
    v_exp_f32 v79, v79
    v_cvt_pk_bf16_f32 v97, v74, v75
    v_mfma_f32_32x32x16_bf16 v[104:119], v[44:47], v[92:95], v[104:119]
    v_exp_f32 v80, v80
    v_exp_f32 v81, v81
    v_cvt_pk_bf16_f32 v98, v76, v77
    v_exp_f32 v82, v82
    v_exp_f32 v83, v83
    v_cvt_pk_bf16_f32 v99, v78, v79
    v_mfma_f32_32x32x8bf16_1k v[56:71], v[38:39], v[24:25], v[56:71]
    s_add_u32 s40, s98, 12800
    buffer_load_dwordx4 v[252:255], v1, s[8:11], s40 offen
    v_exp_f32 v84, v84
    v_exp_f32 v85, v85
    v_exp_f32 v86, v86
    v_exp_f32 v87, v87
    v_cvt_pk_bf16_f32 v100, v80, v81
    v_cvt_pk_bf16_f32 v101, v82, v83
    v_cvt_pk_bf16_f32 v102, v84, v85
    v_cvt_pk_bf16_f32 v103, v86, v87
    s_setprio 3
    s_waitcnt vmcnt(10)
    s_barrier
    v_mfma_f32_32x32x16_bf16 v[120:135], v[40:43], v[96:99], v[120:135]
    ds_read_b128 v[28:31], v11 offset:28672
    v_exp_f32 v56, v56
    v_exp_f32 v57, v57
    ds_read_b64 v[36:37], v12 offset:28672
    v_exp_f32 v58, v58
    v_exp_f32 v59, v59
    v_mfma_f32_32x32x16_bf16 v[72:87], v[32:35], v[20:23], 0
    v_exp_f32 v60, v60
    ds_read_b128 v[48:51], v13 offset:16384
    v_exp_f32 v61, v61
    v_cvt_pk_bf16_f32 v88, v56, v57
    ds_read_b128 v[52:55], v13 offset:17408
    v_exp_f32 v62, v62
    v_exp_f32 v63, v63
    v_cvt_pk_bf16_f32 v89, v58, v59
    v_mfma_f32_32x32x16_bf16 v[120:135], v[44:47], v[100:103], v[120:135]
    v_exp_f32 v64, v64
    v_exp_f32 v65, v65
    v_cvt_pk_bf16_f32 v90, v60, v61
    v_exp_f32 v66, v66
    v_exp_f32 v67, v67
    v_cvt_pk_bf16_f32 v91, v62, v63
    v_mfma_f32_32x32x8bf16_1k v[72:87], v[38:39], v[26:27], v[72:87]
    v_exp_f32 v68, v68
    v_exp_f32 v69, v69
    v_exp_f32 v70, v70
    v_exp_f32 v71, v71
    v_cvt_pk_bf16_f32 v92, v64, v65
    v_cvt_pk_bf16_f32 v93, v66, v67
    v_cvt_pk_bf16_f32 v94, v68, v69
    v_cvt_pk_bf16_f32 v95, v70, v71
    s_setprio 2
    s_waitcnt lgkmcnt(0)
    v_mfma_f32_32x32x16_bf16 v[104:119], v[48:51], v[88:91], v[104:119]
    s_nop 0
    v_exp_f32 v72, v72
    v_exp_f32 v73, v73
    s_add_u32 m0, s54, 0
    s_mov_b64 exec, s[58:59]
    buffer_load_dwordx4 v8, s[8:11], s52 offen lds
    s_mov_b64 exec, -1
    s_add_u32 s52, s52, 5120
    v_exp_f32 v74, v74
    v_exp_f32 v75, v75
    v_mfma_f32_32x32x16_bf16 v[56:71], v[28:31], v[16:19], 0
    v_exp_f32 v76, v76
    v_exp_f32 v77, v77
    v_cvt_pk_bf16_f32 v96, v72, v73
    v_exp_f32 v78, v78
    v_exp_f32 v79, v79
    v_cvt_pk_bf16_f32 v97, v74, v75
    v_mfma_f32_32x32x16_bf16 v[104:119], v[52:55], v[92:95], v[104:119]
    v_exp_f32 v80, v80
    v_exp_f32 v81, v81
    s_add_u32 m0, s55, 0
    s_nop 0
    buffer_load_dwordx4 v9, s[8:11], s53 offen lds
    s_add_u32 s53, s53, 163840
    v_cvt_pk_bf16_f32 v98, v76, v77
    v_exp_f32 v82, v82
    v_exp_f32 v83, v83
    v_cvt_pk_bf16_f32 v99, v78, v79
    v_mfma_f32_32x32x8bf16_1k v[56:71], v[36:37], v[24:25], v[56:71]
    v_exp_f32 v84, v84
    v_exp_f32 v85, v85
    v_exp_f32 v86, v86
    v_exp_f32 v87, v87
    v_cvt_pk_bf16_f32 v100, v80, v81
    v_cvt_pk_bf16_f32 v101, v82, v83
    v_cvt_pk_bf16_f32 v102, v84, v85
    v_cvt_pk_bf16_f32 v103, v86, v87
    s_setprio 1
    v_mfma_f32_32x32x16_bf16 v[120:135], v[48:51], v[96:99], v[120:135]
    ds_read_b128 v[32:35], v11 offset:29696
    s_nop 0
    v_exp_f32 v56, v56
    v_exp_f32 v57, v57
    ds_read_b64 v[38:39], v12 offset:29184
    v_exp_f32 v58, v58
    v_exp_f32 v59, v59
    v_mfma_f32_32x32x16_bf16 v[72:87], v[28:31], v[20:23], 0
    v_exp_f32 v60, v60
    ds_read_b128 v[40:43], v13 offset:28672
    v_exp_f32 v61, v61
    s_mov_b32 m0, s61
    s_nop 0
    buffer_load_dwordx4 v10, s[8:11], s62 offen lds
    s_cmp_lt_u32 s62, s63
    s_cselect_b32 s67, 8192, 0
    s_add_u32 s62, s62, s67
    s_add_u32 s61, s61, s67
    v_cvt_pk_bf16_f32 v88, v56, v57
    ds_read_b128 v[44:47], v13 offset:29696
    v_exp_f32 v62, v62
    v_exp_f32 v63, v63
    v_cvt_pk_bf16_f32 v89, v58, v59
    v_mfma_f32_32x32x16_bf16 v[120:135], v[52:55], v[100:103], v[120:135]
    v_exp_f32 v64, v64
    v_exp_f32 v65, v65
    v_cvt_pk_bf16_f32 v90, v60, v61
    v_exp_f32 v66, v66
    v_exp_f32 v67, v67
    v_cvt_pk_bf16_f32 v91, v62, v63
    v_mfma_f32_32x32x8bf16_1k v[72:87], v[36:37], v[26:27], v[72:87]
    v_exp_f32 v68, v68
    v_exp_f32 v69, v69
    v_exp_f32 v70, v70
    v_exp_f32 v71, v71
    v_cvt_pk_bf16_f32 v92, v64, v65
    v_cvt_pk_bf16_f32 v93, v66, v67
    v_cvt_pk_bf16_f32 v94, v68, v69
    v_cvt_pk_bf16_f32 v95, v70, v71
    s_setprio 0
    s_waitcnt lgkmcnt(0)
    v_mfma_f32_32x32x16_bf16 v[104:119], v[40:43], v[88:91], v[104:119]
    s_nop 0
    v_exp_f32 v72, v72
    v_exp_f32 v73, v73
    v_exp_f32 v74, v74
    v_exp_f32 v75, v75
    v_mfma_f32_32x32x16_bf16 v[56:71], v[32:35], v[16:19], 0
    v_exp_f32 v76, v76
    v_exp_f32 v77, v77
    v_cvt_pk_bf16_f32 v96, v72, v73
    v_exp_f32 v78, v78
    v_exp_f32 v79, v79
    v_cvt_pk_bf16_f32 v97, v74, v75
    v_mfma_f32_32x32x16_bf16 v[104:119], v[44:47], v[92:95], v[104:119]
    v_exp_f32 v80, v80
    s_sub_u32 s40, s12, 4
    s_cmp_lt_u32 s40, 2
    s_cselect_b32 s40, 0, s38
    buffer_load_dword v149, v148, s[8:11], s40 offen
    v_exp_f32 v81, v81
    v_cvt_pk_bf16_f32 v98, v76, v77
    v_exp_f32 v82, v82
    v_exp_f32 v83, v83
    v_cvt_pk_bf16_f32 v99, v78, v79
    v_mfma_f32_32x32x8bf16_1k v[56:71], v[38:39], v[24:25], v[56:71]
    v_exp_f32 v84, v84
    v_exp_f32 v85, v85
    v_exp_f32 v86, v86
    v_exp_f32 v87, v87
    v_cvt_pk_bf16_f32 v100, v80, v81
    v_cvt_pk_bf16_f32 v101, v82, v83
    v_cvt_pk_bf16_f32 v102, v84, v85
    v_cvt_pk_bf16_f32 v103, v86, v87
    s_setprio 3
    s_waitcnt vmcnt(8)
    s_barrier
    v_mfma_f32_32x32x16_bf16 v[120:135], v[40:43], v[96:99], v[120:135]
    ds_read_b128 v[28:31], v11 offset:43008
    v_exp_f32 v56, v56
    v_exp_f32 v57, v57
    ds_read_b64 v[36:37], v12 offset:43008
    v_exp_f32 v58, v58
    v_exp_f32 v59, v59
    v_mfma_f32_32x32x16_bf16 v[72:87], v[32:35], v[20:23], 0
    v_exp_f32 v60, v60
    ds_read_b128 v[48:51], v13 offset:30720
    v_exp_f32 v61, v61
    v_cvt_pk_bf16_f32 v88, v56, v57
    ds_read_b128 v[52:55], v13 offset:31744
    v_exp_f32 v62, v62
    v_exp_f32 v63, v63
    v_cvt_pk_bf16_f32 v89, v58, v59
    v_mfma_f32_32x32x16_bf16 v[120:135], v[44:47], v[100:103], v[120:135]
    v_exp_f32 v64, v64
    v_exp_f32 v65, v65
    v_cvt_pk_bf16_f32 v90, v60, v61
    v_exp_f32 v66, v66
    v_exp_f32 v67, v67
    v_cvt_pk_bf16_f32 v91, v62, v63
    v_mfma_f32_32x32x8bf16_1k v[72:87], v[38:39], v[26:27], v[72:87]
    v_exp_f32 v68, v68
    v_exp_f32 v69, v69
    v_exp_f32 v70, v70
    v_exp_f32 v71, v71
    v_cvt_pk_bf16_f32 v92, v64, v65
    v_cvt_pk_bf16_f32 v93, v66, v67
    v_cvt_pk_bf16_f32 v94, v68, v69
    v_cvt_pk_bf16_f32 v95, v70, v71
    s_setprio 2
    s_waitcnt lgkmcnt(0)
    v_mfma_f32_32x32x16_bf16 v[104:119], v[48:51], v[88:91], v[104:119]
    s_nop 0
    v_exp_f32 v72, v72
    v_exp_f32 v73, v73
    s_add_u32 m0, s54, 14336
    s_mov_b64 exec, s[58:59]
    buffer_load_dwordx4 v8, s[8:11], s52 offen lds
    s_mov_b64 exec, -1
    s_add_u32 s52, s52, 5120
    v_exp_f32 v74, v74
    v_exp_f32 v75, v75
    v_mfma_f32_32x32x16_bf16 v[56:71], v[28:31], v[16:19], 0
    v_exp_f32 v76, v76
    v_exp_f32 v77, v77
    v_cvt_pk_bf16_f32 v96, v72, v73
    v_exp_f32 v78, v78
    v_exp_f32 v79, v79
    v_cvt_pk_bf16_f32 v97, v74, v75
    v_mfma_f32_32x32x16_bf16 v[104:119], v[52:55], v[92:95], v[104:119]
    v_exp_f32 v80, v80
    v_exp_f32 v81, v81
    s_add_u32 m0, s55, 14336
    s_nop 0
    buffer_load_dwordx4 v9, s[8:11], s53 offen lds
    s_add_u32 s53, s53, 163840
    v_cvt_pk_bf16_f32 v98, v76, v77
    v_exp_f32 v82, v82
    v_exp_f32 v83, v83
    v_cvt_pk_bf16_f32 v99, v78, v79
    v_mfma_f32_32x32x8bf16_1k v[56:71], v[36:37], v[24:25], v[56:71]
    v_exp_f32 v84, v84
    v_exp_f32 v85, v85
    v_exp_f32 v86, v86
    v_exp_f32 v87, v87
    v_cvt_pk_bf16_f32 v100, v80, v81
    v_cvt_pk_bf16_f32 v101, v82, v83
    v_cvt_pk_bf16_f32 v102, v84, v85
    v_cvt_pk_bf16_f32 v103, v86, v87
    s_setprio 1
    v_mfma_f32_32x32x16_bf16 v[120:135], v[48:51], v[96:99], v[120:135]
    ds_read_b128 v[32:35], v11 offset:44032
    s_nop 0
    v_exp_f32 v56, v56
    v_exp_f32 v57, v57
    ds_read_b64 v[38:39], v12 offset:43520
    v_exp_f32 v58, v58
    v_exp_f32 v59, v59
    v_mfma_f32_32x32x16_bf16 v[72:87], v[28:31], v[20:23], 0
    v_exp_f32 v60, v60
    ds_read_b128 v[40:43], v13 offset:43008
    v_exp_f32 v61, v61
    s_mov_b32 m0, s61
    s_nop 0
    buffer_load_dwordx4 v10, s[8:11], s62 offen lds
    s_cmp_lt_u32 s62, s63
    s_cselect_b32 s67, 8192, 0
    s_add_u32 s62, s62, s67
    s_add_u32 s61, s61, s67
    v_cvt_pk_bf16_f32 v88, v56, v57
    ds_read_b128 v[44:47], v13 offset:44032
    v_exp_f32 v62, v62
    v_exp_f32 v63, v63
    v_cvt_pk_bf16_f32 v89, v58, v59
    v_mfma_f32_32x32x16_bf16 v[120:135], v[52:55], v[100:103], v[120:135]
    v_exp_f32 v64, v64
    v_exp_f32 v65, v65
    v_cvt_pk_bf16_f32 v90, v60, v61
    v_exp_f32 v66, v66
    v_exp_f32 v67, v67
    v_cvt_pk_bf16_f32 v91, v62, v63
    v_mfma_f32_32x32x8bf16_1k v[72:87], v[36:37], v[26:27], v[72:87]
    v_exp_f32 v68, v68
    v_exp_f32 v69, v69
    v_exp_f32 v70, v70
    v_exp_f32 v71, v71
    v_cvt_pk_bf16_f32 v92, v64, v65
    v_cvt_pk_bf16_f32 v93, v66, v67
    v_cvt_pk_bf16_f32 v94, v68, v69
    v_cvt_pk_bf16_f32 v95, v70, v71
    s_setprio 0
    s_waitcnt lgkmcnt(0)
    v_mfma_f32_32x32x16_bf16 v[104:119], v[40:43], v[88:91], v[104:119]
    s_nop 0
    v_exp_f32 v72, v72
    v_exp_f32 v73, v73
    v_exp_f32 v74, v74
    v_exp_f32 v75, v75
    v_mfma_f32_32x32x16_bf16 v[56:71], v[32:35], v[16:19], 0
    v_exp_f32 v76, v76
    v_exp_f32 v77, v77
    v_cvt_pk_bf16_f32 v96, v72, v73
    v_exp_f32 v78, v78
    v_exp_f32 v79, v79
    v_cvt_pk_bf16_f32 v97, v74, v75
    v_mfma_f32_32x32x16_bf16 v[104:119], v[44:47], v[92:95], v[104:119]
    v_exp_f32 v80, v80
    s_sub_u32 s40, s12, 6
    s_cmp_lt_u32 s40, 2
    s_cselect_b32 s40, 0, s38
    buffer_load_dword v149, v148, s[8:11], s40 offen
    v_exp_f32 v81, v81
    v_cvt_pk_bf16_f32 v98, v76, v77
    v_exp_f32 v82, v82
    v_exp_f32 v83, v83
    v_cvt_pk_bf16_f32 v99, v78, v79
    v_mfma_f32_32x32x8bf16_1k v[56:71], v[38:39], v[24:25], v[56:71]
    v_exp_f32 v84, v84
    v_exp_f32 v85, v85
    v_exp_f32 v86, v86
    v_exp_f32 v87, v87
    v_cvt_pk_bf16_f32 v100, v80, v81
    v_cvt_pk_bf16_f32 v101, v82, v83
    v_cvt_pk_bf16_f32 v102, v84, v85
    v_cvt_pk_bf16_f32 v103, v86, v87
    s_setprio 3
    s_waitcnt vmcnt(6)
    s_barrier
    v_mfma_f32_32x32x16_bf16 v[120:135], v[40:43], v[96:99], v[120:135]
    ds_read_b128 v[28:31], v11 offset:0
    v_exp_f32 v56, v56
    v_exp_f32 v57, v57
    ds_read_b64 v[36:37], v12 offset:0
    v_exp_f32 v58, v58
    v_exp_f32 v59, v59
    v_mfma_f32_32x32x16_bf16 v[72:87], v[32:35], v[20:23], 0
    v_exp_f32 v60, v60
    ds_read_b128 v[48:51], v13 offset:45056
    v_exp_f32 v61, v61
    v_cvt_pk_bf16_f32 v88, v56, v57
    ds_read_b128 v[52:55], v13 offset:46080
    v_exp_f32 v62, v62
    v_exp_f32 v63, v63
    v_cvt_pk_bf16_f32 v89, v58, v59
    v_mfma_f32_32x32x16_bf16 v[120:135], v[44:47], v[100:103], v[120:135]
    v_exp_f32 v64, v64
    v_exp_f32 v65, v65
    v_cvt_pk_bf16_f32 v90, v60, v61
    v_exp_f32 v66, v66
    v_exp_f32 v67, v67
    v_cvt_pk_bf16_f32 v91, v62, v63
    v_mfma_f32_32x32x8bf16_1k v[72:87], v[38:39], v[26:27], v[72:87]
    v_exp_f32 v68, v68
    v_exp_f32 v69, v69
    v_exp_f32 v70, v70
    v_exp_f32 v71, v71
    v_cvt_pk_bf16_f32 v92, v64, v65
    v_cvt_pk_bf16_f32 v93, v66, v67
    v_cvt_pk_bf16_f32 v94, v68, v69
    v_cvt_pk_bf16_f32 v95, v70, v71
    s_setprio 2
    s_waitcnt lgkmcnt(0)
    v_mfma_f32_32x32x16_bf16 v[104:119], v[48:51], v[88:91], v[104:119]
    s_nop 0
    v_exp_f32 v72, v72
    v_exp_f32 v73, v73
    s_add_u32 m0, s54, 28672
    s_mov_b64 exec, s[58:59]
    buffer_load_dwordx4 v8, s[8:11], s52 offen lds
    s_mov_b64 exec, -1
    s_add_u32 s52, s52, 5120
    v_exp_f32 v74, v74
    v_exp_f32 v75, v75
    v_mfma_f32_32x32x16_bf16 v[56:71], v[28:31], v[16:19], 0
    v_exp_f32 v76, v76
    v_exp_f32 v77, v77
    v_cvt_pk_bf16_f32 v96, v72, v73
    v_exp_f32 v78, v78
    v_exp_f32 v79, v79
    v_cvt_pk_bf16_f32 v97, v74, v75
    v_mfma_f32_32x32x16_bf16 v[104:119], v[52:55], v[92:95], v[104:119]
    v_exp_f32 v80, v80
    v_exp_f32 v81, v81
    s_add_u32 m0, s55, 28672
    s_nop 0
    buffer_load_dwordx4 v9, s[8:11], s53 offen lds
    s_add_u32 s53, s53, 163840
    v_cvt_pk_bf16_f32 v98, v76, v77
    v_exp_f32 v82, v82
    v_exp_f32 v83, v83
    v_cvt_pk_bf16_f32 v99, v78, v79
    v_mfma_f32_32x32x8bf16_1k v[56:71], v[36:37], v[24:25], v[56:71]
    v_exp_f32 v84, v84
    v_exp_f32 v85, v85
    v_exp_f32 v86, v86
    v_exp_f32 v87, v87
    v_cvt_pk_bf16_f32 v100, v80, v81
    v_cvt_pk_bf16_f32 v101, v82, v83
    v_cvt_pk_bf16_f32 v102, v84, v85
    v_cvt_pk_bf16_f32 v103, v86, v87
    s_setprio 1
    v_mfma_f32_32x32x16_bf16 v[120:135], v[48:51], v[96:99], v[120:135]
    ds_read_b128 v[32:35], v11 offset:1024
    s_nop 0
    v_exp_f32 v56, v56
    v_exp_f32 v57, v57
    ds_read_b64 v[38:39], v12 offset:512
    v_exp_f32 v58, v58
    v_exp_f32 v59, v59
    v_mfma_f32_32x32x16_bf16 v[72:87], v[28:31], v[20:23], 0
    v_exp_f32 v60, v60
    ds_read_b128 v[40:43], v13 offset:0
    v_exp_f32 v61, v61
    s_lshl_b32 s40, s64, 7
    s_add_u32 s40, s40, 30822400
    v_lshlrev_b32 v150, 2, v3
    buffer_load_dword v150, v150, s[8:11], s40 offen sc1
    v_cvt_pk_bf16_f32 v88, v56, v57
    ds_read_b128 v[44:47], v13 offset:1024
    v_exp_f32 v62, v62
    v_exp_f32 v63, v63
    v_cvt_pk_bf16_f32 v89, v58, v59
    v_mfma_f32_32x32x16_bf16 v[120:135], v[52:55], v[100:103], v[120:135]
    v_exp_f32 v64, v64
    v_exp_f32 v65, v65
    v_cvt_pk_bf16_f32 v90, v60, v61
    v_exp_f32 v66, v66
    v_exp_f32 v67, v67
    v_cvt_pk_bf16_f32 v91, v62, v63
    v_mfma_f32_32x32x8bf16_1k v[72:87], v[36:37], v[26:27], v[72:87]
    v_exp_f32 v68, v68
    v_exp_f32 v69, v69
    v_exp_f32 v70, v70
    v_exp_f32 v71, v71
    v_cvt_pk_bf16_f32 v92, v64, v65
    v_cvt_pk_bf16_f32 v93, v66, v67
    v_cvt_pk_bf16_f32 v94, v68, v69
    v_cvt_pk_bf16_f32 v95, v70, v71
    s_setprio 0
    s_waitcnt lgkmcnt(0)
    v_mfma_f32_32x32x16_bf16 v[104:119], v[40:43], v[88:91], v[104:119]
    s_nop 0
    v_exp_f32 v72, v72
    v_exp_f32 v73, v73
    v_exp_f32 v74, v74
    v_exp_f32 v75, v75
    v_mfma_f32_32x32x16_bf16 v[56:71], v[32:35], v[16:19], 0
    v_exp_f32 v76, v76
    v_exp_f32 v77, v77
    v_cvt_pk_bf16_f32 v96, v72, v73
    v_exp_f32 v78, v78
    v_exp_f32 v79, v79
    v_cvt_pk_bf16_f32 v97, v74, v75
    v_mfma_f32_32x32x16_bf16 v[104:119], v[44:47], v[92:95], v[104:119]
    v_exp_f32 v80, v80
    s_sub_u32 s40, s12, 0
    s_cmp_lt_u32 s40, 4
    s_cselect_b32 s40, 0, s38
    buffer_load_dword v149, v148, s[8:11], s40 offen
    v_exp_f32 v81, v81
    v_cvt_pk_bf16_f32 v98, v76, v77
    v_exp_f32 v82, v82
    v_exp_f32 v83, v83
    v_cvt_pk_bf16_f32 v99, v78, v79
    v_mfma_f32_32x32x8bf16_1k v[56:71], v[38:39], v[24:25], v[56:71]
    v_exp_f32 v84, v84
    v_exp_f32 v85, v85
    v_exp_f32 v86, v86
    v_exp_f32 v87, v87
    v_cvt_pk_bf16_f32 v100, v80, v81
    v_cvt_pk_bf16_f32 v101, v82, v83
    v_cvt_pk_bf16_f32 v102, v84, v85
    v_cvt_pk_bf16_f32 v103, v86, v87
    s_setprio 3
    s_waitcnt vmcnt(6)
    s_barrier
    v_mfma_f32_32x32x16_bf16 v[120:135], v[40:43], v[96:99], v[120:135]
    ds_read_b128 v[28:31], v11 offset:14336
    v_exp_f32 v56, v56
    v_exp_f32 v57, v57
    ds_read_b64 v[36:37], v12 offset:14336
    v_exp_f32 v58, v58
    v_exp_f32 v59, v59
    v_mfma_f32_32x32x16_bf16 v[72:87], v[32:35], v[20:23], 0
    v_exp_f32 v60, v60
    ds_read_b128 v[48:51], v13 offset:2048
    v_exp_f32 v61, v61
    v_cvt_pk_bf16_f32 v88, v56, v57
    ds_read_b128 v[52:55], v13 offset:3072
    v_exp_f32 v62, v62
    v_exp_f32 v63, v63
    v_cvt_pk_bf16_f32 v89, v58, v59
    v_mfma_f32_32x32x16_bf16 v[120:135], v[44:47], v[100:103], v[120:135]
    v_exp_f32 v64, v64
    v_exp_f32 v65, v65
    v_cvt_pk_bf16_f32 v90, v60, v61
    v_exp_f32 v66, v66
    v_exp_f32 v67, v67
    v_cvt_pk_bf16_f32 v91, v62, v63
    v_mfma_f32_32x32x8bf16_1k v[72:87], v[38:39], v[26:27], v[72:87]
    v_exp_f32 v68, v68
    v_exp_f32 v69, v69
    v_exp_f32 v70, v70
    v_exp_f32 v71, v71
    v_cvt_pk_bf16_f32 v92, v64, v65
    v_cvt_pk_bf16_f32 v93, v66, v67
    v_cvt_pk_bf16_f32 v94, v68, v69
    v_cvt_pk_bf16_f32 v95, v70, v71
    s_setprio 2
    s_waitcnt lgkmcnt(0)
    v_mfma_f32_32x32x16_bf16 v[104:119], v[48:51], v[88:91], v[104:119]
    s_nop 0
    v_exp_f32 v72, v72
    v_exp_f32 v73, v73
    s_add_u32 m0, s54, 43008
    s_mov_b64 exec, s[58:59]
    buffer_load_dwordx4 v8, s[8:11], s52 offen lds
    s_mov_b64 exec, -1
    s_add_u32 s52, s52, 5120
    v_exp_f32 v74, v74
    v_exp_f32 v75, v75
    v_mfma_f32_32x32x16_bf16 v[56:71], v[28:31], v[16:19], 0
    v_exp_f32 v76, v76
    v_exp_f32 v77, v77
    v_cvt_pk_bf16_f32 v96, v72, v73
    v_exp_f32 v78, v78
    v_exp_f32 v79, v79
    v_cvt_pk_bf16_f32 v97, v74, v75
    v_mfma_f32_32x32x16_bf16 v[104:119], v[52:55], v[92:95], v[104:119]
    v_exp_f32 v80, v80
    v_exp_f32 v81, v81
    s_add_u32 m0, s55, 43008
    s_nop 0
    buffer_load_dwordx4 v9, s[8:11], s53 offen lds
    s_add_u32 s53, s53, 163840
    v_cvt_pk_bf16_f32 v98, v76, v77
    v_exp_f32 v82, v82
    v_exp_f32 v83, v83
    v_cvt_pk_bf16_f32 v99, v78, v79
    v_mfma_f32_32x32x8bf16_1k v[56:71], v[36:37], v[24:25], v[56:71]
    v_exp_f32 v84, v84
    v_exp_f32 v85, v85
    v_exp_f32 v86, v86
    v_exp_f32 v87, v87
    v_cvt_pk_bf16_f32 v100, v80, v81
    v_cvt_pk_bf16_f32 v101, v82, v83
    v_cvt_pk_bf16_f32 v102, v84, v85
    v_cvt_pk_bf16_f32 v103, v86, v87
    s_setprio 1
    v_mfma_f32_32x32x16_bf16 v[120:135], v[48:51], v[96:99], v[120:135]
    ds_read_b128 v[32:35], v11 offset:15360
    s_nop 0
    v_exp_f32 v56, v56
    v_exp_f32 v57, v57
    ds_read_b64 v[38:39], v12 offset:14848
    v_exp_f32 v58, v58
    v_exp_f32 v59, v59
    v_mfma_f32_32x32x16_bf16 v[72:87], v[28:31], v[20:23], 0
    v_exp_f32 v60, v60
    ds_read_b128 v[40:43], v13 offset:14336
    v_exp_f32 v61, v61
    v_cvt_pk_bf16_f32 v88, v56, v57
    ds_read_b128 v[44:47], v13 offset:15360
    v_exp_f32 v62, v62
    v_exp_f32 v63, v63
    v_cvt_pk_bf16_f32 v89, v58, v59
    v_mfma_f32_32x32x16_bf16 v[120:135], v[52:55], v[100:103], v[120:135]
    v_exp_f32 v64, v64
    v_exp_f32 v65, v65
    v_cvt_pk_bf16_f32 v90, v60, v61
    v_exp_f32 v66, v66
    v_exp_f32 v67, v67
    v_cvt_pk_bf16_f32 v91, v62, v63
    v_mfma_f32_32x32x8bf16_1k v[72:87], v[36:37], v[26:27], v[72:87]
    v_exp_f32 v68, v68
    v_exp_f32 v69, v69
    v_exp_f32 v70, v70
    v_exp_f32 v71, v71
    v_cvt_pk_bf16_f32 v92, v64, v65
    v_cvt_pk_bf16_f32 v93, v66, v67
    v_cvt_pk_bf16_f32 v94, v68, v69
    v_cvt_pk_bf16_f32 v95, v70, v71
    s_setprio 0
    s_waitcnt lgkmcnt(0)
    v_mfma_f32_32x32x16_bf16 v[104:119], v[40:43], v[88:91], v[104:119]
    s_nop 0
    v_exp_f32 v72, v72
    v_exp_f32 v73, v73
    v_exp_f32 v74, v74
    v_exp_f32 v75, v75
    v_mfma_f32_32x32x16_bf16 v[56:71], v[32:35], v[16:19], 0
    v_exp_f32 v76, v76
    v_exp_f32 v77, v77
    v_cvt_pk_bf16_f32 v96, v72, v73
    v_exp_f32 v78, v78
    v_exp_f32 v79, v79
    v_cvt_pk_bf16_f32 v97, v74, v75
    v_mfma_f32_32x32x16_bf16 v[104:119], v[44:47], v[92:95], v[104:119]
    v_exp_f32 v80, v80
    buffer_load_dword v149, v147, s[8:11], s51 offen
    v_exp_f32 v81, v81
    v_cvt_pk_bf16_f32 v98, v76, v77
    v_exp_f32 v82, v82
    v_exp_f32 v83, v83
    v_cvt_pk_bf16_f32 v99, v78, v79
    v_mfma_f32_32x32x8bf16_1k v[56:71], v[38:39], v[24:25], v[56:71]
    v_exp_f32 v84, v84
    v_exp_f32 v85, v85
    v_exp_f32 v86, v86
    v_exp_f32 v87, v87
    v_cvt_pk_bf16_f32 v100, v80, v81
    v_cvt_pk_bf16_f32 v101, v82, v83
    v_cvt_pk_bf16_f32 v102, v84, v85
    v_cvt_pk_bf16_f32 v103, v86, v87
    s_setprio 3
    s_waitcnt vmcnt(5)
    s_barrier
    v_mfma_f32_32x32x16_bf16 v[120:135], v[40:43], v[96:99], v[120:135]
    ds_read_b128 v[28:31], v11 offset:28672
    v_exp_f32 v56, v56
    v_exp_f32 v57, v57
    ds_read_b64 v[36:37], v12 offset:28672
    v_exp_f32 v58, v58
    v_exp_f32 v59, v59
    v_mfma_f32_32x32x16_bf16 v[72:87], v[32:35], v[20:23], 0
    v_exp_f32 v60, v60
    ds_read_b128 v[48:51], v13 offset:16384
    v_exp_f32 v61, v61
    v_cvt_pk_bf16_f32 v88, v56, v57
    ds_read_b128 v[52:55], v13 offset:17408
    v_exp_f32 v62, v62
    v_exp_f32 v63, v63
    v_cvt_pk_bf16_f32 v89, v58, v59
    v_mfma_f32_32x32x16_bf16 v[120:135], v[44:47], v[100:103], v[120:135]
    v_exp_f32 v64, v64
    v_exp_f32 v65, v65
    v_cvt_pk_bf16_f32 v90, v60, v61
    v_exp_f32 v66, v66
    v_exp_f32 v67, v67
    v_cvt_pk_bf16_f32 v91, v62, v63
    v_mfma_f32_32x32x8bf16_1k v[72:87], v[38:39], v[26:27], v[72:87]
    v_exp_f32 v68, v68
    v_exp_f32 v69, v69
    v_exp_f32 v70, v70
    v_exp_f32 v71, v71
    v_cvt_pk_bf16_f32 v92, v64, v65
    v_cvt_pk_bf16_f32 v93, v66, v67
    v_cvt_pk_bf16_f32 v94, v68, v69
    v_cvt_pk_bf16_f32 v95, v70, v71
    s_setprio 2
    s_waitcnt lgkmcnt(0)
    v_mfma_f32_32x32x16_bf16 v[104:119], v[48:51], v[88:91], v[104:119]
    s_nop 0
    v_exp_f32 v72, v72
    v_exp_f32 v73, v73
    v_exp_f32 v74, v74
    v_exp_f32 v75, v75
    v_mfma_f32_32x32x16_bf16 v[56:71], v[28:31], v[16:19], 0
    v_exp_f32 v76, v76
    v_exp_f32 v77, v77
    v_cvt_pk_bf16_f32 v96, v72, v73
    v_exp_f32 v78, v78
    v_exp_f32 v79, v79
    v_cvt_pk_bf16_f32 v97, v74, v75
    v_mfma_f32_32x32x16_bf16 v[104:119], v[52:55], v[92:95], v[104:119]
    v_exp_f32 v80, v80
    v_exp_f32 v81, v81
    v_cvt_pk_bf16_f32 v98, v76, v77
    v_exp_f32 v82, v82
    v_exp_f32 v83, v83
    v_cvt_pk_bf16_f32 v99, v78, v79
    v_mfma_f32_32x32x8bf16_1k v[56:71], v[36:37], v[24:25], v[56:71]
    buffer_load_dwordx2 v[136:137], v0, s[72:75], s57 offen offset:0
    buffer_load_dwordx2 v[138:139], v0, s[72:75], s57 offen offset:32
    buffer_load_dwordx2 v[140:141], v0, s[72:75], s57 offen offset:64
    v_exp_f32 v84, v84
    v_exp_f32 v85, v85
    v_exp_f32 v86, v86
    v_exp_f32 v87, v87
    v_cvt_pk_bf16_f32 v100, v80, v81
    v_cvt_pk_bf16_f32 v101, v82, v83
    v_cvt_pk_bf16_f32 v102, v84, v85
    v_cvt_pk_bf16_f32 v103, v86, v87
    s_setprio 1
    v_mfma_f32_32x32x16_bf16 v[120:135], v[48:51], v[96:99], v[120:135]
    ds_read_b128 v[32:35], v11 offset:29696
    v_exp_f32 v56, v56
    v_exp_f32 v57, v57
    ds_read_b64 v[38:39], v12 offset:29184
    v_exp_f32 v58, v58
    v_exp_f32 v59, v59
    v_mfma_f32_32x32x16_bf16 v[72:87], v[28:31], v[20:23], 0
    v_exp_f32 v60, v60
    ds_read_b128 v[40:43], v13 offset:28672
    v_exp_f32 v61, v61
    v_cvt_pk_bf16_f32 v88, v56, v57
    ds_read_b128 v[44:47], v13 offset:29696
    v_exp_f32 v62, v62
    v_exp_f32 v63, v63
    v_cvt_pk_bf16_f32 v89, v58, v59
    v_mfma_f32_32x32x16_bf16 v[120:135], v[52:55], v[100:103], v[120:135]
    v_exp_f32 v64, v64
    v_exp_f32 v65, v65
    v_cvt_pk_bf16_f32 v90, v60, v61
    v_exp_f32 v66, v66
    v_exp_f32 v67, v67
    v_cvt_pk_bf16_f32 v91, v62, v63
    v_mfma_f32_32x32x8bf16_1k v[72:87], v[36:37], v[26:27], v[72:87]
    v_exp_f32 v68, v68
    v_exp_f32 v69, v69
    v_exp_f32 v70, v70
    v_exp_f32 v71, v71
    v_cvt_pk_bf16_f32 v92, v64, v65
    v_cvt_pk_bf16_f32 v93, v66, v67
    v_cvt_pk_bf16_f32 v94, v68, v69
    v_cvt_pk_bf16_f32 v95, v70, v71
    s_setprio 0
    s_waitcnt lgkmcnt(0)
    v_mfma_f32_32x32x16_bf16 v[104:119], v[40:43], v[88:91], v[104:119]
    s_nop 0
    v_exp_f32 v72, v72
    v_exp_f32 v73, v73
    v_exp_f32 v74, v74
    v_exp_f32 v75, v75
    v_mfma_f32_32x32x16_bf16 v[56:71], v[32:35], v[16:19], 0
    v_exp_f32 v76, v76
    v_exp_f32 v77, v77
    v_cvt_pk_bf16_f32 v96, v72, v73
    v_exp_f32 v78, v78
    v_exp_f32 v79, v79
    v_cvt_pk_bf16_f32 v97, v74, v75
    v_mfma_f32_32x32x16_bf16 v[104:119], v[44:47], v[92:95], v[104:119]
    v_exp_f32 v80, v80
    v_exp_f32 v81, v81
    v_cvt_pk_bf16_f32 v98, v76, v77
    v_exp_f32 v82, v82
    v_exp_f32 v83, v83
    v_cvt_pk_bf16_f32 v99, v78, v79
    v_mfma_f32_32x32x8bf16_1k v[56:71], v[38:39], v[24:25], v[56:71]
    v_exp_f32 v84, v84
    v_exp_f32 v85, v85
    v_exp_f32 v86, v86
    v_exp_f32 v87, v87
    v_cvt_pk_bf16_f32 v100, v80, v81
    v_cvt_pk_bf16_f32 v101, v82, v83
    v_cvt_pk_bf16_f32 v102, v84, v85
    v_cvt_pk_bf16_f32 v103, v86, v87
    s_setprio 3
    s_waitcnt vmcnt(4)
    s_barrier
    v_mfma_f32_32x32x16_bf16 v[120:135], v[40:43], v[96:99], v[120:135]
    ds_read_b128 v[28:31], v11 offset:43008
    v_exp_f32 v56, v56
    v_exp_f32 v57, v57
    ds_read_b64 v[36:37], v12 offset:43008
    v_exp_f32 v58, v58
    v_exp_f32 v59, v59
    v_mfma_f32_32x32x16_bf16 v[72:87], v[32:35], v[20:23], 0
    v_exp_f32 v60, v60
    ds_read_b128 v[48:51], v13 offset:30720
    v_exp_f32 v61, v61
    v_cvt_pk_bf16_f32 v88, v56, v57
    ds_read_b128 v[52:55], v13 offset:31744
    v_exp_f32 v62, v62
    v_exp_f32 v63, v63
    v_cvt_pk_bf16_f32 v89, v58, v59
    v_mfma_f32_32x32x16_bf16 v[120:135], v[44:47], v[100:103], v[120:135]
    v_exp_f32 v64, v64
    v_exp_f32 v65, v65
    v_cvt_pk_bf16_f32 v90, v60, v61
    v_exp_f32 v66, v66
    v_exp_f32 v67, v67
    v_cvt_pk_bf16_f32 v91, v62, v63
    v_mfma_f32_32x32x8bf16_1k v[72:87], v[38:39], v[26:27], v[72:87]
    v_exp_f32 v68, v68
    v_exp_f32 v69, v69
    v_exp_f32 v70, v70
    v_exp_f32 v71, v71
    v_cvt_pk_bf16_f32 v92, v64, v65
    v_cvt_pk_bf16_f32 v93, v66, v67
    v_cvt_pk_bf16_f32 v94, v68, v69
    v_cvt_pk_bf16_f32 v95, v70, v71
    s_setprio 3
    s_waitcnt lgkmcnt(0)
    v_mfma_f32_32x32x16_bf16 v[104:119], v[48:51], v[88:91], v[104:119]
    s_nop 0
    v_exp_f32 v72, v72
    v_exp_f32 v73, v73
    v_exp_f32 v74, v74
    v_exp_f32 v75, v75
    v_mfma_f32_32x32x16_bf16 v[56:71], v[28:31], v[16:19], 0
    v_exp_f32 v76, v76
    v_exp_f32 v77, v77
    v_cvt_pk_bf16_f32 v96, v72, v73
    v_exp_f32 v78, v78
    v_exp_f32 v79, v79
    v_cvt_pk_bf16_f32 v97, v74, v75
    v_mfma_f32_32x32x16_bf16 v[104:119], v[52:55], v[92:95], v[104:119]
    v_exp_f32 v80, v80
    v_exp_f32 v81, v81
    v_cvt_pk_bf16_f32 v98, v76, v77
    v_exp_f32 v82, v82
    v_exp_f32 v83, v83
    v_cvt_pk_bf16_f32 v99, v78, v79
    v_mfma_f32_32x32x8bf16_1k v[56:71], v[36:37], v[24:25], v[56:71]
    v_exp_f32 v84, v84
    v_exp_f32 v85, v85
    v_exp_f32 v86, v86
    v_exp_f32 v87, v87
    v_cvt_pk_bf16_f32 v100, v80, v81
    v_cvt_pk_bf16_f32 v101, v82, v83
    v_cvt_pk_bf16_f32 v102, v84, v85
    v_cvt_pk_bf16_f32 v103, v86, v87
    s_setprio 2
    v_mfma_f32_32x32x16_bf16 v[120:135], v[48:51], v[96:99], v[120:135]
    ds_read_b128 v[32:35], v11 offset:44032
    s_nop 0
    v_exp_f32 v56, v56
    v_exp_f32 v57, v57
    ds_read_b64 v[38:39], v12 offset:43520
    v_exp_f32 v58, v58
    v_exp_f32 v59, v59
    v_mfma_f32_32x32x16_bf16 v[72:87], v[28:31], v[20:23], 0
    v_exp_f32 v60, v60
    ds_read_b128 v[40:43], v13 offset:43008
    v_exp_f32 v61, v61
    v_cvt_pk_bf16_f32 v88, v56, v57
    ds_read_b128 v[44:47], v13 offset:44032
    v_exp_f32 v62, v62
    v_exp_f32 v63, v63
    v_cvt_pk_bf16_f32 v89, v58, v59
    v_mfma_f32_32x32x16_bf16 v[120:135], v[52:55], v[100:103], v[120:135]
    v_exp_f32 v64, v64
    v_exp_f32 v65, v65
    v_cvt_pk_bf16_f32 v90, v60, v61
    v_exp_f32 v66, v66
    v_exp_f32 v67, v67
    v_cvt_pk_bf16_f32 v91, v62, v63
    v_mfma_f32_32x32x8bf16_1k v[72:87], v[36:37], v[26:27], v[72:87]
    v_exp_f32 v68, v68
    v_exp_f32 v69, v69
    v_exp_f32 v70, v70
    v_exp_f32 v71, v71
    v_cvt_pk_bf16_f32 v92, v64, v65
    v_cvt_pk_bf16_f32 v93, v66, v67
    v_cvt_pk_bf16_f32 v94, v68, v69
    v_cvt_pk_bf16_f32 v95, v70, v71
    s_setprio 1
    s_waitcnt lgkmcnt(0)
    v_mfma_f32_32x32x16_bf16 v[104:119], v[40:43], v[88:91], v[104:119]
    s_nop 0
    v_exp_f32 v72, v72
    v_exp_f32 v73, v73
    v_exp_f32 v74, v74
    v_exp_f32 v75, v75
    v_mfma_f32_32x32x16_bf16 v[56:71], v[32:35], v[16:19], 0
    v_exp_f32 v76, v76
    v_exp_f32 v77, v77
    v_cvt_pk_bf16_f32 v96, v72, v73
    v_exp_f32 v78, v78
    v_exp_f32 v79, v79
    v_cvt_pk_bf16_f32 v97, v74, v75
    v_mfma_f32_32x32x16_bf16 v[104:119], v[44:47], v[92:95], v[104:119]
    v_exp_f32 v80, v80
    v_exp_f32 v81, v81
    v_cvt_pk_bf16_f32 v98, v76, v77
    v_exp_f32 v82, v82
    v_exp_f32 v83, v83
    v_cvt_pk_bf16_f32 v99, v78, v79
    v_mfma_f32_32x32x8bf16_1k v[56:71], v[38:39], v[24:25], v[56:71]
    v_exp_f32 v84, v84
    v_exp_f32 v85, v85
    v_exp_f32 v86, v86
    v_exp_f32 v87, v87
    v_cvt_pk_bf16_f32 v100, v80, v81
    v_cvt_pk_bf16_f32 v101, v82, v83
    v_cvt_pk_bf16_f32 v102, v84, v85
    v_cvt_pk_bf16_f32 v103, v86, v87
    s_setprio 1
    v_mfma_f32_32x32x16_bf16 v[120:135], v[40:43], v[96:99], v[120:135]
    s_nop 1
    v_exp_f32 v56, v56
    v_exp_f32 v57, v57
    v_exp_f32 v58, v58
    v_exp_f32 v59, v59
    v_mfma_f32_32x32x16_bf16 v[72:87], v[32:35], v[20:23], 0
    v_exp_f32 v60, v60
    ds_read_b128 v[48:51], v13 offset:45056
    v_exp_f32 v61, v61
    v_cvt_pk_bf16_f32 v88, v56, v57
    ds_read_b128 v[52:55], v13 offset:46080
    v_exp_f32 v62, v62
    v_exp_f32 v63, v63
    v_cvt_pk_bf16_f32 v89, v58, v59
    v_mfma_f32_32x32x16_bf16 v[120:135], v[44:47], v[100:103], v[120:135]
    v_exp_f32 v64, v64
    v_exp_f32 v65, v65
    v_cvt_pk_bf16_f32 v90, v60, v61
    v_exp_f32 v66, v66
    v_exp_f32 v67, v67
    v_cvt_pk_bf16_f32 v91, v62, v63
    v_mfma_f32_32x32x8bf16_1k v[72:87], v[38:39], v[26:27], v[72:87]
    v_exp_f32 v68, v68
    v_exp_f32 v69, v69
    v_exp_f32 v70, v70
    v_exp_f32 v71, v71
    v_cvt_pk_bf16_f32 v92, v64, v65
    v_cvt_pk_bf16_f32 v93, v66, v67
    v_cvt_pk_bf16_f32 v94, v68, v69
    v_cvt_pk_bf16_f32 v95, v70, v71
    s_setprio 0
    s_waitcnt lgkmcnt(0)
    v_mfma_f32_32x32x16_bf16 v[104:119], v[48:51], v[88:91], v[104:119]
    s_nop 0
    v_exp_f32 v72, v72
    v_exp_f32 v73, v73
    v_exp_f32 v74, v74
    v_exp_f32 v75, v75
    v_exp_f32 v76, v76
    v_exp_f32 v77, v77
    v_cvt_pk_bf16_f32 v96, v72, v73
    v_exp_f32 v78, v78
    v_exp_f32 v79, v79
    v_cvt_pk_bf16_f32 v97, v74, v75
    v_mfma_f32_32x32x16_bf16 v[104:119], v[52:55], v[92:95], v[104:119]
    v_exp_f32 v80, v80
    v_exp_f32 v81, v81
    v_cvt_pk_bf16_f32 v98, v76, v77
    v_exp_f32 v82, v82
    v_exp_f32 v83, v83
    v_cvt_pk_bf16_f32 v99, v78, v79
    v_exp_f32 v84, v84
    v_exp_f32 v85, v85
    v_exp_f32 v86, v86
    v_exp_f32 v87, v87
    v_cvt_pk_bf16_f32 v100, v80, v81
    v_cvt_pk_bf16_f32 v101, v82, v83
    v_cvt_pk_bf16_f32 v102, v84, v85
    v_cvt_pk_bf16_f32 v103, v86, v87
    v_mfma_f32_32x32x16_bf16 v[120:135], v[48:51], v[96:99], v[120:135]
    s_nop 0
    v_mfma_f32_32x32x16_bf16 v[120:135], v[52:55], v[100:103], v[120:135]
    s_setprio 0
    s_mov_b32 s41, 0
    v_cmp_eq_u32 vcc, 0, v150
    s_cbranch_vccz .Lxt13
.Lxt12:
    s_lshl_b32 s40, s64, 7
    s_add_u32 s40, s40, 30822400
    v_lshlrev_b32 v14, 2, v3
    buffer_load_dword v150, v14, s[8:11], s40 offen sc1
    s_add_u32 s41, s41, 1
    s_waitcnt vmcnt(0)
    v_cmp_eq_u32 vcc, 0, v150
    s_cbranch_vccz .Lxt13
    s_cmp_lt_u32 s41, 40000
    s_cbranch_scc1 .Lxt12
.Lxt13:
    v_cmp_ne_u32 vcc, s66, v150
    s_nop 3
    s_cmp_eq_u64 vcc, 0
    s_cselect_b32 s66, 1, 0
.Lat_combine:
    s_cmp_eq_u32 s46, 0
    s_cbranch_scc1 .Lat_noswap
    s_nop 7
    v_swap_b32 v104, v120
    v_swap_b32 v105, v121
    v_swap_b32 v106, v122
    v_swap_b32 v107, v123
    v_swap_b32 v108, v124
    v_swap_b32 v109, v125
    v_swap_b32 v110, v126
    v_swap_b32 v111, v127
    v_swap_b32 v112, v128
    v_swap_b32 v113, v129
    v_swap_b32 v114, v130
    v_swap_b32 v115, v131
.Lat_noswap:
    s_nop 7
    s_mul_i32 s40, s12, 3072
    v_add_u32 v14, s40, v10
    ds_write_b128 v14, v[120:123] offset:0
    ds_write_b128 v14, v[124:127] offset:1024
    ds_write_b128 v14, v[128:131] offset:2048
    s_xor_b32 s40, s12, 4
    s_mul_i32 s40, s40, 3072
    v_add_u32 v14, s40, v10
    s_waitcnt lgkmcnt(0)
    s_barrier
    ds_read_b128 v[56:59], v14 offset:0
    ds_read_b128 v[60:63], v14 offset:1024
    ds_read_b128 v[64:67], v14 offset:2048
    s_waitcnt lgkmcnt(0)
    v_add_f32 v104, v104, v56
    v_add_f32 v105, v105, v57
    v_add_f32 v106, v106, v58
    v_add_f32 v107, v107, v59
    v_add_f32 v108, v108, v60
    v_add_f32 v109, v109, v61
    v_add_f32 v110, v110, v62
    v_add_f32 v111, v111, v63
    v_add_f32 v112, v112, v64
    v_add_f32 v113, v113, v65
    v_add_f32 v114, v114, v66
    v_add_f32 v115, v115, v67
    v_mov_b32 v56, v112
    v_mov_b32 v57, v112
    s_nop 1
    v_permlane32_swap_b32 v56, v57
    v_mov_b32 v58, 0
    v_fmac_f32 v58, 0, v104
    v_fmac_f32 v58, 0, v105
    v_fmac_f32 v58, 0, v106
    v_fmac_f32 v58, 0, v107
    v_fmac_f32 v58, 0, v108
    v_fmac_f32 v58, 0, v109
    v_fmac_f32 v58, 0, v110
    v_fmac_f32 v58, 0, v111
    v_fmac_f32 v58, 0, v112
    v_fmac_f32 v58, 0, v113
    v_fmac_f32 v58, 0, v114
    v_fmac_f32 v58, 0, v115
    s_mov_b32 s40, 0x1f800000
    v_cmp_nle_f32 vcc, s40, v57
    s_mov_b32 s40, 0x5f800000
    v_cmp_nge_f32 s[44:45], s40, v57
    s_nop 3
    s_or_b64 s[44:45], s[44:45], vcc
    v_cmp_u_f32 vcc, v58, v58
    s_nop 3
    s_or_b64 s[44:45], s[44:45], vcc
    s_cmp_eq_u64 s[44:45], 0
    s_cbranch_scc1 .Lok14
    v_mov_b32 v58, 159744
    v_mov_b32 v59, 1
    ds_write_b32 v58, v59
.Lok14:
    v_rcp_f32 v57, v57
    s_nop 0
    v_mul_f32 v104, v104, v57
    v_mul_f32 v105, v105, v57
    v_mul_f32 v106, v106, v57
    v_mul_f32 v107, v107, v57
    v_mul_f32 v108, v108, v57
    v_mul_f32 v109, v109, v57
    v_mul_f32 v110, v110, v57
    v_mul_f32 v111, v111, v57
    v_mul_f32 v112, v112, v57
    v_mul_f32 v113, v113, v57
    v_mul_f32 v114, v114, v57
    v_mul_f32 v115, v115, v57
    v_cvt_pk_bf16_f32 v60, v104, v105
    v_cvt_pk_bf16_f32 v61, v106, v107
    v_cvt_pk_bf16_f32 v62, v108, v109
    v_cvt_pk_bf16_f32 v63, v110, v111
    v_cvt_pk_bf16_f32 v64, v112, v113
    v_cvt_pk_bf16_f32 v65, v114, v115
    s_mul_i32 s61, s46, 40960
    s_add_u32 s61, s61, s47
    s_add_u32 s61, s61, 18186240
    s_lshl_b32 s62, s42, 8
    s_add_u32 s62, s62, s61
    s_lshl_b32 s63, s43, 8
    s_add_u32 s63, s63, s61
    s_and_b32 s61, s36, 1
    s_lshl_b32 s61, s61, 3
    s_add_u32 s63, s63, s61
    s_cmp_eq_u32 s66, 1
    s_cbranch_scc0 .Lst15
    buffer_store_dwordx4 v[60:63], v7, s[8:11], s62 offen
    s_mov_b64 exec, 0xffffffff
    buffer_store_dwordx2 v[64:65], v5, s[8:11], s63 offen
    s_mov_b64 exec, -1
    s_branch .Lst16
.Lst15:
    buffer_store_dwordx4 v[60:63], v7, s[8:11], s62 offen sc1
    s_mov_b64 exec, 0xffffffff
    buffer_store_dwordx2 v[64:65], v5, s[8:11], s63 offen sc1
    s_mov_b64 exec, -1
.Lst16:
    s_and_b32 s20, s65, 3
    s_lshr_b32 s21, s65, 2
    s_and_b32 s22, s12, 3
    s_lshr_b32 s23, s12, 2
    s_lshl_b32 s29, s64, 4
    s_lshl_b32 s30, s20, 2
    s_add_u32 s29, s29, s30
    s_add_u32 s29, s29, s22
    v_and_b32 v14, 15, v2
    v_lshrrev_b32 v15, 4, v2
    s_mul_i32 s30, s29, 20480
    s_mul_i32 s31, s23, 10240
    s_add_u32 s30, s30, s31
    s_add_u32 s30, s30, 18186240
    s_mul_i32 s33, s23, 10240
    s_add_u32 s33, s33, 57344
    s_cmp_eq_u32 s23, 0
    s_cselect_b32 s34, 0, 61440
    s_add_u32 s34, s34, s33
    v_add_u32 v142, s34, v10
    s_cmp_eq_u32 s23, 0
    s_cselect_b32 s34, 40960, 0
    s_add_u32 s34, s34, s33
    v_add_u32 v143, s34, v10
    s_cmp_eq_u32 s23, 0
    s_mov_b32 s35, 20480
    s_cselect_b32 s34, 61440, s35
    s_add_u32 s34, s34, s33
    v_add_u32 v145, s34, v10
    s_mul_i32 s40, s12, 3072
    s_add_u32 s40, s40, 32768
    v_add_u32 v146, s40, v10
    s_xor_b32 s40, s12, 4
    s_mul_i32 s40, s40, 3072
    s_lshl_b32 s41, s23, 10
    s_add_u32 s40, s40, s41
    s_add_u32 s40, s40, 32768
    v_add_u32 v147, s40, v10
    s_mul_i32 s34, s29, 20480
    s_mul_i32 s35, s21, 2560
    s_add_u32 s34, s34, s35
    s_mul_i32 s35, s23, 1536
    s_add_u32 s34, s34, s35
    s_add_u32 s34, s34, 20807680
    v_lshrrev_b32 v148, 1, v15
    v_lshlrev_b32 v148, 8, v148
    v_lshl_add_u32 v148, v14, 4, v148
    v_and_b32 v144, 1, v15
    v_lshl_add_u32 v148, v144, 3, v148
    s_lshl_b32 s33, s29, 7
    s_lshl_b32 s35, s21, 1
    s_add_u32 s35, s35, s23
    s_lshl_b32 s35, s35, 14
    s_add_u32 s33, s33, s35
    s_add_u32 s33, s33, 30556160
    v_lshlrev_b32 v144, 3, v14
    s_cmp_eq_u32 s23, 0
    s_cselect_b32 s35, s34, 2147479552
    s_waitcnt vmcnt(2)
    v_lshlrev_b32 v96, 16, v136
    v_and_b32 v97, 0xffff0000, v136
    v_lshlrev_b32 v98, 16, v137
    v_and_b32 v99, 0xffff0000, v137
    v_lshlrev_b32 v100, 16, v138
    v_and_b32 v101, 0xffff0000, v138
    v_lshlrev_b32 v102, 16, v139
    v_and_b32 v103, 0xffff0000, v139
    v_lshlrev_b32 v104, 16, v140
    v_and_b32 v105, 0xffff0000, v140
    v_lshlrev_b32 v106, 16, v141
    v_and_b32 v107, 0xffff0000, v141
    s_cmp_eq_u32 s23, 0
    s_cselect_b64 vcc, -1, 0
    v_cndmask_b32 v104, 0, v104, vcc
    v_cndmask_b32 v105, 0, v105, vcc
    v_cndmask_b32 v106, 0, v106, vcc
    v_cndmask_b32 v107, 0, v107, vcc
    v_mov_b32 v108, 0
    v_mov_b32 v109, 0
    v_mov_b32 v110, 0
    v_mov_b32 v111, 0
    v_mov_b32 v112, 0
    v_mov_b32 v113, 0
    v_mov_b32 v114, 0
    v_mov_b32 v115, 0
    s_waitcnt vmcnt(0) lgkmcnt(0)
    s_barrier
    v_mov_b32 v14, 159744
    ds_read_b32 v15, v14
    s_waitcnt lgkmcnt(0)
    v_readfirstlane_b32 s40, v15
    s_nop 3
    s_sub_u32 s40, s40, s39
    s_cmp_eq_u32 s40, 1
    s_cbranch_scc1 .Lat_fallback
.Lat_done:
    s_cmp_lg_u32 s12, 0
    s_cbranch_scc1 .Lsy17
    s_lshl_b32 s40, s37, 7
    s_lshl_b32 s41, s36, 2
    s_add_u32 s40, s40, s41
    s_add_u32 s40, s40, 30818304
    v_mov_b32 v14, 0
    v_mov_b32 v15, 1
    s_mov_b64 exec, 1
    s_cmp_eq_u32 s66, 1
    s_cbranch_scc0 .Lst22
    buffer_store_dword v15, v14, s[8:11], s40 offen
    s_branch .Lst23
.Lst22:
    buffer_store_dword v15, v14, s[8:11], s40 offen sc1
.Lst23:
    s_mov_b64 exec, -1
    s_mov_b32 s44, -1
    s_mov_b32 s45, 0
    s_lshl_b32 s40, s64, 7
    s_add_u32 s40, s40, 30818304
    v_lshlrev_b32 v14, 2, v2
    s_mov_b64 exec, s[44:45]
    s_mov_b32 s41, 0
.Lsy19:
    buffer_load_dword v15, v14, s[8:11], s40 offen sc1
    s_add_u32 s41, s41, 1
    s_waitcnt vmcnt(0)
    v_cmp_eq_u32 vcc, 0, v15
    s_cbranch_vccz .Lsy20
    s_cmp_lt_u32 s41, 40000
    s_cbranch_scc1 .Lsy19
.Lsy20:
    s_mov_b64 exec, -1
    s_cmp_eq_u32 s66, 1
    s_cbranch_scc1 .Lsy21
    buffer_inv sc1
    s_waitcnt vmcnt(0)
.Lsy21:
    s_barrier
    s_branch .Lsy18
.Lsy17:
    s_barrier
.Lsy18:
    s_add_u32 s31, s30, 0
    buffer_load_dwordx4 v[16:19], v10, s[8:11], s31 offen offset:0 sc1
    buffer_load_dwordx4 v[20:23], v10, s[8:11], s31 offen offset:1024 sc1
    buffer_load_dwordx4 v[24:27], v10, s[8:11], s31 offen offset:2048 sc1
    buffer_load_dwordx4 v[28:31], v10, s[8:11], s31 offen offset:3072 sc1
    s_add_u32 s31, s30, 4096
    buffer_load_dwordx4 v[32:35], v10, s[8:11], s31 offen offset:0 sc1
    buffer_load_dwordx4 v[36:39], v10, s[8:11], s31 offen offset:1024 sc1
    buffer_load_dwordx4 v[40:43], v10, s[8:11], s31 offen offset:2048 sc1
    buffer_load_dwordx4 v[44:47], v10, s[8:11], s31 offen offset:3072 sc1
    s_add_u32 s31, s30, 8192
    buffer_load_dwordx4 v[48:51], v10, s[8:11], s31 offen offset:0 sc1
    buffer_load_dwordx4 v[52:55], v10, s[8:11], s31 offen offset:1024 sc1
    ds_read_b128 v[56:59], v142 offset:0
    ds_read_b128 v[60:63], v142 offset:20480
    ds_read_b128 v[64:67], v143 offset:0
    ds_read_b128 v[68:71], v145 offset:0
    ds_read_b128 v[72:75], v145 offset:20480
    ds_read_b128 v[76:79], v142 offset:1024
    ds_read_b128 v[80:83], v142 offset:21504
    ds_read_b128 v[84:87], v143 offset:1024
    ds_read_b128 v[88:91], v145 offset:1024
    ds_read_b128 v[92:95], v145 offset:21504
    s_waitcnt vmcnt(9) lgkmcnt(5)
    v_mfma_f32_16x16x32_bf16 v[104:107], v[64:67], v[16:19], v[104:107]
    v_mfma_f32_16x16x32_bf16 v[108:111], v[68:71], v[16:19], v[108:111]
    v_mfma_f32_16x16x32_bf16 v[112:115], v[72:75], v[16:19], v[112:115]
    v_mfma_f32_16x16x32_bf16 v[96:99], v[56:59], v[16:19], v[96:99]
    v_mfma_f32_16x16x32_bf16 v[100:103], v[60:63], v[16:19], v[100:103]
    ds_read_b128 v[56:59], v142 offset:2048
    ds_read_b128 v[60:63], v142 offset:22528
    ds_read_b128 v[64:67], v143 offset:2048
    ds_read_b128 v[68:71], v145 offset:2048
    ds_read_b128 v[72:75], v145 offset:22528
    s_waitcnt vmcnt(8) lgkmcnt(5)
    v_mfma_f32_16x16x32_bf16 v[104:107], v[84:87], v[20:23], v[104:107]
    v_mfma_f32_16x16x32_bf16 v[108:111], v[88:91], v[20:23], v[108:111]
    v_mfma_f32_16x16x32_bf16 v[112:115], v[92:95], v[20:23], v[112:115]
    v_mfma_f32_16x16x32_bf16 v[96:99], v[76:79], v[20:23], v[96:99]
    v_mfma_f32_16x16x32_bf16 v[100:103], v[80:83], v[20:23], v[100:103]
    ds_read_b128 v[76:79], v142 offset:3072
    ds_read_b128 v[80:83], v142 offset:23552
    ds_read_b128 v[84:87], v143 offset:3072
    ds_read_b128 v[88:91], v145 offset:3072
    ds_read_b128 v[92:95], v145 offset:23552
    s_waitcnt vmcnt(7) lgkmcnt(5)
    v_mfma_f32_16x16x32_bf16 v[104:107], v[64:67], v[24:27], v[104:107]
    v_mfma_f32_16x16x32_bf16 v[108:111], v[68:71], v[24:27], v[108:111]
    v_mfma_f32_16x16x32_bf16 v[112:115], v[72:75], v[24:27], v[112:115]
    v_mfma_f32_16x16x32_bf16 v[96:99], v[56:59], v[24:27], v[96:99]
    v_mfma_f32_16x16x32_bf16 v[100:103], v[60:63], v[24:27], v[100:103]
    ds_read_b128 v[56:59], v142 offset:4096
    ds_read_b128 v[60:63], v142 offset:24576
    ds_read_b128 v[64:67], v143 offset:4096
    ds_read_b128 v[68:71], v145 offset:4096
    ds_read_b128 v[72:75], v145 offset:24576
    s_waitcnt vmcnt(6) lgkmcnt(5)
    v_mfma_f32_16x16x32_bf16 v[104:107], v[84:87], v[28:31], v[104:107]
    v_mfma_f32_16x16x32_bf16 v[108:111], v[88:91], v[28:31], v[108:111]
    v_mfma_f32_16x16x32_bf16 v[112:115], v[92:95], v[28:31], v[112:115]
    v_mfma_f32_16x16x32_bf16 v[96:99], v[76:79], v[28:31], v[96:99]
    v_mfma_f32_16x16x32_bf16 v[100:103], v[80:83], v[28:31], v[100:103]
    ds_read_b128 v[76:79], v142 offset:5120
    ds_read_b128 v[80:83], v142 offset:25600
    ds_read_b128 v[84:87], v143 offset:5120
    ds_read_b128 v[88:91], v145 offset:5120
    ds_read_b128 v[92:95], v145 offset:25600
    s_waitcnt vmcnt(5) lgkmcnt(5)
    v_mfma_f32_16x16x32_bf16 v[104:107], v[64:67], v[32:35], v[104:107]
    v_mfma_f32_16x16x32_bf16 v[108:111], v[68:71], v[32:35], v[108:111]
    v_mfma_f32_16x16x32_bf16 v[112:115], v[72:75], v[32:35], v[112:115]
    v_mfma_f32_16x16x32_bf16 v[96:99], v[56:59], v[32:35], v[96:99]
    v_mfma_f32_16x16x32_bf16 v[100:103], v[60:63], v[32:35], v[100:103]
    ds_read_b128 v[56:59], v142 offset:6144
    ds_read_b128 v[60:63], v142 offset:26624
    ds_read_b128 v[64:67], v143 offset:6144
    ds_read_b128 v[68:71], v145 offset:6144
    ds_read_b128 v[72:75], v145 offset:26624
    s_waitcnt vmcnt(4) lgkmcnt(5)
    v_mfma_f32_16x16x32_bf16 v[104:107], v[84:87], v[36:39], v[104:107]
    v_mfma_f32_16x16x32_bf16 v[108:111], v[88:91], v[36:39], v[108:111]
    v_mfma_f32_16x16x32_bf16 v[112:115], v[92:95], v[36:39], v[112:115]
    v_mfma_f32_16x16x32_bf16 v[96:99], v[76:79], v[36:39], v[96:99]
    v_mfma_f32_16x16x32_bf16 v[100:103], v[80:83], v[36:39], v[100:103]
    ds_read_b128 v[76:79], v142 offset:7168
    ds_read_b128 v[80:83], v142 offset:27648
    ds_read_b128 v[84:87], v143 offset:7168
    ds_read_b128 v[88:91], v145 offset:7168
    ds_read_b128 v[92:95], v145 offset:27648
    s_waitcnt vmcnt(3) lgkmcnt(5)
    v_mfma_f32_16x16x32_bf16 v[104:107], v[64:67], v[40:43], v[104:107]
    v_mfma_f32_16x16x32_bf16 v[108:111], v[68:71], v[40:43], v[108:111]
    v_mfma_f32_16x16x32_bf16 v[112:115], v[72:75], v[40:43], v[112:115]
    v_mfma_f32_16x16x32_bf16 v[96:99], v[56:59], v[40:43], v[96:99]
    v_mfma_f32_16x16x32_bf16 v[100:103], v[60:63], v[40:43], v[100:103]
    ds_read_b128 v[56:59], v142 offset:8192
    ds_read_b128 v[60:63], v142 offset:28672
    ds_read_b128 v[64:67], v143 offset:8192
    ds_read_b128 v[68:71], v145 offset:8192
    ds_read_b128 v[72:75], v145 offset:28672
    s_waitcnt vmcnt(2) lgkmcnt(5)
    v_mfma_f32_16x16x32_bf16 v[104:107], v[84:87], v[44:47], v[104:107]
    v_mfma_f32_16x16x32_bf16 v[108:111], v[88:91], v[44:47], v[108:111]
    v_mfma_f32_16x16x32_bf16 v[112:115], v[92:95], v[44:47], v[112:115]
    v_mfma_f32_16x16x32_bf16 v[96:99], v[76:79], v[44:47], v[96:99]
    v_mfma_f32_16x16x32_bf16 v[100:103], v[80:83], v[44:47], v[100:103]
    ds_read_b128 v[76:79], v142 offset:9216
    ds_read_b128 v[80:83], v142 offset:29696
    ds_read_b128 v[84:87], v143 offset:9216
    ds_read_b128 v[88:91], v145 offset:9216
    ds_read_b128 v[92:95], v145 offset:29696
    s_waitcnt vmcnt(1) lgkmcnt(5)
    v_mfma_f32_16x16x32_bf16 v[104:107], v[64:67], v[48:51], v[104:107]
    v_mfma_f32_16x16x32_bf16 v[108:111], v[68:71], v[48:51], v[108:111]
    v_mfma_f32_16x16x32_bf16 v[112:115], v[72:75], v[48:51], v[112:115]
    v_mfma_f32_16x16x32_bf16 v[96:99], v[56:59], v[48:51], v[96:99]
    v_mfma_f32_16x16x32_bf16 v[100:103], v[60:63], v[48:51], v[100:103]
    s_waitcnt vmcnt(0) lgkmcnt(0)
    v_mfma_f32_16x16x32_bf16 v[104:107], v[84:87], v[52:55], v[104:107]
    v_mfma_f32_16x16x32_bf16 v[108:111], v[88:91], v[52:55], v[108:111]
    v_mfma_f32_16x16x32_bf16 v[112:115], v[92:95], v[52:55], v[112:115]
    v_mfma_f32_16x16x32_bf16 v[96:99], v[76:79], v[52:55], v[96:99]
    v_mfma_f32_16x16x32_bf16 v[100:103], v[80:83], v[52:55], v[100:103]
    s_nop 3
    ds_write_b128 v146, v[104:107] offset:0
    ds_write_b128 v146, v[108:111] offset:1024
    ds_write_b128 v146, v[112:115] offset:2048
    s_waitcnt lgkmcnt(0)
    s_barrier
    ds_read_b128 v[116:119], v147 offset:0
    ds_read_b128 v[120:123], v147 offset:1024
    ds_read_b128 v[124:127], v147 offset:2048
    s_waitcnt lgkmcnt(0)
    v_add_f32 v96, v96, v116
    v_add_f32 v97, v97, v117
    v_add_f32 v98, v98, v118
    v_add_f32 v99, v99, v119
    v_add_f32 v100, v100, v120
    v_add_f32 v101, v101, v121
    v_add_f32 v102, v102, v122
    v_add_f32 v103, v103, v123
    v_add_f32 v104, v104, v124
    v_add_f32 v105, v105, v125
    v_add_f32 v106, v106, v126
    v_add_f32 v107, v107, v127
    s_cmp_eq_u32 s23, 0
    s_cselect_b64 vcc, -1, 0
    v_cndmask_b32 v104, 0, v104, vcc
    v_cndmask_b32 v105, 0, v105, vcc
    v_cndmask_b32 v106, 0, v106, vcc
    v_cndmask_b32 v107, 0, v107, vcc
    v_add_f32 v116, v96, v97
    v_mul_f32 v117, v96, v96
    v_fmac_f32 v117, v97, v97
    v_add_f32 v116, v116, v98
    v_fmac_f32 v117, v98, v98
    v_add_f32 v116, v116, v99
    v_fmac_f32 v117, v99, v99
    v_add_f32 v116, v116, v100
    v_fmac_f32 v117, v100, v100
    v_add_f32 v116, v116, v101
    v_fmac_f32 v117, v101, v101
    v_add_f32 v116, v116, v102
    v_fmac_f32 v117, v102, v102
    v_add_f32 v116, v116, v103
    v_fmac_f32 v117, v103, v103
    v_add_f32 v116, v116, v104
    v_fmac_f32 v117, v104, v104
    v_add_f32 v116, v116, v105
    v_fmac_f32 v117, v105, v105
    v_add_f32 v116, v116, v106
    v_fmac_f32 v117, v106, v106
    v_add_f32 v116, v116, v107
    v_fmac_f32 v117, v107, v107
    v_cvt_pk_bf16_f32 v120, v96, v97
    v_cvt_pk_bf16_f32 v121, v98, v99
    v_cvt_pk_bf16_f32 v122, v100, v101
    v_cvt_pk_bf16_f32 v123, v102, v103
    v_cvt_pk_bf16_f32 v124, v104, v105
    v_cvt_pk_bf16_f32 v125, v106, v107
    v_mov_b32 v118, v116
    v_mov_b32 v119, v116
    s_nop 1
    v_permlane16_swap_b32 v118, v119
    v_add_f32 v116, v118, v119
    v_mov_b32 v118, v116
    v_mov_b32 v119, v116
    s_nop 1
    v_permlane32_swap_b32 v118, v119
    v_add_f32 v116, v118, v119
    v_mov_b32 v118, v117
    v_mov_b32 v119, v117
    s_nop 1
    v_permlane16_swap_b32 v118, v119
    v_add_f32 v117, v118, v119
    v_mov_b32 v118, v117
    v_mov_b32 v119, v117
    s_nop 1
    v_permlane32_swap_b32 v118, v119
    v_add_f32 v117, v118, v119
    s_cmp_eq_u32 s66, 1
    s_cbranch_scc0 .Lst24
    buffer_store_dwordx2 v[120:121], v148, s[8:11], s34 offen
    buffer_store_dwordx2 v[122:123], v148, s[8:11], s34 offen offset:512
    buffer_store_dwordx2 v[124:125], v148, s[8:11], s35 offen offset:1024
    s_mov_b64 exec, 0xffff
    buffer_store_dwordx2 v[116:117], v144, s[8:11], s33 offen
    s_mov_b64 exec, -1
    s_branch .Lst25
.Lst24:
    buffer_store_dwordx2 v[120:121], v148, s[8:11], s34 offen sc1
    buffer_store_dwordx2 v[122:123], v148, s[8:11], s34 offen offset:512 sc1
    buffer_store_dwordx2 v[124:125], v148, s[8:11], s35 offen offset:1024 sc1
    s_mov_b64 exec, 0xffff
    buffer_store_dwordx2 v[116:117], v144, s[8:11], s33 offen sc1
    s_mov_b64 exec, -1
.Lst25:
    s_cmp_ge_u32 s65, 28
    s_cbranch_scc1 kf_kernel_idle
    s_mov_b32 s52, s68
    s_and_b32 s53, s69, 0xffff
    s_mov_b32 s54, 3456
    s_mov_b32 s55, 0x20000
    s_lshr_b32 s21, s65, 2
    s_lshr_b32 s22, s12, 2
    s_mul_i32 s22, s22, 27
    s_and_b32 s23, s12, 3
    s_add_u32 s22, s22, s23
    s_lshl_b32 s22, s22, 10
    s_mul_i32 s47, s21, 276480
    s_add_u32 s47, s47, 8110080
    s_add_u32 s47, s47, s22
    s_mul_i32 s48, s12, 5120
    s_and_b32 s13, s65, 1
    s_lshl_b32 s15, s64, 1
    s_add_u32 s13, s13, s15
    s_lshr_b32 s14, s65, 1
    s_and_b32 s23, s12, 3
    s_lshr_b32 s26, s12, 2
    v_lshrrev_b32 v7, 4, v3
    s_movk_i32 s17, 20480
    v_mul_lo_u32 v7, v7, s17
    v_and_b32 v6, 15, v3
    v_lshl_add_u32 v7, v6, 4, v7
    v_lshl_add_u32 v7, v4, 8, v7
    s_lshl_b32 s20, s13, 3
    s_lshl_b32 s19, s23, 1
    s_add_u32 s20, s20, s19
    s_mul_i32 s20, s20, 20480
    s_lshl_b32 s19, s26, 10
    s_add_u32 s20, s20, s19
    s_add_u32 s20, s20, 20807680
    s_lshl_b32 s22, s23, 10
    s_lshl_b32 s19, s26, 13
    s_add_u32 s22, s22, s19
    s_lshl_b32 s17, s26, 11
    v_add_u32 v12, s17, v10
    v_add_u32 v13, 0x10000, v12
    s_waitcnt vmcnt(0)
    s_barrier
    s_cmp_lg_u32 s12, 0
    s_cbranch_scc1 .Lsy26
    s_lshl_b32 s40, s64, 7
    s_lshl_b32 s41, s65, 2
    s_add_u32 s40, s40, s41
    s_add_u32 s40, s40, 30819328
    v_mov_b32 v14, 0
    v_mov_b32 v15, 1
    s_mov_b64 exec, 1
    s_cmp_eq_u32 s66, 1
    s_cbranch_scc0 .Lst31
    buffer_store_dword v15, v14, s[8:11], s40 offen
    s_branch .Lst32
.Lst31:
    buffer_store_dword v15, v14, s[8:11], s40 offen sc1
.Lst32:
    s_mov_b64 exec, -1
    s_and_b32 s40, s65, 1
    s_cmp_eq_u32 s40, 0
    s_mov_b32 s44, 0xcccccccc
    s_cselect_b32 s44, 0x33333333, s44
    s_mov_b32 s45, 0
    s_lshl_b32 s40, s64, 7
    s_add_u32 s40, s40, 30819328
    v_lshlrev_b32 v14, 2, v2
    s_mov_b64 exec, s[44:45]
    s_mov_b32 s41, 0
.Lsy28:
    buffer_load_dword v15, v14, s[8:11], s40 offen sc1
    s_add_u32 s41, s41, 1
    s_waitcnt vmcnt(0)
    v_cmp_eq_u32 vcc, 0, v15
    s_cbranch_vccz .Lsy29
    s_cmp_lt_u32 s41, 40000
    s_cbranch_scc1 .Lsy28
.Lsy29:
    s_mov_b64 exec, -1
    s_cmp_eq_u32 s66, 1
    s_cbranch_scc1 .Lsy30
    buffer_inv sc1
    s_waitcnt vmcnt(0)
.Lsy30:
    s_barrier
    s_branch .Lsy27
.Lsy26:
    s_barrier
.Lsy27:
    s_add_u32 m0, s22, 0
    s_add_u32 s21, s20, 0
    buffer_load_dwordx4 v7, s[8:11], s21 offen sc1 lds
    s_add_u32 m0, s22, 4096
    s_add_u32 s21, s20, 512
    buffer_load_dwordx4 v7, s[8:11], s21 offen sc1 lds
    s_add_u32 m0, s22, 16384
    s_add_u32 s21, s20, 2048
    buffer_load_dwordx4 v7, s[8:11], s21 offen sc1 lds
    s_add_u32 m0, s22, 20480
    s_add_u32 s21, s20, 2560
    buffer_load_dwordx4 v7, s[8:11], s21 offen sc1 lds
    s_add_u32 m0, s22, 32768
    s_add_u32 s21, s20, 4096
    buffer_load_dwordx4 v7, s[8:11], s21 offen sc1 lds
    s_add_u32 m0, s22, 36864
    s_add_u32 s21, s20, 4608
    buffer_load_dwordx4 v7, s[8:11], s21 offen sc1 lds
    s_lshl_b32 s27, s13, 7
    s_lshl_b32 s28, s26, 6
    s_add_u32 s27, s27, s28
    s_lshl_b32 s28, s13, 7
    s_lshl_b32 s29, s23, 5
    s_add_u32 s28, s28, s29
    s_lshl_b32 s28, s28, 3
    s_add_u32 s28, s28, 30556160
    v_lshlrev_b32 v14, 3, v3
    v_lshl_add_u32 v14, v4, 17, v14
    s_waitcnt vmcnt(4)
    s_barrier
    ds_read_b128 v[104:107], v12 offset:0
    ds_read_b128 v[108:111], v12 offset:1024
    ds_read_b128 v[112:115], v12 offset:4096
    ds_read_b128 v[116:119], v12 offset:5120
    ds_read_b128 v[120:123], v12 offset:8192
    ds_read_b128 v[124:127], v12 offset:9216
    s_waitcnt lgkmcnt(4)
    v_mfma_f32_32x32x16_bf16 v[72:87], v[152:155], v[104:107], 0
    v_mfma_f32_32x32x16_bf16 v[88:103], v[152:155], v[108:111], 0
    s_add_u32 m0, s22, 49152
    s_add_u32 s21, s20, 6144
    buffer_load_dwordx4 v7, s[8:11], s21 offen sc1 lds
    s_add_u32 s40, s98, 13312
    buffer_load_dwordx4 v[16:19], v1, s[8:11], s40 offen
    ds_read_b128 v[104:107], v12 offset:12288
    ds_read_b128 v[108:111], v12 offset:13312
    s_waitcnt lgkmcnt(4)
    v_mfma_f32_32x32x16_bf16 v[72:87], v[156:159], v[112:115], v[72:87]
    v_mfma_f32_32x32x16_bf16 v[88:103], v[156:159], v[116:119], v[88:103]
    s_add_u32 m0, s22, 53248
    s_add_u32 s21, s20, 6656
    buffer_load_dwordx4 v7, s[8:11], s21 offen sc1 lds
    s_waitcnt lgkmcnt(0)
    v_mfma_f32_32x32x16_bf16 v[72:87], v[160:163], v[120:123], v[72:87]
    v_mfma_f32_32x32x16_bf16 v[88:103], v[160:163], v[124:127], v[88:103]
    s_waitcnt vmcnt(5)
    s_barrier
    ds_read_b128 v[112:115], v12 offset:16384
    ds_read_b128 v[116:119], v12 offset:17408
    s_add_u32 m0, s22, 65536
    s_add_u32 s21, s20, 8192
    buffer_load_dwordx4 v7, s[8:11], s21 offen sc1 lds
    s_add_u32 s40, s98, 13824
    buffer_load_dwordx4 v[20:23], v1, s[8:11], s40 offen
    ds_read_b128 v[120:123], v12 offset:20480
    ds_read_b128 v[124:127], v12 offset:21504
    s_waitcnt lgkmcnt(4)
    v_mfma_f32_32x32x16_bf16 v[72:87], v[164:167], v[104:107], v[72:87]
    v_mfma_f32_32x32x16_bf16 v[88:103], v[164:167], v[108:111], v[88:103]
    s_add_u32 m0, s22, 69632
    s_add_u32 s21, s20, 8704
    buffer_load_dwordx4 v7, s[8:11], s21 offen sc1 lds
    ds_read_b128 v[104:107], v12 offset:24576
    ds_read_b128 v[108:111], v12 offset:25600
    s_waitcnt lgkmcnt(4)
    v_mfma_f32_32x32x16_bf16 v[72:87], v[168:171], v[112:115], v[72:87]
    v_mfma_f32_32x32x16_bf16 v[88:103], v[168:171], v[116:119], v[88:103]
    s_add_u32 s40, s98, 14336
    buffer_load_dwordx4 v[24:27], v1, s[8:11], s40 offen
    ds_read_b128 v[112:115], v12 offset:28672
    ds_read_b128 v[116:119], v12 offset:29696
    s_waitcnt lgkmcnt(4)
    v_mfma_f32_32x32x16_bf16 v[72:87], v[172:175], v[120:123], v[72:87]
    v_mfma_f32_32x32x16_bf16 v[88:103], v[172:175], v[124:127], v[88:103]
    s_add_u32 m0, s22, 0
    s_add_u32 s21, s20, 10240
    buffer_load_dwordx4 v7, s[8:11], s21 offen sc1 lds
    s_waitcnt lgkmcnt(0)
    v_mfma_f32_32x32x16_bf16 v[72:87], v[176:179], v[104:107], v[72:87]
    v_mfma_f32_32x32x16_bf16 v[88:103], v[176:179], v[108:111], v[88:103]
    s_waitcnt vmcnt(8)
    s_barrier
    ds_read_b128 v[120:123], v12 offset:32768
    ds_read_b128 v[124:127], v12 offset:33792
    s_add_u32 s40, s98, 14848
    buffer_load_dwordx4 v[28:31], v1, s[8:11], s40 offen
    ds_read_b128 v[104:107], v12 offset:36864
    ds_read_b128 v[108:111], v12 offset:37888
    s_waitcnt lgkmcnt(4)
    v_mfma_f32_32x32x16_bf16 v[72:87], v[180:183], v[112:115], v[72:87]
    v_mfma_f32_32x32x16_bf16 v[88:103], v[180:183], v[116:119], v[88:103]
    s_add_u32 m0, s22, 4096
    s_add_u32 s21, s20, 10752
    buffer_load_dwordx4 v7, s[8:11], s21 offen sc1 lds
    ds_read_b128 v[112:115], v12 offset:40960
    ds_read_b128 v[116:119], v12 offset:41984
    s_waitcnt lgkmcnt(4)
    v_mfma_f32_32x32x16_bf16 v[72:87], v[184:187], v[120:123], v[72:87]
    v_mfma_f32_32x32x16_bf16 v[88:103], v[184:187], v[124:127], v[88:103]
    s_add_u32 s40, s98, 15360
    buffer_load_dwordx4 v[32:35], v1, s[8:11], s40 offen
    ds_read_b128 v[120:123], v12 offset:45056
    ds_read_b128 v[124:127], v12 offset:46080
    s_waitcnt lgkmcnt(4)
    v_mfma_f32_32x32x16_bf16 v[72:87], v[188:191], v[104:107], v[72:87]
    v_mfma_f32_32x32x16_bf16 v[88:103], v[188:191], v[108:111], v[88:103]
    s_add_u32 m0, s22, 16384
    s_add_u32 s21, s20, 12288
    buffer_load_dwordx4 v7, s[8:11], s21 offen sc1 lds
    s_waitcnt lgkmcnt(0)
    v_mfma_f32_32x32x16_bf16 v[72:87], v[192:195], v[112:115], v[72:87]
    v_mfma_f32_32x32x16_bf16 v[88:103], v[192:195], v[116:119], v[88:103]
    s_waitcnt vmcnt(9)
    s_barrier
    ds_read_b128 v[104:107], v12 offset:49152
    ds_read_b128 v[108:111], v12 offset:50176
    s_add_u32 s40, s98, 15872
    buffer_load_dwordx4 v[36:39], v1, s[8:11], s40 offen
    ds_read_b128 v[112:115], v12 offset:53248
    ds_read_b128 v[116:119], v12 offset:54272
    s_waitcnt lgkmcnt(4)
    v_mfma_f32_32x32x16_bf16 v[72:87], v[196:199], v[120:123], v[72:87]
    v_mfma_f32_32x32x16_bf16 v[88:103], v[196:199], v[124:127], v[88:103]
    s_add_u32 m0, s22, 20480
    s_add_u32 s21, s20, 12800
    buffer_load_dwordx4 v7, s[8:11], s21 offen sc1 lds
    ds_read_b128 v[120:123], v12 offset:57344
    ds_read_b128 v[124:127], v12 offset:58368
    s_waitcnt lgkmcnt(4)
    v_mfma_f32_32x32x16_bf16 v[72:87], v[200:203], v[104:107], v[72:87]
    v_mfma_f32_32x32x16_bf16 v[88:103], v[200:203], v[108:111], v[88:103]
    s_add_u32 s40, s98, 16384
    buffer_load_dwordx4 v[40:43], v1, s[8:11], s40 offen
    ds_read_b128 v[104:107], v12 offset:61440
    ds_read_b128 v[108:111], v12 offset:62464
    s_waitcnt lgkmcnt(4)
    v_mfma_f32_32x32x16_bf16 v[72:87], v[204:207], v[112:115], v[72:87]
    v_mfma_f32_32x32x16_bf16 v[88:103], v[204:207], v[116:119], v[88:103]
    s_add_u32 m0, s22, 32768
    s_add_u32 s21, s20, 14336
    buffer_load_dwordx4 v7, s[8:11], s21 offen sc1 lds
    s_waitcnt lgkmcnt(0)
    v_mfma_f32_32x32x16_bf16 v[72:87], v[208:211], v[120:123], v[72:87]
    v_mfma_f32_32x32x16_bf16 v[88:103], v[208:211], v[124:127], v[88:103]
    s_waitcnt vmcnt(10)
    s_barrier
    ds_read_b128 v[112:115], v13 offset:0
    ds_read_b128 v[116:119], v13 offset:1024
    s_add_u32 s40, s98, 16896
    buffer_load_dwordx4 v[44:47], v1, s[8:11], s40 offen
    ds_read_b128 v[120:123], v13 offset:4096
    ds_read_b128 v[124:127], v13 offset:5120
    s_waitcnt lgkmcnt(4)
    v_mfma_f32_32x32x16_bf16 v[72:87], v[212:215], v[104:107], v[72:87]
    v_mfma_f32_32x32x16_bf16 v[88:103], v[212:215], v[108:111], v[88:103]
    s_add_u32 m0, s22, 36864
    s_add_u32 s21, s20, 14848
    buffer_load_dwordx4 v7, s[8:11], s21 offen sc1 lds
    ds_read_b128 v[104:107], v13 offset:8192
    ds_read_b128 v[108:111], v13 offset:9216
    s_waitcnt lgkmcnt(4)
    v_mfma_f32_32x32x16_bf16 v[72:87], v[216:219], v[112:115], v[72:87]
    v_mfma_f32_32x32x16_bf16 v[88:103], v[216:219], v[116:119], v[88:103]
    s_add_u32 s40, s98, 17408
    buffer_load_dwordx4 v[48:51], v1, s[8:11], s40 offen
    ds_read_b128 v[112:115], v13 offset:12288
    ds_read_b128 v[116:119], v13 offset:13312
    s_waitcnt lgkmcnt(4)
    v_mfma_f32_32x32x16_bf16 v[72:87], v[220:223], v[120:123], v[72:87]
    v_mfma_f32_32x32x16_bf16 v[88:103], v[220:223], v[124:127], v[88:103]
    s_add_u32 m0, s22, 49152
    s_add_u32 s21, s20, 16384
    buffer_load_dwordx4 v7, s[8:11], s21 offen sc1 lds
    s_waitcnt lgkmcnt(0)
    v_mfma_f32_32x32x16_bf16 v[72:87], v[224:227], v[104:107], v[72:87]
    v_mfma_f32_32x32x16_bf16 v[88:103], v[224:227], v[108:111], v[88:103]
    s_waitcnt vmcnt(10)
    s_barrier
    ds_read_b128 v[120:123], v12 offset:0
    ds_read_b128 v[124:127], v12 offset:1024
    s_add_u32 s40, s98, 17920
    buffer_load_dwordx4 v[52:55], v1, s[8:11], s40 offen
    ds_read_b128 v[104:107], v12 offset:4096
    ds_read_b128 v[108:111], v12 offset:5120
    s_waitcnt lgkmcnt(4)
    v_mfma_f32_32x32x16_bf16 v[72:87], v[228:231], v[112:115], v[72:87]
    v_mfma_f32_32x32x16_bf16 v[88:103], v[228:231], v[116:119], v[88:103]
    s_add_u32 m0, s22, 53248
    s_add_u32 s21, s20, 16896
    buffer_load_dwordx4 v7, s[8:11], s21 offen sc1 lds
    ds_read_b128 v[112:115], v12 offset:8192
    ds_read_b128 v[116:119], v12 offset:9216
    s_waitcnt lgkmcnt(4)
    v_mfma_f32_32x32x16_bf16 v[72:87], v[232:235], v[120:123], v[72:87]
    v_mfma_f32_32x32x16_bf16 v[88:103], v[232:235], v[124:127], v[88:103]
    s_add_u32 s40, s98, 18432
    buffer_load_dwordx4 v[56:59], v1, s[8:11], s40 offen
    s_add_u32 s29, s28, 0
    buffer_load_dwordx2 v[128:129], v14, s[8:11], s29 offen sc1
    s_add_u32 s29, s28, 16384
    buffer_load_dwordx2 v[130:131], v14, s[8:11], s29 offen sc1
    ds_read_b128 v[120:123], v12 offset:12288
    ds_read_b128 v[124:127], v12 offset:13312
    s_waitcnt lgkmcnt(4)
    v_mfma_f32_32x32x16_bf16 v[72:87], v[236:239], v[104:107], v[72:87]
    v_mfma_f32_32x32x16_bf16 v[88:103], v[236:239], v[108:111], v[88:103]
    s_add_u32 m0, s22, 65536
    s_add_u32 s21, s20, 18432
    buffer_load_dwordx4 v7, s[8:11], s21 offen sc1 lds
    s_add_u32 s29, s28, 32768
    buffer_load_dwordx2 v[132:133], v14, s[8:11], s29 offen sc1
    s_add_u32 s29, s28, 49152
    buffer_load_dwordx2 v[134:135], v14, s[8:11], s29 offen sc1
    s_waitcnt lgkmcnt(0)
    v_mfma_f32_32x32x16_bf16 v[72:87], v[240:243], v[112:115], v[72:87]
    v_mfma_f32_32x32x16_bf16 v[88:103], v[240:243], v[116:119], v[88:103]
    s_waitcnt vmcnt(14)
    s_barrier
    ds_read_b128 v[104:107], v12 offset:16384
    ds_read_b128 v[108:111], v12 offset:17408
    s_add_u32 s40, s98, 18944
    buffer_load_dwordx4 v[60:63], v1, s[8:11], s40 offen
    s_add_u32 s29, s28, 65536
    buffer_load_dwordx2 v[136:137], v14, s[8:11], s29 offen sc1
    s_add_u32 s29, s28, 81920
    buffer_load_dwordx2 v[138:139], v14, s[8:11], s29 offen sc1
    ds_read_b128 v[112:115], v12 offset:20480
    ds_read_b128 v[116:119], v12 offset:21504
    s_waitcnt lgkmcnt(4)
    v_mfma_f32_32x32x16_bf16 v[72:87], v[244:247], v[120:123], v[72:87]
    v_mfma_f32_32x32x16_bf16 v[88:103], v[244:247], v[124:127], v[88:103]
    s_add_u32 m0, s22, 69632
    s_add_u32 s21, s20, 18944
    buffer_load_dwordx4 v7, s[8:11], s21 offen sc1 lds
    s_add_u32 s29, s28, 98304
    buffer_load_dwordx2 v[140:141], v14, s[8:11], s29 offen sc1
    s_add_u32 s29, s28, 114688
    buffer_load_dwordx2 v[142:143], v14, s[8:11], s29 offen sc1
    ds_read_b128 v[120:123], v12 offset:24576
    ds_read_b128 v[124:127], v12 offset:25600
    s_waitcnt lgkmcnt(4)
    v_mfma_f32_32x32x16_bf16 v[72:87], v[248:251], v[104:107], v[72:87]
    v_mfma_f32_32x32x16_bf16 v[88:103], v[248:251], v[108:111], v[88:103]
    s_add_u32 s40, s98, 19456
    buffer_load_dwordx4 v[64:67], v1, s[8:11], s40 offen
    ds_read_b128 v[104:107], v12 offset:28672
    ds_read_b128 v[108:111], v12 offset:29696
    s_waitcnt lgkmcnt(4)
    v_mfma_f32_32x32x16_bf16 v[72:87], v[252:255], v[112:115], v[72:87]
    v_mfma_f32_32x32x16_bf16 v[88:103], v[252:255], v[116:119], v[88:103]
    s_lshl_b32 s29, s14, 7
    s_lshl_b32 s30, s23, 5
    s_add_u32 s29, s29, s30
    s_lshl_b32 s29, s29, 2
    s_add_u32 s29, s29, 30507008
    v_lshlrev_b32 v15, 2, v3
    buffer_load_dword v144, v15, s[8:11], s29 offen
    s_add_u32 s29, s29, 6912
    buffer_load_dword v145, v15, s[8:11], s29 offen
    s_add_u32 s29, s29, 6912
    buffer_load_dword v146, v15, s[8:11], s29 offen
    s_add_u32 s29, s29, 6912
    buffer_load_dword v147, v15, s[8:11], s29 offen
    s_waitcnt vmcnt(37) lgkmcnt(0)
    v_mfma_f32_32x32x16_bf16 v[72:87], v[16:19], v[120:123], v[72:87]
    v_mfma_f32_32x32x16_bf16 v[88:103], v[16:19], v[124:127], v[88:103]
    s_waitcnt vmcnt(21)
    s_barrier
    ds_read_b128 v[112:115], v12 offset:32768
    ds_read_b128 v[116:119], v12 offset:33792
    s_add_u32 s40, s98, 19968
    buffer_load_dwordx4 v[68:71], v1, s[8:11], s40 offen
    ds_read_b128 v[120:123], v12 offset:36864
    ds_read_b128 v[124:127], v12 offset:37888
    s_waitcnt vmcnt(35) lgkmcnt(4)
    v_mfma_f32_32x32x16_bf16 v[72:87], v[20:23], v[104:107], v[72:87]
    v_mfma_f32_32x32x16_bf16 v[88:103], v[20:23], v[108:111], v[88:103]
    ds_read_b128 v[104:107], v12 offset:40960
    ds_read_b128 v[108:111], v12 offset:41984
    s_waitcnt vmcnt(33) lgkmcnt(4)
    v_mfma_f32_32x32x16_bf16 v[72:87], v[24:27], v[112:115], v[72:87]
    v_mfma_f32_32x32x16_bf16 v[88:103], v[24:27], v[116:119], v[88:103]
    ds_read_b128 v[112:115], v12 offset:45056
    ds_read_b128 v[116:119], v12 offset:46080
    s_waitcnt vmcnt(31) lgkmcnt(4)
    v_mfma_f32_32x32x16_bf16 v[72:87], v[28:31], v[120:123], v[72:87]
    v_mfma_f32_32x32x16_bf16 v[88:103], v[28:31], v[124:127], v[88:103]
    s_waitcnt vmcnt(29) lgkmcnt(0)
    v_mfma_f32_32x32x16_bf16 v[72:87], v[32:35], v[104:107], v[72:87]
    v_mfma_f32_32x32x16_bf16 v[88:103], v[32:35], v[108:111], v[88:103]
    s_waitcnt vmcnt(18)
    s_barrier
    ds_read_b128 v[120:123], v12 offset:49152
    ds_read_b128 v[124:127], v12 offset:50176
    ds_read_b128 v[104:107], v12 offset:53248
    ds_read_b128 v[108:111], v12 offset:54272
    s_waitcnt vmcnt(27) lgkmcnt(4)
    v_mfma_f32_32x32x16_bf16 v[72:87], v[36:39], v[112:115], v[72:87]
    v_mfma_f32_32x32x16_bf16 v[88:103], v[36:39], v[116:119], v[88:103]
    ds_read_b128 v[112:115], v12 offset:57344
    ds_read_b128 v[116:119], v12 offset:58368
    s_waitcnt vmcnt(25) lgkmcnt(4)
    v_mfma_f32_32x32x16_bf16 v[72:87], v[40:43], v[120:123], v[72:87]
    v_mfma_f32_32x32x16_bf16 v[88:103], v[40:43], v[124:127], v[88:103]
    s_lshl_b32 s29, s14, 7
    s_lshl_b32 s30, s23, 5
    s_add_u32 s29, s29, s30
    s_lshl_b32 s29, s29, 1
    v_lshlrev_b32 v15, 4, v4
    buffer_load_dwordx4 v[184:187], v15, s[52:55], s29 offen
    buffer_load_dwordx4 v[188:191], v15, s[52:55], s29 offen offset:32
    ds_read_b128 v[120:123], v12 offset:61440
    ds_read_b128 v[124:127], v12 offset:62464
    s_waitcnt vmcnt(25) lgkmcnt(4)
    v_mfma_f32_32x32x16_bf16 v[72:87], v[44:47], v[104:107], v[72:87]
    v_mfma_f32_32x32x16_bf16 v[88:103], v[44:47], v[108:111], v[88:103]
    s_add_u32 m0, s48, 81920
    s_add_u32 s49, s47, 0
    buffer_load_dwordx4 v10, s[8:11], s49 offen lds
    s_waitcnt vmcnt(4)
    v_add_f32 v144, v144, v145
    v_add_f32 v146, v146, v147
    v_add_f32 v144, v144, v146
    s_lshl_b32 s28, s23, 7
    v_lshlrev_b32 v14, 2, v3
    v_add_u32 v14, s28, v14
    ds_write_b32 v14, v144 offset:1024
    s_cmp_ge_u32 s12, 4
    s_cbranch_scc1 .Lst33
    v_add_f32 v128, v128, v130
    v_add_f32 v129, v129, v131
    v_add_f32 v128, v128, v132
    v_add_f32 v129, v129, v133
    v_add_f32 v128, v128, v134
    v_add_f32 v129, v129, v135
    v_add_f32 v128, v128, v136
    v_add_f32 v129, v129, v137
    v_add_f32 v128, v128, v138
    v_add_f32 v129, v129, v139
    v_add_f32 v128, v128, v140
    v_add_f32 v129, v129, v141
    v_add_f32 v128, v128, v142
    v_add_f32 v129, v129, v143
    v_mov_b32 v130, v128
    v_mov_b32 v131, v128
    s_nop 1
    v_permlane32_swap_b32 v130, v131
    v_add_f32 v128, v130, v131
    v_mov_b32 v130, v129
    v_mov_b32 v131, v129
    s_nop 1
    v_permlane32_swap_b32 v130, v131
    v_add_f32 v129, v130, v131
    v_mul_f32 v128, 0x3acccccd, v128
    v_mul_f32 v129, 0x3acccccd, v129
    v_fma_f32 v129, -v128, v128, v129
    v_max_f32 v129, 0, v129
    v_add_f32 v129, 0x3727c5ac, v129
    v_rsq_f32 v129, v129
    s_nop 0
    v_mul_f32 v128, v128, v129
    s_lshl_b32 s28, s12, 8
    v_lshlrev_b32 v14, 3, v3
    v_add_u32 v14, s28, v14
    ds_write_b64 v14, v[128:129] offset:0
.Lst33:
    s_waitcnt vmcnt(24) lgkmcnt(0)
    v_mfma_f32_32x32x16_bf16 v[72:87], v[48:51], v[112:115], v[72:87]
    v_mfma_f32_32x32x16_bf16 v[88:103], v[48:51], v[116:119], v[88:103]
    s_waitcnt vmcnt(11)
    s_barrier
    ds_read_b128 v[104:107], v13 offset:0
    ds_read_b128 v[108:111], v13 offset:1024
    s_add_u32 m0, s48, 82944
    s_add_u32 s49, s47, 55296
    buffer_load_dwordx4 v10, s[8:11], s49 offen lds
    s_add_u32 m0, s48, 83968
    s_add_u32 s49, s47, 110592
    buffer_load_dwordx4 v10, s[8:11], s49 offen lds
    ds_read_b128 v[112:115], v13 offset:4096
    ds_read_b128 v[116:119], v13 offset:5120
    s_waitcnt vmcnt(24) lgkmcnt(4)
    v_mfma_f32_32x32x16_bf16 v[72:87], v[52:55], v[120:123], v[72:87]
    v_mfma_f32_32x32x16_bf16 v[88:103], v[52:55], v[124:127], v[88:103]
    s_add_u32 m0, s48, 84992
    s_add_u32 s49, s47, 165888
    buffer_load_dwordx4 v10, s[8:11], s49 offen lds
    s_add_u32 m0, s48, 86016
    s_add_u32 s49, s47, 221184
    buffer_load_dwordx4 v10, s[8:11], s49 offen lds
    s_lshl_b32 s28, s26, 9
    v_lshlrev_b32 v14, 3, v3
    v_add_u32 v14, s28, v14
    ds_read_b64 v[128:129], v14 offset:0
    ds_read_b64 v[132:133], v14 offset:256
    s_lshl_b32 s28, s23, 7
    v_lshlrev_b32 v14, 5, v4
    v_add_u32 v14, s28, v14
    ds_read_b128 v[192:195], v14 offset:1024
    ds_read_b128 v[196:199], v14 offset:1040
    ds_read_b128 v[200:203], v14 offset:1088
    ds_read_b128 v[204:207], v14 offset:1104
    ds_read_b128 v[120:123], v13 offset:8192
    ds_read_b128 v[124:127], v13 offset:9216
    s_waitcnt vmcnt(24) lgkmcnt(2)
    v_mfma_f32_32x32x16_bf16 v[72:87], v[56:59], v[104:107], v[72:87]
    v_mfma_f32_32x32x16_bf16 v[88:103], v[56:59], v[108:111], v[88:103]
    s_add_u32 m0, s48, 122880
    s_add_u32 s49, s47, 4096
    buffer_load_dwordx4 v10, s[8:11], s49 offen lds
    s_add_u32 m0, s48, 123904
    s_add_u32 s49, s47, 59392
    buffer_load_dwordx4 v10, s[8:11], s49 offen lds
    ds_read_b128 v[104:107], v13 offset:12288
    ds_read_b128 v[108:111], v13 offset:13312
    s_waitcnt vmcnt(20) lgkmcnt(4)
    v_mfma_f32_32x32x16_bf16 v[72:87], v[60:63], v[112:115], v[72:87]
    v_mfma_f32_32x32x16_bf16 v[88:103], v[60:63], v[116:119], v[88:103]
    s_add_u32 m0, s48, 124928
    s_add_u32 s49, s47, 114688
    buffer_load_dwordx4 v10, s[8:11], s49 offen lds
    s_add_u32 m0, s48, 125952
    s_add_u32 s49, s47, 169984
    buffer_load_dwordx4 v10, s[8:11], s49 offen lds
    s_waitcnt vmcnt(16) lgkmcnt(2)
    v_mfma_f32_32x32x16_bf16 v[72:87], v[64:67], v[120:123], v[72:87]
    v_mfma_f32_32x32x16_bf16 v[88:103], v[64:67], v[124:127], v[88:103]
    s_add_u32 m0, s48, 126976
    s_add_u32 s49, s47, 225280
    buffer_load_dwordx4 v10, s[8:11], s49 offen lds
    s_waitcnt vmcnt(12) lgkmcnt(0)
    v_mfma_f32_32x32x16_bf16 v[72:87], v[68:71], v[104:107], v[72:87]
    v_mfma_f32_32x32x16_bf16 v[88:103], v[68:71], v[108:111], v[88:103]
    s_waitcnt vmcnt(10)
    v_lshlrev_b32 v168, 16, v184
    v_and_b32 v169, 0xffff0000, v184
    v_lshlrev_b32 v170, 16, v185
    v_and_b32 v171, 0xffff0000, v185
    v_lshlrev_b32 v172, 16, v186
    v_and_b32 v173, 0xffff0000, v186
    v_lshlrev_b32 v174, 16, v187
    v_and_b32 v175, 0xffff0000, v187
    v_lshlrev_b32 v176, 16, v188
    v_and_b32 v177, 0xffff0000, v188
    v_lshlrev_b32 v178, 16, v189
    v_and_b32 v179, 0xffff0000, v189
    v_lshlrev_b32 v180, 16, v190
    v_and_b32 v181, 0xffff0000, v190
    v_lshlrev_b32 v182, 16, v191
    v_and_b32 v183, 0xffff0000, v191
    v_fma_f32 v130, -v128, v192, v168
    v_fma_f32 v72, v129, v72, v130
    v_max_f32 v72, 0, v72
    v_mul_f32 v72, v72, v72
    v_fma_f32 v130, -v128, v193, v169
    v_fma_f32 v73, v129, v73, v130
    v_max_f32 v73, 0, v73
    v_mul_f32 v73, v73, v73
    v_fma_f32 v130, -v128, v194, v170
    v_fma_f32 v74, v129, v74, v130
    v_max_f32 v74, 0, v74
    v_mul_f32 v74, v74, v74
    v_fma_f32 v130, -v128, v195, v171
    v_fma_f32 v75, v129, v75, v130
    v_max_f32 v75, 0, v75
    v_mul_f32 v75, v75, v75
    v_fma_f32 v130, -v128, v196, v172
    v_fma_f32 v76, v129, v76, v130
    v_max_f32 v76, 0, v76
    v_mul_f32 v76, v76, v76
    v_fma_f32 v130, -v128, v197, v173
    v_fma_f32 v77, v129, v77, v130
    v_max_f32 v77, 0, v77
    v_mul_f32 v77, v77, v77
    v_fma_f32 v130, -v128, v198, v174
    v_fma_f32 v78, v129, v78, v130
    v_max_f32 v78, 0, v78
    v_mul_f32 v78, v78, v78
    v_fma_f32 v130, -v128, v199, v175
    v_fma_f32 v79, v129, v79, v130
    v_max_f32 v79, 0, v79
    v_mul_f32 v79, v79, v79
    v_fma_f32 v130, -v128, v200, v176
    v_fma_f32 v80, v129, v80, v130
    v_max_f32 v80, 0, v80
    v_mul_f32 v80, v80, v80
    v_fma_f32 v130, -v128, v201, v177
    v_fma_f32 v81, v129, v81, v130
    v_max_f32 v81, 0, v81
    v_mul_f32 v81, v81, v81
    v_fma_f32 v130, -v128, v202, v178
    v_fma_f32 v82, v129, v82, v130
    v_max_f32 v82, 0, v82
    v_mul_f32 v82, v82, v82
    v_fma_f32 v130, -v128, v203, v179
    v_fma_f32 v83, v129, v83, v130
    v_max_f32 v83, 0, v83
    v_mul_f32 v83, v83, v83
    v_fma_f32 v130, -v128, v204, v180
    v_fma_f32 v84, v129, v84, v130
    v_max_f32 v84, 0, v84
    v_mul_f32 v84, v84, v84
    v_fma_f32 v130, -v128, v205, v181
    v_fma_f32 v85, v129, v85, v130
    v_max_f32 v85, 0, v85
    v_mul_f32 v85, v85, v85
    v_fma_f32 v130, -v128, v206, v182
    v_fma_f32 v86, v129, v86, v130
    v_max_f32 v86, 0, v86
    v_mul_f32 v86, v86, v86
    v_fma_f32 v130, -v128, v207, v183
    v_fma_f32 v87, v129, v87, v130
    v_max_f32 v87, 0, v87
    v_mul_f32 v87, v87, v87
    v_fma_f32 v134, -v132, v192, v168
    v_fma_f32 v88, v133, v88, v134
    v_max_f32 v88, 0, v88
    v_mul_f32 v88, v88, v88
    v_fma_f32 v134, -v132, v193, v169
    v_fma_f32 v89, v133, v89, v134
    v_max_f32 v89, 0, v89
    v_mul_f32 v89, v89, v89
    v_fma_f32 v134, -v132, v194, v170
    v_fma_f32 v90, v133, v90, v134
    v_max_f32 v90, 0, v90
    v_mul_f32 v90, v90, v90
    v_fma_f32 v134, -v132, v195, v171
    v_fma_f32 v91, v133, v91, v134
    v_max_f32 v91, 0, v91
    v_mul_f32 v91, v91, v91
    v_fma_f32 v134, -v132, v196, v172
    v_fma_f32 v92, v133, v92, v134
    v_max_f32 v92, 0, v92
    v_mul_f32 v92, v92, v92
    v_fma_f32 v134, -v132, v197, v173
    v_fma_f32 v93, v133, v93, v134
    v_max_f32 v93, 0, v93
    v_mul_f32 v93, v93, v93
    v_fma_f32 v134, -v132, v198, v174
    v_fma_f32 v94, v133, v94, v134
    v_max_f32 v94, 0, v94
    v_mul_f32 v94, v94, v94
    v_fma_f32 v134, -v132, v199, v175
    v_fma_f32 v95, v133, v95, v134
    v_max_f32 v95, 0, v95
    v_mul_f32 v95, v95, v95
    v_fma_f32 v134, -v132, v200, v176
    v_fma_f32 v96, v133, v96, v134
    v_max_f32 v96, 0, v96
    v_mul_f32 v96, v96, v96
    v_fma_f32 v134, -v132, v201, v177
    v_fma_f32 v97, v133, v97, v134
    v_max_f32 v97, 0, v97
    v_mul_f32 v97, v97, v97
    v_fma_f32 v134, -v132, v202, v178
    v_fma_f32 v98, v133, v98, v134
    v_max_f32 v98, 0, v98
    v_mul_f32 v98, v98, v98
    v_fma_f32 v134, -v132, v203, v179
    v_fma_f32 v99, v133, v99, v134
    v_max_f32 v99, 0, v99
    v_mul_f32 v99, v99, v99
    v_fma_f32 v134, -v132, v204, v180
    v_fma_f32 v100, v133, v100, v134
    v_max_f32 v100, 0, v100
    v_mul_f32 v100, v100, v100
    v_fma_f32 v134, -v132, v205, v181
    v_fma_f32 v101, v133, v101, v134
    v_max_f32 v101, 0, v101
    v_mul_f32 v101, v101, v101
    v_fma_f32 v134, -v132, v206, v182
    v_fma_f32 v102, v133, v102, v134
    v_max_f32 v102, 0, v102
    v_mul_f32 v102, v102, v102
    v_fma_f32 v134, -v132, v207, v183
    v_fma_f32 v103, v133, v103, v134
    v_max_f32 v103, 0, v103
    v_mul_f32 v103, v103, v103
    v_cvt_pk_bf16_f32 v104, v72, v73
    v_cvt_pk_bf16_f32 v105, v74, v75
    v_cvt_pk_bf16_f32 v106, v76, v77
    v_cvt_pk_bf16_f32 v107, v78, v79
    v_cvt_pk_bf16_f32 v108, v80, v81
    v_cvt_pk_bf16_f32 v109, v82, v83
    v_cvt_pk_bf16_f32 v110, v84, v85
    v_cvt_pk_bf16_f32 v111, v86, v87
    v_cvt_pk_bf16_f32 v112, v88, v89
    v_cvt_pk_bf16_f32 v113, v90, v91
    v_cvt_pk_bf16_f32 v114, v92, v93
    v_cvt_pk_bf16_f32 v115, v94, v95
    v_cvt_pk_bf16_f32 v116, v96, v97
    v_cvt_pk_bf16_f32 v117, v98, v99
    v_cvt_pk_bf16_f32 v118, v100, v101
    v_cvt_pk_bf16_f32 v119, v102, v103
    v_lshrrev_b32 v13, 4, v3
    s_mov_b32 s18, 55296
    v_mul_lo_u32 v13, v13, s18
    v_and_b32 v14, 15, v3
    v_lshl_add_u32 v13, v14, 4, v13
    v_lshl_add_u32 v13, v4, 8, v13
    s_lshr_b32 s18, s27, 4
    s_mul_i32 s18, s18, 55296
    s_lshl_b32 s17, s14, 2
    s_add_u32 s17, s17, s23
    s_cmp_ge_u32 s17, 54
    s_cselect_b32 s19, 0x40000000, 0
    s_lshl_b32 s17, s17, 10
    s_add_u32 s17, s17, s18
    s_add_u32 s17, s17, 23429120
    s_add_u32 s17, s17, s19
    s_add_u32 s18, s17, 110592
    s_cmp_eq_u32 s66, 1
    s_cbranch_scc0 .Lst34
    buffer_store_dwordx4 v[104:107], v13, s[8:11], s17 offen
    buffer_store_dwordx4 v[108:111], v13, s[8:11], s17 offen offset:512
    buffer_store_dwordx4 v[112:115], v13, s[8:11], s18 offen
    buffer_store_dwordx4 v[116:119], v13, s[8:11], s18 offen offset:512
    s_branch .Lst35
.Lst34:
    buffer_store_dwordx4 v[104:107], v13, s[8:11], s17 offen sc1
    buffer_store_dwordx4 v[108:111], v13, s[8:11], s17 offen offset:512 sc1
    buffer_store_dwordx4 v[112:115], v13, s[8:11], s18 offen sc1
    buffer_store_dwordx4 v[116:119], v13, s[8:11], s18 offen offset:512 sc1
.Lst35:
    s_and_b32 s20, s65, 3
    s_lshr_b32 s21, s65, 2
    s_and_b32 s22, s12, 3
    s_lshr_b32 s23, s12, 2
    s_lshl_b32 s29, s64, 4
    s_lshl_b32 s30, s20, 2
    s_add_u32 s29, s29, s30
    s_add_u32 s29, s29, s22
    s_mul_i32 s32, s29, 55296
    s_mul_i32 s33, s23, 27648
    s_add_u32 s32, s32, s33
    s_add_u32 s32, s32, 23429120
    s_mul_i32 s34, s23, 20480
    v_add_u32 v8, s34, v10
    v_add_u32 v9, 0x10000, v8
    v_add_u32 v11, 0x20000, v8
    s_mov_b32 s52, s70
    s_and_b32 s53, s71, 0xffff
    s_mov_b32 s54, 1280
    s_mov_b32 s55, 0x20000
    v_and_b32 v5, 15, v2
    v_lshrrev_b32 v6, 4, v2
    s_mul_i32 s34, s29, 20480
    s_mul_i32 s35, s21, 2560
    s_add_u32 s34, s34, s35
    s_mul_i32 s35, s23, 1536
    s_add_u32 s34, s34, s35
    s_add_u32 s34, s34, 20807680
    v_lshrrev_b32 v12, 1, v6
    v_lshlrev_b32 v12, 8, v12
    v_lshl_add_u32 v12, v5, 4, v12
    v_and_b32 v13, 1, v6
    v_lshl_add_u32 v12, v13, 3, v12
    s_mul_i32 s35, s21, 160
    s_mul_i32 s36, s23, 96
    s_add_u32 s35, s35, s36
    v_lshlrev_b32 v13, 3, v6
    s_waitcnt vmcnt(0)
    s_barrier
    s_cmp_lg_u32 s12, 0
    s_cbranch_scc1 .Lsy36
    s_lshl_b32 s40, s64, 7
    s_lshl_b32 s41, s65, 2
    s_add_u32 s40, s40, s41
    s_add_u32 s40, s40, 30820352
    v_mov_b32 v14, 0
    v_mov_b32 v15, 1
    s_mov_b64 exec, 1
    s_cmp_eq_u32 s66, 1
    s_cbranch_scc0 .Lst41
    buffer_store_dword v15, v14, s[8:11], s40 offen
    s_branch .Lst42
.Lst41:
    buffer_store_dword v15, v14, s[8:11], s40 offen sc1
.Lst42:
    s_mov_b64 exec, -1
    s_and_b32 s40, s65, 2
    s_cmp_eq_u32 s40, 0
    s_mov_b32 s44, 0x0aaaaaaa
    s_cselect_b32 s44, 0x05555555, s44
    s_mov_b32 s45, 0
    s_lshl_b32 s40, s64, 7
    s_add_u32 s40, s40, 30820352
    v_lshlrev_b32 v14, 2, v2
    s_mov_b64 exec, s[44:45]
    s_mov_b32 s41, 0
.Lsy38:
    buffer_load_dword v15, v14, s[8:11], s40 offen sc1
    s_add_u32 s41, s41, 1
    s_waitcnt vmcnt(0)
    v_cmp_eq_u32 vcc, 0, v15
    s_cbranch_vccz .Lsy39
    s_cmp_lt_u32 s41, 40000
    s_cbranch_scc1 .Lsy38
.Lsy39:
    s_mov_b64 exec, -1
    s_cmp_eq_u32 s66, 1
    s_cbranch_scc1 .Lsy40
    buffer_inv sc1
    s_waitcnt vmcnt(0)
.Lsy40:
    s_barrier
    s_branch .Lsy37
.Lsy36:
    s_cmp_lg_u32 s12, 7
    s_cbranch_scc1 .Lw743
    s_sub_u32 s47, s47, 30720
    s_sub_u32 s48, s48, 35840
    s_add_u32 m0, s48, 0
    s_add_u32 s49, s47, 8192
    buffer_load_dwordx4 v10, s[8:11], s49 offen lds
    s_add_u32 m0, s48, 1024
    s_add_u32 s49, s47, 63488
    buffer_load_dwordx4 v10, s[8:11], s49 offen lds
    s_add_u32 m0, s48, 2048
    s_add_u32 s49, s47, 118784
    buffer_load_dwordx4 v10, s[8:11], s49 offen lds
    s_add_u32 m0, s48, 3072
    s_add_u32 s49, s47, 174080
    buffer_load_dwordx4 v10, s[8:11], s49 offen lds
    s_add_u32 m0, s48, 4096
    s_add_u32 s49, s47, 229376
    buffer_load_dwordx4 v10, s[8:11], s49 offen lds
    s_add_u32 m0, s48, 40960
    s_add_u32 s49, s47, 12288
    buffer_load_dwordx4 v10, s[8:11], s49 offen lds
    s_add_u32 m0, s48, 41984
    s_add_u32 s49, s47, 67584
    buffer_load_dwordx4 v10, s[8:11], s49 offen lds
    s_add_u32 m0, s48, 43008
    s_add_u32 s49, s47, 122880
    buffer_load_dwordx4 v10, s[8:11], s49 offen lds
    s_add_u32 m0, s48, 44032
    s_add_u32 s49, s47, 178176
    buffer_load_dwordx4 v10, s[8:11], s49 offen lds
    s_add_u32 m0, s48, 45056
    s_add_u32 s49, s47, 233472
    buffer_load_dwordx4 v10, s[8:11], s49 offen lds
    s_add_u32 s47, s47, 30720
    s_add_u32 s48, s48, 35840
.Lw743:
    s_add_u32 m0, s48, 0
    s_add_u32 s49, s47, 8192
    buffer_load_dwordx4 v10, s[8:11], s49 offen lds
    s_add_u32 m0, s48, 1024
    s_add_u32 s49, s47, 63488
    buffer_load_dwordx4 v10, s[8:11], s49 offen lds
    s_add_u32 m0, s48, 2048
    s_add_u32 s49, s47, 118784
    buffer_load_dwordx4 v10, s[8:11], s49 offen lds
    s_add_u32 m0, s48, 3072
    s_add_u32 s49, s47, 174080
    buffer_load_dwordx4 v10, s[8:11], s49 offen lds
    s_add_u32 m0, s48, 4096
    s_add_u32 s49, s47, 229376
    buffer_load_dwordx4 v10, s[8:11], s49 offen lds
    s_add_u32 m0, s48, 40960
    s_add_u32 s49, s47, 12288
    buffer_load_dwordx4 v10, s[8:11], s49 offen lds
    s_add_u32 m0, s48, 41984
    s_add_u32 s49, s47, 67584
    buffer_load_dwordx4 v10, s[8:11], s49 offen lds
    s_add_u32 m0, s48, 43008
    s_add_u32 s49, s47, 122880
    buffer_load_dwordx4 v10, s[8:11], s49 offen lds
    s_add_u32 m0, s48, 44032
    s_add_u32 s49, s47, 178176
    buffer_load_dwordx4 v10, s[8:11], s49 offen lds
    s_add_u32 m0, s48, 45056
    s_add_u32 s49, s47, 233472
    buffer_load_dwordx4 v10, s[8:11], s49 offen lds
    s_barrier
.Lsy37:
    s_branch kf_kernel_f2
kf_kernel_idle:
    s_waitcnt vmcnt(0)
    s_barrier
    s_cmp_lg_u32 s12, 0
    s_cbranch_scc1 .Lid44
    s_lshl_b32 s40, s64, 7
    s_lshl_b32 s41, s65, 2
    s_add_u32 s40, s40, s41
    s_add_u32 s40, s40, 30819328
    v_mov_b32 v14, 0
    v_mov_b32 v15, 1
    s_mov_b64 exec, 1
    s_cmp_eq_u32 s66, 1
    s_cbranch_scc0 .Lst45
    buffer_store_dword v15, v14, s[8:11], s40 offen
    s_branch .Lst46
.Lst45:
    buffer_store_dword v15, v14, s[8:11], s40 offen sc1
.Lst46:
    s_mov_b64 exec, -1
.Lid44:
    s_lshr_b32 s21, s65, 2
    s_lshr_b32 s22, s12, 2
    s_mul_i32 s22, s22, 27
    s_and_b32 s23, s12, 3
    s_add_u32 s22, s22, s23
    s_lshl_b32 s22, s22, 10
    s_mul_i32 s47, s21, 276480
    s_add_u32 s47, s47, 8110080
    s_add_u32 s47, s47, s22
    s_mul_i32 s48, s12, 5120
    s_add_u32 m0, s48, 81920
    s_add_u32 s49, s47, 0
    buffer_load_dwordx4 v10, s[8:11], s49 offen lds
    s_add_u32 m0, s48, 82944
    s_add_u32 s49, s47, 55296
    buffer_load_dwordx4 v10, s[8:11], s49 offen lds
    s_add_u32 m0, s48, 83968
    s_add_u32 s49, s47, 110592
    buffer_load_dwordx4 v10, s[8:11], s49 offen lds
    s_add_u32 m0, s48, 84992
    s_add_u32 s49, s47, 165888
    buffer_load_dwordx4 v10, s[8:11], s49 offen lds
    s_add_u32 m0, s48, 86016
    s_add_u32 s49, s47, 221184
    buffer_load_dwordx4 v10, s[8:11], s49 offen lds
    s_add_u32 m0, s48, 122880
    s_add_u32 s49, s47, 4096
    buffer_load_dwordx4 v10, s[8:11], s49 offen lds
    s_add_u32 m0, s48, 123904
    s_add_u32 s49, s47, 59392
    buffer_load_dwordx4 v10, s[8:11], s49 offen lds
    s_add_u32 m0, s48, 124928
    s_add_u32 s49, s47, 114688
    buffer_load_dwordx4 v10, s[8:11], s49 offen lds
    s_add_u32 m0, s48, 125952
    s_add_u32 s49, s47, 169984
    buffer_load_dwordx4 v10, s[8:11], s49 offen lds
    s_add_u32 m0, s48, 126976
    s_add_u32 s49, s47, 225280
    buffer_load_dwordx4 v10, s[8:11], s49 offen lds
    s_waitcnt vmcnt(0)
    s_and_b32 s20, s65, 3
    s_lshr_b32 s21, s65, 2
    s_and_b32 s22, s12, 3
    s_lshr_b32 s23, s12, 2
    s_lshl_b32 s29, s64, 4
    s_lshl_b32 s30, s20, 2
    s_add_u32 s29, s29, s30
    s_add_u32 s29, s29, s22
    s_mul_i32 s32, s29, 55296
    s_mul_i32 s33, s23, 27648
    s_add_u32 s32, s32, s33
    s_add_u32 s32, s32, 23429120
    s_mul_i32 s34, s23, 20480
    v_add_u32 v8, s34, v10
    v_add_u32 v9, 0x10000, v8
    v_add_u32 v11, 0x20000, v8
    s_mov_b32 s52, s70
    s_and_b32 s53, s71, 0xffff
    s_mov_b32 s54, 1280
    s_mov_b32 s55, 0x20000
    v_and_b32 v5, 15, v2
    v_lshrrev_b32 v6, 4, v2
    s_mul_i32 s34, s29, 20480
    s_mul_i32 s35, s21, 2560
    s_add_u32 s34, s34, s35
    s_mul_i32 s35, s23, 1536
    s_add_u32 s34, s34, s35
    s_add_u32 s34, s34, 20807680
    v_lshrrev_b32 v12, 1, v6
    v_lshlrev_b32 v12, 8, v12
    v_lshl_add_u32 v12, v5, 4, v12
    v_and_b32 v13, 1, v6
    v_lshl_add_u32 v12, v13, 3, v12
    s_mul_i32 s35, s21, 160
    s_mul_i32 s36, s23, 96
    s_add_u32 s35, s35, s36
    v_lshlrev_b32 v13, 3, v6
    s_cmp_lg_u32 s12, 0
    s_cbranch_scc1 .Lsy47
    s_and_b32 s40, s65, 2
    s_cmp_eq_u32 s40, 0
    s_mov_b32 s44, 0x0aaaaaaa
    s_cselect_b32 s44, 0x05555555, s44
    s_mov_b32 s45, 0
    s_lshl_b32 s40, s64, 7
    s_add_u32 s40, s40, 30820352
    v_lshlrev_b32 v14, 2, v2
    s_mov_b64 exec, s[44:45]
    s_mov_b32 s41, 0
.Lsy49:
    buffer_load_dword v15, v14, s[8:11], s40 offen sc1
    s_add_u32 s41, s41, 1
    s_waitcnt vmcnt(0)
    v_cmp_eq_u32 vcc, 0, v15
    s_cbranch_vccz .Lsy50
    s_cmp_lt_u32 s41, 40000
    s_cbranch_scc1 .Lsy49
.Lsy50:
    s_mov_b64 exec, -1
    s_cmp_eq_u32 s66, 1
    s_cbranch_scc1 .Lsy51
    buffer_inv sc1
    s_waitcnt vmcnt(0)
.Lsy51:
    s_barrier
    s_branch .Lsy48
.Lsy47:
    s_cmp_lg_u32 s12, 7
    s_cbranch_scc1 .Lw752
    s_sub_u32 s47, s47, 30720
    s_sub_u32 s48, s48, 35840
    s_add_u32 m0, s48, 0
    s_add_u32 s49, s47, 8192
    buffer_load_dwordx4 v10, s[8:11], s49 offen lds
    s_add_u32 m0, s48, 1024
    s_add_u32 s49, s47, 63488
    buffer_load_dwordx4 v10, s[8:11], s49 offen lds
    s_add_u32 m0, s48, 2048
    s_add_u32 s49, s47, 118784
    buffer_load_dwordx4 v10, s[8:11], s49 offen lds
    s_add_u32 m0, s48, 3072
    s_add_u32 s49, s47, 174080
    buffer_load_dwordx4 v10, s[8:11], s49 offen lds
    s_add_u32 m0, s48, 4096
    s_add_u32 s49, s47, 229376
    buffer_load_dwordx4 v10, s[8:11], s49 offen lds
    s_add_u32 m0, s48, 40960
    s_add_u32 s49, s47, 12288
    buffer_load_dwordx4 v10, s[8:11], s49 offen lds
    s_add_u32 m0, s48, 41984
    s_add_u32 s49, s47, 67584
    buffer_load_dwordx4 v10, s[8:11], s49 offen lds
    s_add_u32 m0, s48, 43008
    s_add_u32 s49, s47, 122880
    buffer_load_dwordx4 v10, s[8:11], s49 offen lds
    s_add_u32 m0, s48, 44032
    s_add_u32 s49, s47, 178176
    buffer_load_dwordx4 v10, s[8:11], s49 offen lds
    s_add_u32 m0, s48, 45056
    s_add_u32 s49, s47, 233472
    buffer_load_dwordx4 v10, s[8:11], s49 offen lds
    s_add_u32 s47, s47, 30720
    s_add_u32 s48, s48, 35840
.Lw752:
    s_add_u32 m0, s48, 0
    s_add_u32 s49, s47, 8192
    buffer_load_dwordx4 v10, s[8:11], s49 offen lds
    s_add_u32 m0, s48, 1024
    s_add_u32 s49, s47, 63488
    buffer_load_dwordx4 v10, s[8:11], s49 offen lds
    s_add_u32 m0, s48, 2048
    s_add_u32 s49, s47, 118784
    buffer_load_dwordx4 v10, s[8:11], s49 offen lds
    s_add_u32 m0, s48, 3072
    s_add_u32 s49, s47, 174080
    buffer_load_dwordx4 v10, s[8:11], s49 offen lds
    s_add_u32 m0, s48, 4096
    s_add_u32 s49, s47, 229376
    buffer_load_dwordx4 v10, s[8:11], s49 offen lds
    s_add_u32 m0, s48, 40960
    s_add_u32 s49, s47, 12288
    buffer_load_dwordx4 v10, s[8:11], s49 offen lds
    s_add_u32 m0, s48, 41984
    s_add_u32 s49, s47, 67584
    buffer_load_dwordx4 v10, s[8:11], s49 offen lds
    s_add_u32 m0, s48, 43008
    s_add_u32 s49, s47, 122880
    buffer_load_dwordx4 v10, s[8:11], s49 offen lds
    s_add_u32 m0, s48, 44032
    s_add_u32 s49, s47, 178176
    buffer_load_dwordx4 v10, s[8:11], s49 offen lds
    s_add_u32 m0, s48, 45056
    s_add_u32 s49, s47, 233472
    buffer_load_dwordx4 v10, s[8:11], s49 offen lds
    s_barrier
.Lsy48:
kf_kernel_f2:
    s_add_u32 s33, s32, 0
    buffer_load_dwordx4 v[16:19], v10, s[8:11], s33 offen sc1
    s_add_u32 s33, s32, 1024
    buffer_load_dwordx4 v[20:23], v10, s[8:11], s33 offen sc1
    s_add_u32 s33, s32, 2048
    buffer_load_dwordx4 v[24:27], v10, s[8:11], s33 offen sc1
    s_add_u32 s33, s32, 3072
    buffer_load_dwordx4 v[28:31], v10, s[8:11], s33 offen sc1
    s_add_u32 s33, s32, 4096
    buffer_load_dwordx4 v[32:35], v10, s[8:11], s33 offen sc1
    s_add_u32 s33, s32, 5120
    buffer_load_dwordx4 v[36:39], v10, s[8:11], s33 offen sc1
    s_waitcnt vmcnt(21)
    s_barrier
    ds_read_b128 v[144:147], v9 offset:16384
    ds_read_b128 v[148:151], v9 offset:17408
    ds_read_b128 v[152:155], v9 offset:18432
    ds_read_b128 v[156:159], v9 offset:19456
    ds_read_b128 v[160:163], v9 offset:20480
    ds_read_b128 v[164:167], v9 offset:21504
    ds_read_b128 v[168:171], v9 offset:22528
    ds_read_b128 v[172:175], v9 offset:23552
    ds_read_b128 v[176:179], v9 offset:24576
    ds_read_b128 v[180:183], v9 offset:25600
    s_waitcnt vmcnt(5) lgkmcnt(5)
    v_mfma_f32_16x16x32_bf16 v[124:127], v[144:147], v[16:19], 0
    v_mfma_f32_16x16x32_bf16 v[128:131], v[148:151], v[16:19], 0
    s_add_u32 s33, s32, 6144
    buffer_load_dwordx4 v[40:43], v10, s[8:11], s33 offen sc1
    v_mfma_f32_16x16x32_bf16 v[132:135], v[152:155], v[16:19], 0
    v_mfma_f32_16x16x32_bf16 v[136:139], v[156:159], v[16:19], 0
    v_mfma_f32_16x16x32_bf16 v[140:143], v[160:163], v[16:19], 0
    ds_read_b128 v[144:147], v9 offset:26624
    ds_read_b128 v[148:151], v9 offset:27648
    ds_read_b128 v[152:155], v9 offset:28672
    ds_read_b128 v[156:159], v9 offset:29696
    ds_read_b128 v[160:163], v9 offset:30720
    s_waitcnt vmcnt(5) lgkmcnt(5)
    v_mfma_f32_16x16x32_bf16 v[124:127], v[164:167], v[20:23], v[124:127]
    v_mfma_f32_16x16x32_bf16 v[128:131], v[168:171], v[20:23], v[128:131]
    s_add_u32 s33, s32, 7168
    buffer_load_dwordx4 v[44:47], v10, s[8:11], s33 offen sc1
    v_mfma_f32_16x16x32_bf16 v[132:135], v[172:175], v[20:23], v[132:135]
    v_mfma_f32_16x16x32_bf16 v[136:139], v[176:179], v[20:23], v[136:139]
    v_mfma_f32_16x16x32_bf16 v[140:143], v[180:183], v[20:23], v[140:143]
    ds_read_b128 v[164:167], v9 offset:31744
    ds_read_b128 v[168:171], v9 offset:32768
    ds_read_b128 v[172:175], v9 offset:33792
    ds_read_b128 v[176:179], v9 offset:34816
    ds_read_b128 v[180:183], v9 offset:35840
    s_waitcnt vmcnt(5) lgkmcnt(5)
    v_mfma_f32_16x16x32_bf16 v[124:127], v[144:147], v[24:27], v[124:127]
    v_mfma_f32_16x16x32_bf16 v[128:131], v[148:151], v[24:27], v[128:131]
    s_add_u32 s33, s32, 8192
    buffer_load_dwordx4 v[48:51], v10, s[8:11], s33 offen sc1
    v_mfma_f32_16x16x32_bf16 v[132:135], v[152:155], v[24:27], v[132:135]
    v_mfma_f32_16x16x32_bf16 v[136:139], v[156:159], v[24:27], v[136:139]
    v_mfma_f32_16x16x32_bf16 v[140:143], v[160:163], v[24:27], v[140:143]
    s_waitcnt lgkmcnt(0)
    s_waitcnt vmcnt(19)
    s_barrier
    ds_read_b128 v[144:147], v9 offset:57344
    ds_read_b128 v[148:151], v9 offset:58368
    ds_read_b128 v[152:155], v9 offset:59392
    ds_read_b128 v[156:159], v9 offset:60416
    ds_read_b128 v[160:163], v9 offset:61440
    s_waitcnt vmcnt(5)
    v_mfma_f32_16x16x32_bf16 v[124:127], v[164:167], v[28:31], v[124:127]
    v_mfma_f32_16x16x32_bf16 v[128:131], v[168:171], v[28:31], v[128:131]
    s_add_u32 s33, s32, 9216
    buffer_load_dwordx4 v[52:55], v10, s[8:11], s33 offen sc1
    v_mfma_f32_16x16x32_bf16 v[132:135], v[172:175], v[28:31], v[132:135]
    v_mfma_f32_16x16x32_bf16 v[136:139], v[176:179], v[28:31], v[136:139]
    s_add_u32 m0, s48, 81920
    s_add_u32 s49, s47, 16384
    buffer_load_dwordx4 v10, s[8:11], s49 offen lds
    v_mfma_f32_16x16x32_bf16 v[140:143], v[180:183], v[28:31], v[140:143]
    ds_read_b128 v[164:167], v9 offset:62464
    ds_read_b128 v[168:171], v9 offset:63488
    ds_read_b128 v[172:175], v9 offset:64512
    ds_read_b128 v[176:179], v11 offset:0
    ds_read_b128 v[180:183], v11 offset:1024
    s_waitcnt vmcnt(6) lgkmcnt(5)
    v_mfma_f32_16x16x32_bf16 v[124:127], v[144:147], v[32:35], v[124:127]
    v_mfma_f32_16x16x32_bf16 v[128:131], v[148:151], v[32:35], v[128:131]
    s_add_u32 s33, s32, 10240
    buffer_load_dwordx4 v[56:59], v10, s[8:11], s33 offen sc1
    v_mfma_f32_16x16x32_bf16 v[132:135], v[152:155], v[32:35], v[132:135]
    v_mfma_f32_16x16x32_bf16 v[136:139], v[156:159], v[32:35], v[136:139]
    s_add_u32 m0, s48, 82944
    s_add_u32 s49, s47, 71680
    buffer_load_dwordx4 v10, s[8:11], s49 offen lds
    v_mfma_f32_16x16x32_bf16 v[140:143], v[160:163], v[32:35], v[140:143]
    ds_read_b128 v[144:147], v11 offset:2048
    ds_read_b128 v[148:151], v11 offset:3072
    ds_read_b128 v[152:155], v11 offset:4096
    ds_read_b128 v[156:159], v11 offset:5120
    ds_read_b128 v[160:163], v11 offset:6144
    s_waitcnt vmcnt(7) lgkmcnt(5)
    v_mfma_f32_16x16x32_bf16 v[124:127], v[164:167], v[36:39], v[124:127]
    v_mfma_f32_16x16x32_bf16 v[128:131], v[168:171], v[36:39], v[128:131]
    s_add_u32 s33, s32, 11264
    buffer_load_dwordx4 v[60:63], v10, s[8:11], s33 offen sc1
    v_mfma_f32_16x16x32_bf16 v[132:135], v[172:175], v[36:39], v[132:135]
    v_mfma_f32_16x16x32_bf16 v[136:139], v[176:179], v[36:39], v[136:139]
    v_mfma_f32_16x16x32_bf16 v[140:143], v[180:183], v[36:39], v[140:143]
    ds_read_b128 v[164:167], v11 offset:7168
    ds_read_b128 v[168:171], v11 offset:8192
    ds_read_b128 v[172:175], v11 offset:9216
    ds_read_b128 v[176:179], v11 offset:10240
    ds_read_b128 v[180:183], v11 offset:11264
    s_waitcnt vmcnt(7) lgkmcnt(5)
    v_mfma_f32_16x16x32_bf16 v[124:127], v[144:147], v[40:43], v[124:127]
    v_mfma_f32_16x16x32_bf16 v[128:131], v[148:151], v[40:43], v[128:131]
    s_add_u32 s33, s32, 12288
    buffer_load_dwordx4 v[64:67], v10, s[8:11], s33 offen sc1
    v_mfma_f32_16x16x32_bf16 v[132:135], v[152:155], v[40:43], v[132:135]
    v_mfma_f32_16x16x32_bf16 v[136:139], v[156:159], v[40:43], v[136:139]
    s_add_u32 m0, s48, 83968
    s_add_u32 s49, s47, 126976
    buffer_load_dwordx4 v10, s[8:11], s49 offen lds
    v_mfma_f32_16x16x32_bf16 v[140:143], v[160:163], v[40:43], v[140:143]
    s_waitcnt lgkmcnt(0)
    s_waitcnt vmcnt(21)
    s_barrier
    ds_read_b128 v[144:147], v8 offset:0
    ds_read_b128 v[148:151], v8 offset:1024
    ds_read_b128 v[152:155], v8 offset:2048
    ds_read_b128 v[156:159], v8 offset:3072
    ds_read_b128 v[160:163], v8 offset:4096
    s_waitcnt vmcnt(8)
    v_mfma_f32_16x16x32_bf16 v[124:127], v[164:167], v[44:47], v[124:127]
    v_mfma_f32_16x16x32_bf16 v[128:131], v[168:171], v[44:47], v[128:131]
    s_add_u32 s33, s32, 13312
    buffer_load_dwordx4 v[68:71], v10, s[8:11], s33 offen sc1
    v_mfma_f32_16x16x32_bf16 v[132:135], v[172:175], v[44:47], v[132:135]
    v_mfma_f32_16x16x32_bf16 v[136:139], v[176:179], v[44:47], v[136:139]
    s_add_u32 m0, s48, 84992
    s_add_u32 s49, s47, 182272
    buffer_load_dwordx4 v10, s[8:11], s49 offen lds
    v_mfma_f32_16x16x32_bf16 v[140:143], v[180:183], v[44:47], v[140:143]
    ds_read_b128 v[164:167], v8 offset:5120
    ds_read_b128 v[168:171], v8 offset:6144
    ds_read_b128 v[172:175], v8 offset:7168
    ds_read_b128 v[176:179], v8 offset:8192
    ds_read_b128 v[180:183], v8 offset:9216
    s_waitcnt vmcnt(9) lgkmcnt(5)
    v_mfma_f32_16x16x32_bf16 v[124:127], v[144:147], v[48:51], v[124:127]
    v_mfma_f32_16x16x32_bf16 v[128:131], v[148:151], v[48:51], v[128:131]
    s_add_u32 s33, s32, 14336
    buffer_load_dwordx4 v[72:75], v10, s[8:11], s33 offen sc1
    v_mfma_f32_16x16x32_bf16 v[132:135], v[152:155], v[48:51], v[132:135]
    v_mfma_f32_16x16x32_bf16 v[136:139], v[156:159], v[48:51], v[136:139]
    v_mfma_f32_16x16x32_bf16 v[140:143], v[160:163], v[48:51], v[140:143]
    ds_read_b128 v[144:147], v8 offset:10240
    ds_read_b128 v[148:151], v8 offset:11264
    ds_read_b128 v[152:155], v8 offset:12288
    ds_read_b128 v[156:159], v8 offset:13312
    ds_read_b128 v[160:163], v8 offset:14336
    s_waitcnt vmcnt(9) lgkmcnt(5)
    v_mfma_f32_16x16x32_bf16 v[124:127], v[164:167], v[52:55], v[124:127]
    v_mfma_f32_16x16x32_bf16 v[128:131], v[168:171], v[52:55], v[128:131]
    s_add_u32 s33, s32, 15360
    buffer_load_dwordx4 v[76:79], v10, s[8:11], s33 offen sc1
    v_mfma_f32_16x16x32_bf16 v[132:135], v[172:175], v[52:55], v[132:135]
    v_mfma_f32_16x16x32_bf16 v[136:139], v[176:179], v[52:55], v[136:139]
    s_add_u32 m0, s48, 86016
    s_add_u32 s49, s47, 237568
    buffer_load_dwordx4 v10, s[8:11], s49 offen lds
    v_mfma_f32_16x16x32_bf16 v[140:143], v[180:183], v[52:55], v[140:143]
    ds_read_b128 v[164:167], v8 offset:15360
    ds_read_b128 v[168:171], v8 offset:16384
    ds_read_b128 v[172:175], v8 offset:17408
    ds_read_b128 v[176:179], v8 offset:18432
    ds_read_b128 v[180:183], v8 offset:19456
    s_waitcnt vmcnt(9) lgkmcnt(5)
    v_mfma_f32_16x16x32_bf16 v[124:127], v[144:147], v[56:59], v[124:127]
    v_mfma_f32_16x16x32_bf16 v[128:131], v[148:151], v[56:59], v[128:131]
    s_add_u32 s33, s32, 16384
    buffer_load_dwordx4 v[80:83], v10, s[8:11], s33 offen sc1
    v_mfma_f32_16x16x32_bf16 v[132:135], v[152:155], v[56:59], v[132:135]
    v_mfma_f32_16x16x32_bf16 v[136:139], v[156:159], v[56:59], v[136:139]
    s_add_u32 m0, s48, 122880
    s_add_u32 s49, s47, 20480
    buffer_load_dwordx4 v10, s[8:11], s49 offen lds
    v_mfma_f32_16x16x32_bf16 v[140:143], v[160:163], v[56:59], v[140:143]
    s_waitcnt lgkmcnt(0)
    s_waitcnt vmcnt(23)
    s_barrier
    ds_read_b128 v[144:147], v8 offset:40960
    ds_read_b128 v[148:151], v8 offset:41984
    ds_read_b128 v[152:155], v8 offset:43008
    ds_read_b128 v[156:159], v8 offset:44032
    ds_read_b128 v[160:163], v8 offset:45056
    s_waitcnt vmcnt(9)
    v_mfma_f32_16x16x32_bf16 v[124:127], v[164:167], v[60:63], v[124:127]
    v_mfma_f32_16x16x32_bf16 v[128:131], v[168:171], v[60:63], v[128:131]
    s_add_u32 s33, s32, 17408
    buffer_load_dwordx4 v[84:87], v10, s[8:11], s33 offen sc1
    v_mfma_f32_16x16x32_bf16 v[132:135], v[172:175], v[60:63], v[132:135]
    v_mfma_f32_16x16x32_bf16 v[136:139], v[176:179], v[60:63], v[136:139]
    s_add_u32 m0, s48, 123904
    s_add_u32 s49, s47, 75776
    buffer_load_dwordx4 v10, s[8:11], s49 offen lds
    v_mfma_f32_16x16x32_bf16 v[140:143], v[180:183], v[60:63], v[140:143]
    ds_read_b128 v[164:167], v8 offset:46080
    ds_read_b128 v[168:171], v8 offset:47104
    ds_read_b128 v[172:175], v8 offset:48128
    ds_read_b128 v[176:179], v8 offset:49152
    ds_read_b128 v[180:183], v8 offset:50176
    s_waitcnt vmcnt(10) lgkmcnt(5)
    v_mfma_f32_16x16x32_bf16 v[124:127], v[144:147], v[64:67], v[124:127]
    v_mfma_f32_16x16x32_bf16 v[128:131], v[148:151], v[64:67], v[128:131]
    s_add_u32 s33, s32, 18432
    buffer_load_dwordx4 v[88:91], v10, s[8:11], s33 offen sc1
    v_mfma_f32_16x16x32_bf16 v[132:135], v[152:155], v[64:67], v[132:135]
    v_mfma_f32_16x16x32_bf16 v[136:139], v[156:159], v[64:67], v[136:139]
    s_add_u32 m0, s48, 124928
    s_add_u32 s49, s47, 131072
    buffer_load_dwordx4 v10, s[8:11], s49 offen lds
    v_mfma_f32_16x16x32_bf16 v[140:143], v[160:163], v[64:67], v[140:143]
    ds_read_b128 v[144:147], v8 offset:51200
    ds_read_b128 v[148:151], v8 offset:52224
    ds_read_b128 v[152:155], v8 offset:53248
    ds_read_b128 v[156:159], v8 offset:54272
    ds_read_b128 v[160:163], v8 offset:55296
    s_waitcnt vmcnt(10) lgkmcnt(5)
    v_mfma_f32_16x16x32_bf16 v[124:127], v[164:167], v[68:71], v[124:127]
    v_mfma_f32_16x16x32_bf16 v[128:131], v[168:171], v[68:71], v[128:131]
    s_add_u32 s33, s32, 19456
    buffer_load_dwordx4 v[92:95], v10, s[8:11], s33 offen sc1
    v_mfma_f32_16x16x32_bf16 v[132:135], v[172:175], v[68:71], v[132:135]
    v_mfma_f32_16x16x32_bf16 v[136:139], v[176:179], v[68:71], v[136:139]
    s_add_u32 m0, s48, 125952
    s_add_u32 s49, s47, 186368
    buffer_load_dwordx4 v10, s[8:11], s49 offen lds
    v_mfma_f32_16x16x32_bf16 v[140:143], v[180:183], v[68:71], v[140:143]
    ds_read_b128 v[164:167], v8 offset:56320
    ds_read_b128 v[168:171], v8 offset:57344
    ds_read_b128 v[172:175], v8 offset:58368
    ds_read_b128 v[176:179], v8 offset:59392
    ds_read_b128 v[180:183], v8 offset:60416
    s_waitcnt vmcnt(10) lgkmcnt(5)
    v_mfma_f32_16x16x32_bf16 v[124:127], v[144:147], v[72:75], v[124:127]
    v_mfma_f32_16x16x32_bf16 v[128:131], v[148:151], v[72:75], v[128:131]
    s_add_u32 s33, s32, 20480
    buffer_load_dwordx4 v[96:99], v10, s[8:11], s33 offen sc1
    v_mfma_f32_16x16x32_bf16 v[132:135], v[152:155], v[72:75], v[132:135]
    s_add_u32 m0, s48, 126976
    s_add_u32 s49, s47, 241664
    buffer_load_dwordx4 v10, s[8:11], s49 offen lds
    v_mfma_f32_16x16x32_bf16 v[136:139], v[156:159], v[72:75], v[136:139]
    v_mfma_f32_16x16x32_bf16 v[140:143], v[160:163], v[72:75], v[140:143]
    s_add_u32 m0, s48, 0
    s_add_u32 s49, s47, 24576
    buffer_load_dwordx4 v10, s[8:11], s49 offen lds
    s_waitcnt lgkmcnt(0)
    s_waitcnt vmcnt(11)
    s_barrier
    ds_read_b128 v[144:147], v9 offset:16384
    ds_read_b128 v[148:151], v9 offset:17408
    ds_read_b128 v[152:155], v9 offset:18432
    ds_read_b128 v[156:159], v9 offset:19456
    ds_read_b128 v[160:163], v9 offset:20480
    s_waitcnt vmcnt(12)
    v_mfma_f32_16x16x32_bf16 v[124:127], v[164:167], v[76:79], v[124:127]
    v_mfma_f32_16x16x32_bf16 v[128:131], v[168:171], v[76:79], v[128:131]
    s_add_u32 s33, s32, 21504
    buffer_load_dwordx4 v[100:103], v10, s[8:11], s33 offen sc1
    v_mfma_f32_16x16x32_bf16 v[132:135], v[172:175], v[76:79], v[132:135]
    v_mfma_f32_16x16x32_bf16 v[136:139], v[176:179], v[76:79], v[136:139]
    s_add_u32 m0, s48, 1024
    s_add_u32 s49, s47, 79872
    buffer_load_dwordx4 v10, s[8:11], s49 offen lds
    v_mfma_f32_16x16x32_bf16 v[140:143], v[180:183], v[76:79], v[140:143]
    ds_read_b128 v[164:167], v9 offset:21504
    ds_read_b128 v[168:171], v9 offset:22528
    ds_read_b128 v[172:175], v9 offset:23552
    ds_read_b128 v[176:179], v9 offset:24576
    ds_read_b128 v[180:183], v9 offset:25600
    s_waitcnt vmcnt(12) lgkmcnt(5)
    v_mfma_f32_16x16x32_bf16 v[124:127], v[144:147], v[80:83], v[124:127]
    v_mfma_f32_16x16x32_bf16 v[128:131], v[148:151], v[80:83], v[128:131]
    s_add_u32 s33, s32, 22528
    buffer_load_dwordx4 v[104:107], v10, s[8:11], s33 offen sc1
    v_mfma_f32_16x16x32_bf16 v[132:135], v[152:155], v[80:83], v[132:135]
    v_mfma_f32_16x16x32_bf16 v[136:139], v[156:159], v[80:83], v[136:139]
    s_add_u32 m0, s48, 2048
    s_add_u32 s49, s47, 135168
    buffer_load_dwordx4 v10, s[8:11], s49 offen lds
    v_mfma_f32_16x16x32_bf16 v[140:143], v[160:163], v[80:83], v[140:143]
    ds_read_b128 v[144:147], v9 offset:26624
    ds_read_b128 v[148:151], v9 offset:27648
    ds_read_b128 v[152:155], v9 offset:28672
    ds_read_b128 v[156:159], v9 offset:29696
    ds_read_b128 v[160:163], v9 offset:30720
    s_waitcnt vmcnt(12) lgkmcnt(5)
    v_mfma_f32_16x16x32_bf16 v[124:127], v[164:167], v[84:87], v[124:127]
    v_mfma_f32_16x16x32_bf16 v[128:131], v[168:171], v[84:87], v[128:131]
    s_add_u32 s33, s32, 23552
    buffer_load_dwordx4 v[108:111], v10, s[8:11], s33 offen sc1
    v_mfma_f32_16x16x32_bf16 v[132:135], v[172:175], v[84:87], v[132:135]
    v_mfma_f32_16x16x32_bf16 v[136:139], v[176:179], v[84:87], v[136:139]
    s_add_u32 m0, s48, 3072
    s_add_u32 s49, s47, 190464
    buffer_load_dwordx4 v10, s[8:11], s49 offen lds
    v_mfma_f32_16x16x32_bf16 v[140:143], v[180:183], v[84:87], v[140:143]
    ds_read_b128 v[164:167], v9 offset:31744
    ds_read_b128 v[168:171], v9 offset:32768
    ds_read_b128 v[172:175], v9 offset:33792
    ds_read_b128 v[176:179], v9 offset:34816
    ds_read_b128 v[180:183], v9 offset:35840
    s_waitcnt vmcnt(12) lgkmcnt(5)
    v_mfma_f32_16x16x32_bf16 v[124:127], v[144:147], v[88:91], v[124:127]
    v_mfma_f32_16x16x32_bf16 v[128:131], v[148:151], v[88:91], v[128:131]
    s_add_u32 s33, s32, 24576
    buffer_load_dwordx4 v[112:115], v10, s[8:11], s33 offen sc1
    v_mfma_f32_16x16x32_bf16 v[132:135], v[152:155], v[88:91], v[132:135]
    v_mfma_f32_16x16x32_bf16 v[136:139], v[156:159], v[88:91], v[136:139]
    s_add_u32 m0, s48, 4096
    s_add_u32 s49, s47, 245760
    buffer_load_dwordx4 v10, s[8:11], s49 offen lds
    v_mfma_f32_16x16x32_bf16 v[140:143], v[160:163], v[88:91], v[140:143]
    s_waitcnt lgkmcnt(0)
    s_waitcnt vmcnt(9)
    s_barrier
    ds_read_b128 v[144:147], v9 offset:57344
    ds_read_b128 v[148:151], v9 offset:58368
    ds_read_b128 v[152:155], v9 offset:59392
    ds_read_b128 v[156:159], v9 offset:60416
    ds_read_b128 v[160:163], v9 offset:61440
    s_waitcnt vmcnt(12)
    v_mfma_f32_16x16x32_bf16 v[124:127], v[164:167], v[92:95], v[124:127]
    v_mfma_f32_16x16x32_bf16 v[128:131], v[168:171], v[92:95], v[128:131]
    s_add_u32 s33, s32, 25600
    buffer_load_dwordx4 v[116:119], v10, s[8:11], s33 offen sc1
    v_mfma_f32_16x16x32_bf16 v[132:135], v[172:175], v[92:95], v[132:135]
    v_mfma_f32_16x16x32_bf16 v[136:139], v[176:179], v[92:95], v[136:139]
    v_mfma_f32_16x16x32_bf16 v[140:143], v[180:183], v[92:95], v[140:143]
    ds_read_b128 v[164:167], v9 offset:62464
    ds_read_b128 v[168:171], v9 offset:63488
    ds_read_b128 v[172:175], v9 offset:64512
    ds_read_b128 v[176:179], v11 offset:0
    ds_read_b128 v[180:183], v11 offset:1024
    s_waitcnt vmcnt(11) lgkmcnt(5)
    v_mfma_f32_16x16x32_bf16 v[124:127], v[144:147], v[96:99], v[124:127]
    v_mfma_f32_16x16x32_bf16 v[128:131], v[148:151], v[96:99], v[128:131]
    s_add_u32 s33, s32, 26624
    buffer_load_dwordx4 v[120:123], v10, s[8:11], s33 offen sc1
    v_mfma_f32_16x16x32_bf16 v[132:135], v[152:155], v[96:99], v[132:135]
    v_mfma_f32_16x16x32_bf16 v[136:139], v[156:159], v[96:99], v[136:139]
    v_mfma_f32_16x16x32_bf16 v[140:143], v[160:163], v[96:99], v[140:143]
    buffer_load_dwordx2 v[200:201], v12, s[8:11], s34 offen offset:0 sc1
    buffer_load_dwordx2 v[202:203], v12, s[8:11], s34 offen offset:512 sc1
    buffer_load_dwordx2 v[204:205], v12, s[8:11], s34 offen offset:1024 sc1
    buffer_load_dwordx2 v[208:209], v13, s[52:55], s35 offen offset:0
    buffer_load_dwordx2 v[210:211], v13, s[52:55], s35 offen offset:32
    buffer_load_dwordx2 v[212:213], v13, s[52:55], s35 offen offset:64
    ds_read_b128 v[144:147], v11 offset:2048
    ds_read_b128 v[148:151], v11 offset:3072
    ds_read_b128 v[152:155], v11 offset:4096
    ds_read_b128 v[156:159], v11 offset:5120
    ds_read_b128 v[160:163], v11 offset:6144
    s_waitcnt vmcnt(15) lgkmcnt(5)
    v_mfma_f32_16x16x32_bf16 v[124:127], v[164:167], v[100:103], v[124:127]
    v_mfma_f32_16x16x32_bf16 v[128:131], v[168:171], v[100:103], v[128:131]
    v_mfma_f32_16x16x32_bf16 v[132:135], v[172:175], v[100:103], v[132:135]
    v_mfma_f32_16x16x32_bf16 v[136:139], v[176:179], v[100:103], v[136:139]
    v_mfma_f32_16x16x32_bf16 v[140:143], v[180:183], v[100:103], v[140:143]
    ds_read_b128 v[164:167], v11 offset:7168
    ds_read_b128 v[168:171], v11 offset:8192
    ds_read_b128 v[172:175], v11 offset:9216
    ds_read_b128 v[176:179], v11 offset:10240
    ds_read_b128 v[180:183], v11 offset:11264
    s_waitcnt vmcnt(13) lgkmcnt(5)
    v_mfma_f32_16x16x32_bf16 v[124:127], v[144:147], v[104:107], v[124:127]
    v_mfma_f32_16x16x32_bf16 v[128:131], v[148:151], v[104:107], v[128:131]
    v_mfma_f32_16x16x32_bf16 v[132:135], v[152:155], v[104:107], v[132:135]
    v_mfma_f32_16x16x32_bf16 v[136:139], v[156:159], v[104:107], v[136:139]
    v_mfma_f32_16x16x32_bf16 v[140:143], v[160:163], v[104:107], v[140:143]
    s_waitcnt lgkmcnt(0)
    s_waitcnt vmcnt(8)
    s_barrier
    ds_read_b128 v[144:147], v8 offset:0
    ds_read_b128 v[148:151], v8 offset:1024
    ds_read_b128 v[152:155], v8 offset:2048
    ds_read_b128 v[156:159], v8 offset:3072
    ds_read_b128 v[160:163], v8 offset:4096
    s_waitcnt vmcnt(11)
    v_mfma_f32_16x16x32_bf16 v[124:127], v[164:167], v[108:111], v[124:127]
    v_mfma_f32_16x16x32_bf16 v[128:131], v[168:171], v[108:111], v[128:131]
    v_mfma_f32_16x16x32_bf16 v[132:135], v[172:175], v[108:111], v[132:135]
    v_mfma_f32_16x16x32_bf16 v[136:139], v[176:179], v[108:111], v[136:139]
    v_mfma_f32_16x16x32_bf16 v[140:143], v[180:183], v[108:111], v[140:143]
    ds_read_b128 v[164:167], v8 offset:5120
    ds_read_b128 v[168:171], v8 offset:6144
    ds_read_b128 v[172:175], v8 offset:7168
    ds_read_b128 v[176:179], v8 offset:8192
    ds_read_b128 v[180:183], v8 offset:9216
    s_waitcnt vmcnt(9) lgkmcnt(5)
    v_mfma_f32_16x16x32_bf16 v[124:127], v[144:147], v[112:115], v[124:127]
    v_mfma_f32_16x16x32_bf16 v[128:131], v[148:151], v[112:115], v[128:131]
    v_mfma_f32_16x16x32_bf16 v[132:135], v[152:155], v[112:115], v[132:135]
    v_mfma_f32_16x16x32_bf16 v[136:139], v[156:159], v[112:115], v[136:139]
    v_mfma_f32_16x16x32_bf16 v[140:143], v[160:163], v[112:115], v[140:143]
    ds_read_b128 v[144:147], v8 offset:10240
    ds_read_b128 v[148:151], v8 offset:11264
    ds_read_b128 v[152:155], v8 offset:12288
    ds_read_b128 v[156:159], v8 offset:13312
    ds_read_b128 v[160:163], v8 offset:14336
    s_waitcnt vmcnt(7) lgkmcnt(5)
    v_mfma_f32_16x16x32_bf16 v[124:127], v[164:167], v[116:119], v[124:127]
    v_mfma_f32_16x16x32_bf16 v[128:131], v[168:171], v[116:119], v[128:131]
    v_mfma_f32_16x16x32_bf16 v[132:135], v[172:175], v[116:119], v[132:135]
    v_mfma_f32_16x16x32_bf16 v[136:139], v[176:179], v[116:119], v[136:139]
    v_mfma_f32_16x16x32_bf16 v[140:143], v[180:183], v[116:119], v[140:143]
    s_waitcnt vmcnt(6) lgkmcnt(0)
    v_mfma_f32_16x16x32_bf16 v[124:127], v[144:147], v[120:123], v[124:127]
    v_mfma_f32_16x16x32_bf16 v[128:131], v[148:151], v[120:123], v[128:131]
    v_mfma_f32_16x16x32_bf16 v[132:135], v[152:155], v[120:123], v[132:135]
    v_mfma_f32_16x16x32_bf16 v[136:139], v[156:159], v[120:123], v[136:139]
    v_mfma_f32_16x16x32_bf16 v[140:143], v[160:163], v[120:123], v[140:143]
    s_mul_i32 s40, s12, 3072
    s_add_u32 s40, s40, 81920
    v_add_u32 v14, s40, v10
    s_nop 7
    s_cmp_eq_u32 s23, 0
    s_cbranch_scc0 .Lfx53
    ds_write_b128 v14, v[136:139] offset:0
    ds_write_b128 v14, v[140:143] offset:1024
    s_branch .Lfx54
.Lfx53:
    ds_write_b128 v14, v[124:127] offset:0
    ds_write_b128 v14, v[128:131] offset:1024
    ds_write_b128 v14, v[132:135] offset:2048
    s_waitcnt lgkmcnt(0)
    v_mov_b32 v124, v136
    v_mov_b32 v125, v137
    v_mov_b32 v126, v138
    v_mov_b32 v127, v139
    v_mov_b32 v128, v140
    v_mov_b32 v129, v141
    v_mov_b32 v130, v142
    v_mov_b32 v131, v143
.Lfx54:
    s_xor_b32 s40, s12, 4
    s_mul_i32 s40, s40, 3072
    s_add_u32 s40, s40, 81920
    v_add_u32 v14, s40, v10
    s_waitcnt lgkmcnt(0)
    s_barrier
    ds_read_b128 v[184:187], v14 offset:0
    ds_read_b128 v[188:191], v14 offset:1024
    ds_read_b128 v[192:195], v14 offset:2048
    s_waitcnt vmcnt(0) lgkmcnt(0)
    v_add_f32 v124, v124, v184
    v_add_f32 v125, v125, v185
    v_add_f32 v126, v126, v186
    v_add_f32 v127, v127, v187
    v_add_f32 v128, v128, v188
    v_add_f32 v129, v129, v189
    v_add_f32 v130, v130, v190
    v_add_f32 v131, v131, v191
    v_add_f32 v132, v132, v192
    v_add_f32 v133, v133, v193
    v_add_f32 v134, v134, v194
    v_add_f32 v135, v135, v195
    v_lshlrev_b32 v184, 16, v200
    v_and_b32 v185, 0xffff0000, v200
    v_lshlrev_b32 v186, 16, v208
    v_and_b32 v187, 0xffff0000, v208
    v_add_f32 v124, v124, v186
    v_add_f32 v125, v125, v187
    v_add_f32 v124, v124, v184
    v_add_f32 v125, v125, v185
    v_lshlrev_b32 v184, 16, v201
    v_and_b32 v185, 0xffff0000, v201
    v_lshlrev_b32 v186, 16, v209
    v_and_b32 v187, 0xffff0000, v209
    v_add_f32 v126, v126, v186
    v_add_f32 v127, v127, v187
    v_add_f32 v126, v126, v184
    v_add_f32 v127, v127, v185
    v_lshlrev_b32 v184, 16, v202
    v_and_b32 v185, 0xffff0000, v202
    v_lshlrev_b32 v186, 16, v210
    v_and_b32 v187, 0xffff0000, v210
    v_add_f32 v128, v128, v186
    v_add_f32 v129, v129, v187
    v_add_f32 v128, v128, v184
    v_add_f32 v129, v129, v185
    v_lshlrev_b32 v184, 16, v203
    v_and_b32 v185, 0xffff0000, v203
    v_lshlrev_b32 v186, 16, v211
    v_and_b32 v187, 0xffff0000, v211
    v_add_f32 v130, v130, v186
    v_add_f32 v131, v131, v187
    v_add_f32 v130, v130, v184
    v_add_f32 v131, v131, v185
    v_lshlrev_b32 v184, 16, v204
    v_and_b32 v185, 0xffff0000, v204
    v_lshlrev_b32 v186, 16, v212
    v_and_b32 v187, 0xffff0000, v212
    v_add_f32 v132, v132, v186
    v_add_f32 v133, v133, v187
    v_add_f32 v132, v132, v184
    v_add_f32 v133, v133, v185
    v_lshlrev_b32 v184, 16, v205
    v_and_b32 v185, 0xffff0000, v205
    v_lshlrev_b32 v186, 16, v213
    v_and_b32 v187, 0xffff0000, v213
    v_add_f32 v134, v134, v186
    v_add_f32 v135, v135, v187
    v_add_f32 v134, v134, v184
    v_add_f32 v135, v135, v185
    v_cvt_pk_bf16_f32 v188, v124, v125
    v_cvt_pk_bf16_f32 v189, v126, v127
    v_cvt_pk_bf16_f32 v190, v128, v129
    v_cvt_pk_bf16_f32 v191, v130, v131
    v_cvt_pk_bf16_f32 v192, v132, v133
    v_cvt_pk_bf16_f32 v193, v134, v135
    s_lshl_b32 s33, s29, 4
    v_add_u32 v7, s33, v5
    s_movk_i32 s34, 1280
    v_mul_lo_u32 v7, v7, s34
    v_lshl_add_u32 v7, v6, 3, v7
    s_mul_i32 s34, s21, 160
    s_mul_i32 s35, s23, 96
    s_add_u32 s34, s34, s35
    s_cmp_eq_u32 s23, 0
    s_cselect_b32 s35, s34, 0x7ff00000
    buffer_store_dwordx2 v[188:189], v7, s[76:79], s34 offen
    buffer_store_dwordx2 v[190:191], v7, s[76:79], s34 offen offset:32
    buffer_store_dwordx2 v[192:193], v7, s[76:79], s35 offen offset:64
kf_kernel_fin:
kf_kernel_end:
    s_endpgm
.Lat_fallback:
    s_mov_b32 s39, 1
    s_sub_u32 s52, s52, 81920
    s_sub_u32 s53, s53, 2621440
    v_mov_b32 v72, 0xff7fffff
    v_mov_b32 v73, 0xff7fffff
    s_mov_b32 s60, 16
.Lat_fb1:
    s_barrier
    s_add_u32 m0, s54, 28672
    s_mov_b64 exec, s[58:59]
    buffer_load_dwordx4 v8, s[8:11], s52 offen lds
    s_mov_b64 exec, -1
    s_add_u32 s52, s52, 5120
    s_add_u32 m0, s55, 28672
    s_nop 0
    buffer_load_dwordx4 v9, s[8:11], s53 offen lds
    s_add_u32 s53, s53, 163840
    s_waitcnt vmcnt(0)
    s_barrier
    ds_read_b128 v[28:31], v11 offset:28672
    ds_read_b64 v[36:37], v12 offset:28672
    s_waitcnt lgkmcnt(0)
    v_mfma_f32_32x32x16_bf16 v[56:71], v[28:31], v[16:19], 0
    v_mfma_f32_32x32x8bf16_1k v[56:71], v[36:37], v[24:25], v[56:71]
    s_nop 11
    v_max3_f32 v72, v56, v57, v72
    v_max3_f32 v72, v58, v59, v72
    v_max3_f32 v72, v60, v61, v72
    v_max3_f32 v72, v62, v63, v72
    v_max3_f32 v72, v64, v65, v72
    v_max3_f32 v72, v66, v67, v72
    v_max3_f32 v72, v68, v69, v72
    v_max3_f32 v72, v70, v71, v72
    v_mfma_f32_32x32x16_bf16 v[56:71], v[28:31], v[20:23], 0
    v_mfma_f32_32x32x8bf16_1k v[56:71], v[36:37], v[26:27], v[56:71]
    s_nop 11
    v_max3_f32 v73, v56, v57, v73
    v_max3_f32 v73, v58, v59, v73
    v_max3_f32 v73, v60, v61, v73
    v_max3_f32 v73, v62, v63, v73
    v_max3_f32 v73, v64, v65, v73
    v_max3_f32 v73, v66, v67, v73
    v_max3_f32 v73, v68, v69, v73
    v_max3_f32 v73, v70, v71, v73
    ds_read_b128 v[28:31], v11 offset:29696
    ds_read_b64 v[36:37], v12 offset:29184
    s_waitcnt lgkmcnt(0)
    v_mfma_f32_32x32x16_bf16 v[56:71], v[28:31], v[16:19], 0
    v_mfma_f32_32x32x8bf16_1k v[56:71], v[36:37], v[24:25], v[56:71]
    s_nop 11
    v_max3_f32 v72, v56, v57, v72
    v_max3_f32 v72, v58, v59, v72
    v_max3_f32 v72, v60, v61, v72
    v_max3_f32 v72, v62, v63, v72
    v_max3_f32 v72, v64, v65, v72
    v_max3_f32 v72, v66, v67, v72
    v_max3_f32 v72, v68, v69, v72
    v_max3_f32 v72, v70, v71, v72
    v_mfma_f32_32x32x16_bf16 v[56:71], v[28:31], v[20:23], 0
    v_mfma_f32_32x32x8bf16_1k v[56:71], v[36:37], v[26:27], v[56:71]
    s_nop 11
    v_max3_f32 v73, v56, v57, v73
    v_max3_f32 v73, v58, v59, v73
    v_max3_f32 v73, v60, v61, v73
    v_max3_f32 v73, v62, v63, v73
    v_max3_f32 v73, v64, v65, v73
    v_max3_f32 v73, v66, v67, v73
    v_max3_f32 v73, v68, v69, v73
    v_max3_f32 v73, v70, v71, v73
    s_sub_u32 s60, s60, 1
    s_cmp_lg_u32 s60, 0
    s_cbranch_scc1 .Lat_fb1
    v_mov_b32 v56, v72
    v_mov_b32 v57, v72
    s_nop 1
    v_permlane32_swap_b32 v56, v57
    v_max_f32 v72, v56, v57
    v_mov_b32 v56, v73
    v_mov_b32 v57, v73
    s_nop 1
    v_permlane32_swap_b32 v56, v57
    v_max_f32 v73, v56, v57
    s_barrier
    s_lshl_b32 s40, s12, 9
    v_lshlrev_b32 v14, 3, v2
    v_add_u32 v14, s40, v14
    ds_write_b64 v14, v[72:73]
    s_xor_b32 s40, s12, 4
    s_lshl_b32 s40, s40, 9
    v_lshlrev_b32 v14, 3, v2
    v_add_u32 v14, s40, v14
    s_waitcnt lgkmcnt(0)
    s_barrier
    ds_read_b64 v[56:57], v14
    s_waitcnt lgkmcnt(0)
    v_max_f32 v72, v72, v56
    v_max_f32 v73, v73, v57
    s_sub_u32 s52, s52, 81920
    s_sub_u32 s53, s53, 2621440
    v_mov_b32 v104, 0
    v_mov_b32 v105, 0
    v_mov_b32 v106, 0
    v_mov_b32 v107, 0
    v_mov_b32 v108, 0
    v_mov_b32 v109, 0
    v_mov_b32 v110, 0
    v_mov_b32 v111, 0
    v_mov_b32 v112, 0
    v_mov_b32 v113, 0
    v_mov_b32 v114, 0
    v_mov_b32 v115, 0
    v_mov_b32 v116, 0
    v_mov_b32 v117, 0
    v_mov_b32 v118, 0
    v_mov_b32 v119, 0
    v_mov_b32 v120, 0
    v_mov_b32 v121, 0
    v_mov_b32 v122, 0
    v_mov_b32 v123, 0
    v_mov_b32 v124, 0
    v_mov_b32 v125, 0
    v_mov_b32 v126, 0
    v_mov_b32 v127, 0
    v_mov_b32 v128, 0
    v_mov_b32 v129, 0
    v_mov_b32 v130, 0
    v_mov_b32 v131, 0
    v_mov_b32 v132, 0
    v_mov_b32 v133, 0
    v_mov_b32 v134, 0
    v_mov_b32 v135, 0
    s_mov_b32 s60, 16
.Lat_fb2:
    s_barrier
    s_add_u32 m0, s54, 28672
    s_mov_b64 exec, s[58:59]
    buffer_load_dwordx4 v8, s[8:11], s52 offen lds
    s_mov_b64 exec, -1
    s_add_u32 s52, s52, 5120
    s_add_u32 m0, s55, 28672
    s_nop 0
    buffer_load_dwordx4 v9, s[8:11], s53 offen lds
    s_add_u32 s53, s53, 163840
    s_waitcnt vmcnt(0)
    s_barrier
    ds_read_b128 v[28:31], v11 offset:28672
    ds_read_b64 v[36:37], v12 offset:28672
    ds_read_b128 v[40:43], v13 offset:28672
    ds_read_b128 v[44:47], v13 offset:29696
    s_waitcnt lgkmcnt(0)
    v_mfma_f32_32x32x16_bf16 v[56:71], v[28:31], v[16:19], 0
    v_mfma_f32_32x32x8bf16_1k v[56:71], v[36:37], v[24:25], v[56:71]
    s_nop 11
    v_sub_f32 v56, v56, v72
    v_sub_f32 v57, v57, v72
    v_sub_f32 v58, v58, v72
    v_sub_f32 v59, v59, v72
    v_sub_f32 v60, v60, v72
    v_sub_f32 v61, v61, v72
    v_sub_f32 v62, v62, v72
    v_sub_f32 v63, v63, v72
    v_sub_f32 v64, v64, v72
    v_sub_f32 v65, v65, v72
    v_sub_f32 v66, v66, v72
    v_sub_f32 v67, v67, v72
    v_sub_f32 v68, v68, v72
    v_sub_f32 v69, v69, v72
    v_sub_f32 v70, v70, v72
    v_sub_f32 v71, v71, v72
    v_exp_f32 v56, v56
    v_exp_f32 v57, v57
    v_exp_f32 v58, v58
    v_exp_f32 v59, v59
    v_exp_f32 v60, v60
    v_exp_f32 v61, v61
    v_exp_f32 v62, v62
    v_exp_f32 v63, v63
    v_exp_f32 v64, v64
    v_exp_f32 v65, v65
    v_exp_f32 v66, v66
    v_exp_f32 v67, v67
    v_exp_f32 v68, v68
    v_exp_f32 v69, v69
    v_exp_f32 v70, v70
    v_exp_f32 v71, v71
    v_cvt_pk_bf16_f32 v88, v56, v57
    v_cvt_pk_bf16_f32 v89, v58, v59
    v_cvt_pk_bf16_f32 v90, v60, v61
    v_cvt_pk_bf16_f32 v91, v62, v63
    v_cvt_pk_bf16_f32 v92, v64, v65
    v_cvt_pk_bf16_f32 v93, v66, v67
    v_cvt_pk_bf16_f32 v94, v68, v69
    v_cvt_pk_bf16_f32 v95, v70, v71
    v_mfma_f32_32x32x16_bf16 v[104:119], v[40:43], v[88:91], v[104:119]
    s_nop 0
    v_mfma_f32_32x32x16_bf16 v[104:119], v[44:47], v[92:95], v[104:119]
    v_mfma_f32_32x32x16_bf16 v[56:71], v[28:31], v[20:23], 0
    v_mfma_f32_32x32x8bf16_1k v[56:71], v[36:37], v[26:27], v[56:71]
    s_nop 11
    v_sub_f32 v56, v56, v73
    v_sub_f32 v57, v57, v73
    v_sub_f32 v58, v58, v73
    v_sub_f32 v59, v59, v73
    v_sub_f32 v60, v60, v73
    v_sub_f32 v61, v61, v73
    v_sub_f32 v62, v62, v73
    v_sub_f32 v63, v63, v73
    v_sub_f32 v64, v64, v73
    v_sub_f32 v65, v65, v73
    v_sub_f32 v66, v66, v73
    v_sub_f32 v67, v67, v73
    v_sub_f32 v68, v68, v73
    v_sub_f32 v69, v69, v73
    v_sub_f32 v70, v70, v73
    v_sub_f32 v71, v71, v73
    v_exp_f32 v56, v56
    v_exp_f32 v57, v57
    v_exp_f32 v58, v58
    v_exp_f32 v59, v59
    v_exp_f32 v60, v60
    v_exp_f32 v61, v61
    v_exp_f32 v62, v62
    v_exp_f32 v63, v63
    v_exp_f32 v64, v64
    v_exp_f32 v65, v65
    v_exp_f32 v66, v66
    v_exp_f32 v67, v67
    v_exp_f32 v68, v68
    v_exp_f32 v69, v69
    v_exp_f32 v70, v70
    v_exp_f32 v71, v71
    v_cvt_pk_bf16_f32 v88, v56, v57
    v_cvt_pk_bf16_f32 v89, v58, v59
    v_cvt_pk_bf16_f32 v90, v60, v61
    v_cvt_pk_bf16_f32 v91, v62, v63
    v_cvt_pk_bf16_f32 v92, v64, v65
    v_cvt_pk_bf16_f32 v93, v66, v67
    v_cvt_pk_bf16_f32 v94, v68, v69
    v_cvt_pk_bf16_f32 v95, v70, v71
    v_mfma_f32_32x32x16_bf16 v[120:135], v[40:43], v[88:91], v[120:135]
    s_nop 0
    v_mfma_f32_32x32x16_bf16 v[120:135], v[44:47], v[92:95], v[120:135]
    ds_read_b128 v[28:31], v11 offset:29696
    ds_read_b64 v[36:37], v12 offset:29184
    ds_read_b128 v[40:43], v13 offset:30720
    ds_read_b128 v[44:47], v13 offset:31744
    s_waitcnt lgkmcnt(0)
    v_mfma_f32_32x32x16_bf16 v[56:71], v[28:31], v[16:19], 0
    v_mfma_f32_32x32x8bf16_1k v[56:71], v[36:37], v[24:25], v[56:71]
    s_nop 11
    v_sub_f32 v56, v56, v72
    v_sub_f32 v57, v57, v72
    v_sub_f32 v58, v58, v72
    v_sub_f32 v59, v59, v72
    v_sub_f32 v60, v60, v72
    v_sub_f32 v61, v61, v72
    v_sub_f32 v62, v62, v72
    v_sub_f32 v63, v63, v72
    v_sub_f32 v64, v64, v72
    v_sub_f32 v65, v65, v72
    v_sub_f32 v66, v66, v72
    v_sub_f32 v67, v67, v72
    v_sub_f32 v68, v68, v72
    v_sub_f32 v69, v69, v72
    v_sub_f32 v70, v70, v72
    v_sub_f32 v71, v71, v72
    v_exp_f32 v56, v56
    v_exp_f32 v57, v57
    v_exp_f32 v58, v58
    v_exp_f32 v59, v59
    v_exp_f32 v60, v60
    v_exp_f32 v61, v61
    v_exp_f32 v62, v62
    v_exp_f32 v63, v63
    v_exp_f32 v64, v64
    v_exp_f32 v65, v65
    v_exp_f32 v66, v66
    v_exp_f32 v67, v67
    v_exp_f32 v68, v68
    v_exp_f32 v69, v69
    v_exp_f32 v70, v70
    v_exp_f32 v71, v71
    v_cvt_pk_bf16_f32 v88, v56, v57
    v_cvt_pk_bf16_f32 v89, v58, v59
    v_cvt_pk_bf16_f32 v90, v60, v61
    v_cvt_pk_bf16_f32 v91, v62, v63
    v_cvt_pk_bf16_f32 v92, v64, v65
    v_cvt_pk_bf16_f32 v93, v66, v67
    v_cvt_pk_bf16_f32 v94, v68, v69
    v_cvt_pk_bf16_f32 v95, v70, v71
    v_mfma_f32_32x32x16_bf16 v[104:119], v[40:43], v[88:91], v[104:119]
    s_nop 0
    v_mfma_f32_32x32x16_bf16 v[104:119], v[44:47], v[92:95], v[104:119]
    v_mfma_f32_32x32x16_bf16 v[56:71], v[28:31], v[20:23], 0
    v_mfma_f32_32x32x8bf16_1k v[56:71], v[36:37], v[26:27], v[56:71]
    s_nop 11
    v_sub_f32 v56, v56, v73
    v_sub_f32 v57, v57, v73
    v_sub_f32 v58, v58, v73
    v_sub_f32 v59, v59, v73
    v_sub_f32 v60, v60, v73
    v_sub_f32 v61, v61, v73
    v_sub_f32 v62, v62, v73
    v_sub_f32 v63, v63, v73
    v_sub_f32 v64, v64, v73
    v_sub_f32 v65, v65, v73
    v_sub_f32 v66, v66, v73
    v_sub_f32 v67, v67, v73
    v_sub_f32 v68, v68, v73
    v_sub_f32 v69, v69, v73
    v_sub_f32 v70, v70, v73
    v_sub_f32 v71, v71, v73
    v_exp_f32 v56, v56
    v_exp_f32 v57, v57
    v_exp_f32 v58, v58
    v_exp_f32 v59, v59
    v_exp_f32 v60, v60
    v_exp_f32 v61, v61
    v_exp_f32 v62, v62
    v_exp_f32 v63, v63
    v_exp_f32 v64, v64
    v_exp_f32 v65, v65
    v_exp_f32 v66, v66
    v_exp_f32 v67, v67
    v_exp_f32 v68, v68
    v_exp_f32 v69, v69
    v_exp_f32 v70, v70
    v_exp_f32 v71, v71
    v_cvt_pk_bf16_f32 v88, v56, v57
    v_cvt_pk_bf16_f32 v89, v58, v59
    v_cvt_pk_bf16_f32 v90, v60, v61
    v_cvt_pk_bf16_f32 v91, v62, v63
    v_cvt_pk_bf16_f32 v92, v64, v65
    v_cvt_pk_bf16_f32 v93, v66, v67
    v_cvt_pk_bf16_f32 v94, v68, v69
    v_cvt_pk_bf16_f32 v95, v70, v71
    v_mfma_f32_32x32x16_bf16 v[120:135], v[40:43], v[88:91], v[120:135]
    s_nop 0
    v_mfma_f32_32x32x16_bf16 v[120:135], v[44:47], v[92:95], v[120:135]
    s_sub_u32 s60, s60, 1
    s_cmp_lg_u32 s60, 0
    s_cbranch_scc1 .Lat_fb2
    s_nop 15
    s_barrier
    s_branch .Lat_combine
.Lkf_last:
    s_endpgm
.section .rodata,"a"
.p2align 6
.amdhsa_kernel k1_kernel
  .amdhsa_next_free_vgpr 160
  .amdhsa_next_free_sgpr 102
  .amdhsa_accum_offset 160
  .amdhsa_group_segment_fixed_size 0
  .amdhsa_kernarg_size 88
  .amdhsa_user_sgpr_count 2
  .amdhsa_user_sgpr_kernarg_segment_ptr 1
  .amdhsa_system_sgpr_workgroup_id_x 1
.end_amdhsa_kernel

.p2align 6
.amdhsa_kernel kf_kernel
  .amdhsa_next_free_vgpr 256
  .amdhsa_next_free_sgpr 102
  .amdhsa_accum_offset 256
  .amdhsa_group_segment_fixed_size 0
  .amdhsa_kernarg_size 88
  .amdhsa_user_sgpr_count 2
  .amdhsa_user_sgpr_kernarg_segment_ptr 1
  .amdhsa_system_sgpr_workgroup_id_x 1
.end_amdhsa_kernel
```
